```python
import torch

def _softmax(x, axis=-1):
    return torch.softmax(x, dim=axis)
def _gelu(x):
    return torch.nn.functional.gelu(x, approximate="tanh")
def _silu(x):
    return torch.nn.functional.silu(x)
def _sigmoid(x):
    return torch.sigmoid(x)
def _layernorm(x, axis=-1, eps=1e-5):
    m = x.mean(dim=axis, keepdim=True)
    v = x.var(dim=axis, keepdim=True, unbiased=False)
    return (x - m) / torch.sqrt(v + eps)
def _scatter_add(tgt, idx, src, axis=0):
    return tgt.clone().index_add_(axis, idx, src)
def _segment_sum(src, seg, n):
    out = torch.zeros((n,) + src.shape[1:], dtype=src.dtype)
    return out.index_add_(0, seg, src)
def _pad(x, pw):
    flat = tuple(v for pair in reversed(pw) for v in pair)
    return torch.nn.functional.pad(x, flat)

kernel_name = 'concat_heads__mha_block_cached__gqa_block_cached__near_ridge'

def setup_inputs():

    _w = (lambda a: (lambda t: t.to(torch.bfloat16) if t.is_floating_point() else t)(torch.as_tensor(a)))
    def _A_setup():
        B, Sq, D = 8, 160, 576
        H, Sk, Dh = 32, 1024, 128
        return {
            "x": _w((lambda *s: torch.randn(*s, dtype=torch.bfloat16) * 0.8)(B, Sq, D)),
            "k_cache": _w((lambda *s: torch.randn(*s, dtype=torch.bfloat16) * 0.8)(B, H, Sk, Dh)),
            "v_cache": _w((lambda *s: torch.randn(*s, dtype=torch.bfloat16) * 0.05)(B, H, Sk, Dh)),
            "wq": _w((lambda *s: torch.randn(*s, dtype=torch.bfloat16) * 0.8)(D, H * Dh) * (D ** -0.5)),
            "wo": _w((lambda *s: torch.randn(*s, dtype=torch.bfloat16) * 0.05)(H * Dh, D) * ((H * Dh) ** -0.5)),
        }
    _A_in = _A_setup()

    def _B_setup():
        B, Sq, D = 8, 160, 576
        Hq, Hkv, Sk, Dh = 32, 32, 1024, 128
        assert Hq % Hkv == 0, (Hq, Hkv)
        return {
            "x": _w((lambda *s: torch.randn(*s, dtype=torch.bfloat16) * 0.8)(B, Sq, D)),
            "k_cache": _w((lambda *s: torch.randn(*s, dtype=torch.bfloat16) * 0.8)(B, Hkv, Sk, Dh)),
            "v_cache": _w((lambda *s: torch.randn(*s, dtype=torch.bfloat16) * 0.05)(B, Hkv, Sk, Dh)),
            "wq": _w((lambda *s: torch.randn(*s, dtype=torch.bfloat16) * 0.8)(D, Hq * Dh) * (D ** -0.5)),
            "wo": _w((lambda *s: torch.randn(*s, dtype=torch.bfloat16) * 0.05)(Hq * Dh, D) * ((Hq * Dh) ** -0.5)),
        }
    _B_in = _B_setup()

    return {
        "A_x": _A_in["x"],
        "A_k_cache": _A_in["k_cache"],
        "A_v_cache": _A_in["v_cache"],
        "A_wq": _A_in["wq"],
        "A_wo": _A_in["wo"],
        "B_x": _B_in["x"],
        "B_k_cache": _B_in["k_cache"],
        "B_v_cache": _B_in["v_cache"],
        "B_wq": _B_in["wq"],
        "B_wo": _B_in["wo"],
    }

def reference(A_x, A_k_cache, A_v_cache, A_wq, A_wo, B_x, B_k_cache, B_v_cache, B_wq, B_wo):
    def _A_ref(x, k_cache, v_cache, wq, wo):
        B, Sq, D = x.shape
        H, Dh = 32, 128
        q = (lambda x, *d: x.permute(*d))((x @ wq).reshape(B, Sq, H, Dh), 0, 2, 1, 3)
        scores = torch.einsum("bhqd,bhkd->bhqk", q, k_cache) * (Dh ** -0.5)
        p = _softmax(scores, axis=-1)
        o = torch.einsum("bhqk,bhkd->bhqd", p, v_cache)
        return (lambda x, *d: x.permute(*d))(o, 0, 2, 1, 3).reshape(B, Sq, H * Dh) @ wo

    def _B_ref(x, k_cache, v_cache, wq, wo):
        B, Sq, D = x.shape
        Hq, Dh = 32, 128
        Hkv = k_cache.shape[1]
        rep = Hq // Hkv
        q = (lambda x, *d: x.permute(*d))((x @ wq).reshape(B, Sq, Hq, Dh), 0, 2, 1, 3)
        k = (lambda x, n, axis: torch.repeat_interleave(x, n, dim=axis))(k_cache, rep, axis=1)
        v = (lambda x, n, axis: torch.repeat_interleave(x, n, dim=axis))(v_cache, rep, axis=1)
        scores = torch.einsum("bhqd,bhkd->bhqk", q, k) * (Dh ** -0.5)
        p = _softmax(scores, axis=-1)
        o = torch.einsum("bhqk,bhkd->bhqd", p, v)
        return (lambda x, *d: x.permute(*d))(o, 0, 2, 1, 3).reshape(B, Sq, Hq * Dh) @ wo

    a = _A_ref(A_x, A_k_cache, A_v_cache, A_wq, A_wo)
    b = _B_ref(B_x, B_k_cache, B_v_cache, B_wq, B_wo)
    return torch.concatenate([a, b], axis=-1)
```

```asm
; @launch grid=(256,1,1) block=(256,1,1) lds=163840
.amdgcn_target "amdgcn-amd-amdhsa--gfx950"
.text
.globl concat_heads__mha_block_cached__gqa_block_cached__near_ridge_kernel
.p2align 8
.type concat_heads__mha_block_cached__gqa_block_cached__near_ridge_kernel,@function
concat_heads__mha_block_cached__gqa_block_cached__near_ridge_kernel:
    s_cmp_ge_u32 s2, 256
    s_cbranch_scc1 L_attn_end
    s_load_dwordx16 s[56:71], s[0:1], 0
    s_load_dwordx8 s[72:79], s[0:1], 64
    s_load_dwordx2 s[80:81], s[0:1], 96
    v_lshrrev_b32 v1, 6, v0
    v_and_b32 v252, 63, v0
    v_readfirstlane_b32 s24, v1
    s_lshr_b32 s51, s2, 2
    s_and_b32 s51, s51, 1
    s_and_b32 s36, s2, 3
    s_lshl_b32 s36, s36, 3
    s_lshr_b32 s37, s2, 3
    s_and_b32 s38, s37, 7
    s_add_u32 s49, s36, s38
    s_lshr_b32 s50, s37, 3
    s_lshl_b32 s36, s50, 1
    s_add_u32 s43, s38, s36
    s_cmp_ge_u32 s43, 9
    s_cselect_b32 s36, 9, 0
    s_sub_u32 s43, s43, s36
    s_lshr_b32 s83, s24, 1
    s_and_b32 s84, s24, 1
    s_mul_i32 s44, s24, 46080
    s_mul_i32 s87, s24, 5120
    s_lshl_b32 s88, s24, 11
    s_lshl_b32 s89, s24, 16
    v_lshrrev_b32 v1, 4, v252
    v_and_b32 v2, 15, v252
    v_lshlrev_b32 v3, 2, v1
    v_xor_b32 v3, v3, v2
    v_lshlrev_b32 v3, 4, v3
    v_lshl_add_u32 v229, v1, 13, v3
    v_add_u32 v230, 31744, v229
    v_lshrrev_b32 v4, 3, v252
    v_and_b32 v5, 7, v252
    v_xor_b32 v5, v5, v1
    v_lshlrev_b32 v5, 4, v5
    s_lshl_b32 s36, s84, 6
    v_xor_b32 v5, s36, v5
    v_mul_u32_u24 v4, 1152, v4
    v_add_u32 v6, v4, v5
    v_xor_b32 v5, 64, v5
    v_add_u32 v7, v4, v5
    v_add_u32 v224, 0, v6
    v_add_u32 v225, 8192, v7
    v_add_u32 v226, 16384, v6
    v_add_u32 v227, 24576, v7
    v_add_u32 v228, 36864, v6
    s_waitcnt lgkmcnt(0)
    s_cmp_eq_u32 s51, 0
    s_cselect_b32 s16, s62, s72
    s_cselect_b32 s17, s63, s73
    s_cselect_b32 s12, s56, s66
    s_cselect_b32 s13, s57, s67
    s_cselect_b32 s4, s58, s68
    s_cselect_b32 s5, s59, s69
    s_cselect_b32 s8, s60, s70
    s_cselect_b32 s9, s61, s71
    s_cselect_b32 s92, s64, s74
    s_cselect_b32 s93, s65, s75
    s_lshl_b32 s36, s49, 8
    s_add_u32 s16, s16, s36
    s_addc_u32 s17, s17, 0
    s_mov_b32 s18, 4710656
    s_mov_b32 s19, 0x20000
    s_mul_i32 s36, s50, 184320
    s_add_u32 s12, s12, s36
    s_addc_u32 s13, s13, 0
    s_mov_b32 s14, 921600
    s_mov_b32 s15, 0x20000
    s_add_u32 s46, s43, 0
    s_cmp_ge_u32 s46, 9
    s_cselect_b32 s39, 9, 0
    s_sub_u32 s46, s46, s39
    s_lshl_b32 s46, s46, 19
    s_add_u32 s46, s46, s89
    s_add_u32 m0, s88, 16384
    s_nop 0
    buffer_load_dwordx4 v229, s[16:19], s46 offen lds
    buffer_load_dwordx4 v230, s[16:19], s46 offen offset:1024 lds
    s_add_u32 s45, s43, 0
    s_cmp_ge_u32 s45, 9
    s_cselect_b32 s39, 9, 0
    s_sub_u32 s45, s45, s39
    s_lshl_b32 s45, s45, 7
    s_add_u32 s45, s45, s44
    s_add_u32 m0, s87, 98304
    s_nop 0
    buffer_load_dwordx4 v224, s[12:15], s45 offen lds
    buffer_load_dwordx4 v225, s[12:15], s45 offen offset:1024 lds
    buffer_load_dwordx4 v226, s[12:15], s45 offen offset:2048 lds
    buffer_load_dwordx4 v227, s[12:15], s45 offen offset:3072 lds
    s_add_u32 m0, s87, 102400
    s_nop 0
    buffer_load_dwordx4 v228, s[12:15], s45 offen lds
    s_add_u32 s46, s43, 0
    s_cmp_ge_u32 s46, 9
    s_cselect_b32 s39, 9, 0
    s_sub_u32 s46, s46, s39
    s_lshl_b32 s46, s46, 19
    s_add_u32 s46, s46, s89
    s_add_u32 s46, s46, 262144
    s_add_u32 m0, s88, 40960
    s_nop 0
    buffer_load_dwordx4 v229, s[16:19], s46 offen lds
    buffer_load_dwordx4 v230, s[16:19], s46 offen offset:1024 lds
    s_lshl_b32 s36, s50, 5
    s_add_u32 s36, s36, s49
    s_lshr_b32 s37, s36, 14
    s_lshl_b32 s36, s36, 18
    s_add_u32 s4, s4, s36
    s_addc_u32 s5, s5, s37
    s_mov_b32 s6, 0x2040000
    s_mov_b32 s7, 0x20000
    s_add_u32 s8, s8, s36
    s_addc_u32 s9, s9, s37
    s_mov_b32 s10, 0x2040000
    s_mov_b32 s11, 0x20000
    s_mov_b32 s20, s80
    s_mov_b32 s21, s81
    s_mov_b32 s22, 20971520
    s_mov_b32 s23, 0x20000
    s_lshl_b32 s36, s51, 3
    s_add_u32 s36, s36, s50
    s_mul_i32 s36, s36, 10
    s_mul_i32 s37, s84, 5
    s_add_u32 s36, s36, s37
    s_lshl_b32 s36, s36, 17
    s_lshl_b32 s37, s49, 12
    s_add_u32 s36, s36, s37
    s_lshl_b32 s37, s83, 11
    s_add_u32 s48, s36, s37
    s_mul_i32 s25, s83, 49152
    s_add_u32 s82, s25, 24576
    s_lshl_b32 s36, s84, 12
    s_add_u32 s52, s25, s36
    s_add_u32 s53, s82, s36
    s_lshl_b32 s42, s83, 13
    s_add_u32 s42, s42, s36
    s_lshr_b32 s86, s2, 3
    s_lshl_b32 s86, s86, 1
    s_and_b32 s86, s86, 15
    s_mov_b32 s54, 0x3e0293ee
    s_lshl_b32 s90, s2, 7
    s_mov_b32 s85, 0
    v_xor_b32 v3, v1, v2
    v_lshlrev_b32 v3, 4, v3
    v_lshl_add_u32 v164, v1, 8, v3
    v_xor_b32 v165, 64, v164
    v_xor_b32 v166, 128, v164
    v_xor_b32 v167, 192, v164
    v_lshlrev_b32 v3, 1, v1
    v_xor_b32 v3, v3, v2
    v_lshlrev_b32 v3, 4, v3
    v_lshl_add_u32 v168, v1, 8, v3
    v_xor_b32 v169, 128, v168
    v_lshrrev_b32 v6, 1, v2
    v_xor_b32 v6, v6, v1
    v_lshlrev_b32 v6, 4, v6
    s_mul_i32 s36, s84, 10240
    s_add_u32 s36, s36, 98304
    v_lshl_add_u32 v6, v2, 7, v6
    v_add_u32 v232, s36, v6
    v_xor_b32 v233, 64, v232
    v_xor_b32 v6, v1, v2
    v_lshlrev_b32 v6, 4, v6
    v_lshl_add_u32 v160, v2, 8, v6
    v_lshrrev_b32 v6, 2, v2
    v_and_b32 v7, 3, v2
    v_lshl_add_u32 v8, v1, 2, v6
    v_and_b32 v9, 7, v8
    s_lshl_b32 s36, s83, 2
    v_xor_b32 v9, s36, v9
    v_lshlrev_b32 v8, 8, v8
    v_lshl_add_u32 v8, v9, 5, v8
    v_lshl_add_u32 v161, v7, 3, v8
    v_lshl_add_u32 v8, v1, 3, v6
    v_lshlrev_b32 v8, 8, v8
    s_lshl_b32 s36, s83, 1
    v_xor_b32 v9, s36, v6
    v_lshl_add_u32 v8, v9, 6, v8
    v_lshl_add_u32 v8, v7, 4, v8
    v_add_u32 v236, 16384, v8
    v_xor_b32 v237, 64, v236
    v_add_u32 v238, 40960, v8
    v_xor_b32 v239, 64, v238
    v_add_u32 v240, 65536, v8
    v_xor_b32 v241, 64, v240
    v_add_u32 v242, 90112, v8
    v_xor_b32 v243, 64, v242
    v_lshlrev_b32 v10, 4, v252
    v_add_u32 v162, 98304, v10
    v_mov_b32 v251, v10
    s_mov_b32 s95, 0x70000000
    v_add_u32 v11, 0, v252
    v_mul_u32_u24 v12, 2731, v11
    v_lshrrev_b32 v12, 16, v12
    v_mul_u32_u24 v13, 24, v12
    v_sub_u32 v13, v11, v13
    v_lshrrev_b32 v14, 1, v12
    v_and_b32 v14, 3, v14
    v_lshlrev_b32 v14, 1, v14
    v_xor_b32 v13, v13, v14
    v_mul_u32_u24 v12, 1152, v12
    v_lshl_add_u32 v253, v13, 4, v12
    v_add_u32 v11, 64, v252
    v_mul_u32_u24 v12, 2731, v11
    v_lshrrev_b32 v12, 16, v12
    v_mul_u32_u24 v13, 24, v12
    v_sub_u32 v13, v11, v13
    v_lshrrev_b32 v14, 1, v12
    v_and_b32 v14, 3, v14
    v_lshlrev_b32 v14, 1, v14
    v_xor_b32 v13, v13, v14
    v_mul_u32_u24 v12, 1152, v12
    v_lshl_add_u32 v254, v13, 4, v12
    v_add_u32 v11, 128, v252
    v_mul_u32_u24 v12, 2731, v11
    v_lshrrev_b32 v12, 16, v12
    v_mul_u32_u24 v13, 24, v12
    v_sub_u32 v13, v11, v13
    v_lshrrev_b32 v14, 1, v12
    v_and_b32 v14, 3, v14
    v_lshlrev_b32 v14, 1, v14
    v_xor_b32 v13, v13, v14
    v_mul_u32_u24 v12, 1152, v12
    v_lshl_add_u32 v255, v13, 4, v12
    s_add_u32 s96, s80, 0x5000000
    s_addc_u32 s97, s81, 0
    s_mov_b32 s98, 32768
    s_mov_b32 s99, 0x20000
    s_cmp_lg_u32 s24, 0
    s_cbranch_scc1 L_attn_f0
    v_mov_b32 v20, 0
    v_mov_b32 v21, 0
    s_mov_b64 exec, 1
    buffer_store_dword v20, v21, s[96:99], s90 offen sc0 sc1
    s_mov_b64 exec, -1
L_attn_f0:
    s_add_u32 s45, s43, 0
    s_cmp_ge_u32 s45, 9
    s_cselect_b32 s39, 9, 0
    s_sub_u32 s45, s45, s39
    s_lshl_b32 s45, s45, 7
    s_add_u32 s45, s45, s44
    s_add_u32 s45, s45, 737280
    s_add_u32 m0, s87, 118784
    s_nop 0
    buffer_load_dwordx4 v224, s[12:15], s45 offen lds
    buffer_load_dwordx4 v225, s[12:15], s45 offen offset:1024 lds
    buffer_load_dwordx4 v226, s[12:15], s45 offen offset:2048 lds
    buffer_load_dwordx4 v227, s[12:15], s45 offen offset:3072 lds
    s_add_u32 m0, s87, 122880
    s_nop 0
    buffer_load_dwordx4 v228, s[12:15], s45 offen lds
    s_add_u32 s46, s43, 1
    s_cmp_ge_u32 s46, 9
    s_cselect_b32 s39, 9, 0
    s_sub_u32 s46, s46, s39
    s_lshl_b32 s46, s46, 19
    s_add_u32 s46, s46, s89
    s_add_u32 m0, s88, 65536
    s_nop 0
    buffer_load_dwordx4 v229, s[16:19], s46 offen lds
    buffer_load_dwordx4 v230, s[16:19], s46 offen offset:1024 lds
    s_add_u32 s46, s43, 1
    s_cmp_ge_u32 s46, 9
    s_cselect_b32 s39, 9, 0
    s_sub_u32 s46, s46, s39
    s_lshl_b32 s46, s46, 19
    s_add_u32 s46, s46, s89
    s_add_u32 s46, s46, 262144
    s_add_u32 m0, s88, 90112
    s_nop 0
    buffer_load_dwordx4 v229, s[16:19], s46 offen lds
    buffer_load_dwordx4 v230, s[16:19], s46 offen offset:1024 lds
    s_add_u32 s38, s85, 0
    s_add_u32 s36, s38, s86
    s_and_b32 s36, s36, 15
    s_lshl_b32 s36, s36, 14
    s_add_u32 s36, s36, s42
    s_lshr_b32 s37, s38, 4
    s_lshl_b32 s37, s37, 25
    s_add_u32 s36, s36, s37
    s_cmp_lt_u32 s38, 32
    s_cselect_b32 s29, s36, 0x70000000
    s_add_u32 s38, s85, 1
    s_add_u32 s36, s38, s86
    s_and_b32 s36, s36, 15
    s_lshl_b32 s36, s36, 14
    s_add_u32 s36, s36, s42
    s_lshr_b32 s37, s38, 4
    s_lshl_b32 s37, s37, 25
    s_add_u32 s36, s36, s37
    s_cmp_lt_u32 s38, 32
    s_cselect_b32 s30, s36, 0x70000000
    s_waitcnt vmcnt(9)
    s_waitcnt lgkmcnt(0)
    s_barrier
    ds_read_b128 a[0:3], v232 offset:0
    ds_read_b128 a[4:7], v232 offset:2048
    ds_read_b128 a[8:11], v232 offset:4096
    ds_read_b128 a[12:15], v232 offset:6144
    ds_read_b128 a[16:19], v232 offset:8192
    ds_read_b128 a[20:23], v233 offset:0
    ds_read_b64_tr_b16 v[192:193], v236 offset:0
    ds_read_b64_tr_b16 v[194:195], v236 offset:1024
    ds_read_b64_tr_b16 v[196:197], v236 offset:8
    ds_read_b64_tr_b16 v[198:199], v236 offset:1032
    ds_read_b64_tr_b16 v[200:201], v237 offset:0
    ds_read_b64_tr_b16 v[202:203], v237 offset:1024
    ds_read_b64_tr_b16 v[204:205], v237 offset:8
    ds_read_b64_tr_b16 v[206:207], v237 offset:1032
    ds_read_b64_tr_b16 v[208:209], v238 offset:0
    ds_read_b64_tr_b16 v[210:211], v238 offset:1024
    ds_read_b64_tr_b16 v[212:213], v238 offset:8
    ds_read_b64_tr_b16 v[214:215], v238 offset:1032
    ds_read_b64_tr_b16 v[216:217], v239 offset:0
    ds_read_b64_tr_b16 v[218:219], v239 offset:1024
    ds_read_b64_tr_b16 v[220:221], v239 offset:8
    ds_read_b64_tr_b16 v[222:223], v239 offset:1032
    s_waitcnt lgkmcnt(14)
    v_mfma_f32_16x16x32_bf16 v[80:83], v[192:195], a[0:3], 0
    s_waitcnt lgkmcnt(12)
    ds_read_b128 a[24:27], v233 offset:2048
    v_mfma_f32_16x16x32_bf16 v[84:87], v[196:199], a[0:3], 0
    s_waitcnt lgkmcnt(11)
    v_mfma_f32_16x16x32_bf16 v[88:91], v[200:203], a[0:3], 0
    s_waitcnt lgkmcnt(9)
    v_mfma_f32_16x16x32_bf16 v[92:95], v[204:207], a[0:3], 0
    s_add_u32 s45, s43, 1
    v_mfma_f32_16x16x32_bf16 v[96:99], v[192:195], a[4:7], 0
    s_cmp_ge_u32 s45, 9
    s_cselect_b32 s39, 9, 0
    ds_read_b128 a[28:31], v233 offset:4096
    v_mfma_f32_16x16x32_bf16 v[100:103], v[196:199], a[4:7], 0
    s_sub_u32 s45, s45, s39
    v_mfma_f32_16x16x32_bf16 v[104:107], v[200:203], a[4:7], 0
    s_lshl_b32 s45, s45, 7
    v_mfma_f32_16x16x32_bf16 v[108:111], v[204:207], a[4:7], 0
    s_add_u32 s45, s45, s44
    v_mfma_f32_16x16x32_bf16 v[112:115], v[192:195], a[8:11], 0
    s_add_u32 m0, s87, 139264
    ds_read_b128 a[32:35], v233 offset:6144
    v_mfma_f32_16x16x32_bf16 v[116:119], v[196:199], a[8:11], 0
    buffer_load_dwordx4 v224, s[12:15], s45 offen lds
    v_mfma_f32_16x16x32_bf16 v[120:123], v[200:203], a[8:11], 0
    v_mfma_f32_16x16x32_bf16 v[124:127], v[204:207], a[8:11], 0
    buffer_load_dwordx4 v225, s[12:15], s45 offen offset:1024 lds
    v_mfma_f32_16x16x32_bf16 v[128:131], v[192:195], a[12:15], 0
    ds_read_b128 a[36:39], v233 offset:8192
    v_mfma_f32_16x16x32_bf16 v[132:135], v[196:199], a[12:15], 0
    buffer_load_dwordx4 v226, s[12:15], s45 offen offset:2048 lds
    v_mfma_f32_16x16x32_bf16 v[136:139], v[200:203], a[12:15], 0
    v_mfma_f32_16x16x32_bf16 v[140:143], v[204:207], a[12:15], 0
    buffer_load_dwordx4 v227, s[12:15], s45 offen offset:3072 lds
    v_mfma_f32_16x16x32_bf16 v[144:147], v[192:195], a[16:19], 0
    v_mfma_f32_16x16x32_bf16 v[148:151], v[196:199], a[16:19], 0
    s_add_u32 m0, s87, 143360
    s_nop 0
    buffer_load_dwordx4 v228, s[12:15], s45 offen lds
    v_mfma_f32_16x16x32_bf16 v[152:155], v[200:203], a[16:19], 0
    v_mfma_f32_16x16x32_bf16 v[156:159], v[204:207], a[16:19], 0
    s_waitcnt lgkmcnt(10)
    v_mfma_f32_16x16x32_bf16 v[80:83], v[208:211], a[20:23], v[80:83]
    s_waitcnt lgkmcnt(8)
    v_mfma_f32_16x16x32_bf16 v[84:87], v[212:215], a[20:23], v[84:87]
    s_waitcnt lgkmcnt(6)
    v_mfma_f32_16x16x32_bf16 v[88:91], v[216:219], a[20:23], v[88:91]
    s_waitcnt vmcnt(9)
    s_waitcnt lgkmcnt(0)
    s_barrier
    s_cmp_lg_u32 s24, 0
    s_cbranch_scc1 L_attn_noinit
    v_mov_b32 v180, 0
    v_mov_b32 v181, 1
    s_mov_b32 s96, s78
    s_mov_b32 s97, s79
    s_mov_b32 s98, 256
    s_mov_b32 s99, 0x20000
    s_mov_b64 exec, 1
    buffer_atomic_add v181, v180, s[96:99], 0 offen sc1
    s_mov_b64 exec, -1
L_attn_noinit:
    ds_read_b128 a[40:43], v232 offset:20480
    s_nop 2
    v_mfma_f32_16x16x32_bf16 v[92:95], v[220:223], a[20:23], v[92:95]
    ds_read_b128 a[44:47], v232 offset:22528
    v_mfma_f32_16x16x32_bf16 v[96:99], v[208:211], a[24:27], v[96:99]
    s_add_u32 s45, s43, 1
    ds_read_b128 a[48:51], v232 offset:24576
    v_mfma_f32_16x16x32_bf16 v[100:103], v[212:215], a[24:27], v[100:103]
    s_cmp_ge_u32 s45, 9
    s_cselect_b32 s39, 9, 0
    v_mfma_f32_16x16x32_bf16 v[104:107], v[216:219], a[24:27], v[104:107]
    s_sub_u32 s45, s45, s39
    v_mfma_f32_16x16x32_bf16 v[108:111], v[220:223], a[24:27], v[108:111]
    s_lshl_b32 s45, s45, 7
    v_mfma_f32_16x16x32_bf16 v[112:115], v[208:211], a[28:31], v[112:115]
    s_add_u32 s45, s45, s44
    ds_read_b128 a[52:55], v232 offset:26624
    v_mfma_f32_16x16x32_bf16 v[116:119], v[212:215], a[28:31], v[116:119]
    s_add_u32 s45, s45, 737280
    v_mfma_f32_16x16x32_bf16 v[120:123], v[216:219], a[28:31], v[120:123]
    s_add_u32 m0, s87, 98304
    v_mfma_f32_16x16x32_bf16 v[124:127], v[220:223], a[28:31], v[124:127]
    buffer_load_dwordx4 v224, s[12:15], s45 offen lds
    v_mfma_f32_16x16x32_bf16 v[128:131], v[208:211], a[32:35], v[128:131]
    ds_read_b128 a[56:59], v232 offset:28672
    v_mfma_f32_16x16x32_bf16 v[132:135], v[212:215], a[32:35], v[132:135]
    buffer_load_dwordx4 v225, s[12:15], s45 offen offset:1024 lds
    v_mfma_f32_16x16x32_bf16 v[136:139], v[216:219], a[32:35], v[136:139]
    v_mfma_f32_16x16x32_bf16 v[140:143], v[220:223], a[32:35], v[140:143]
    buffer_load_dwordx4 v226, s[12:15], s45 offen offset:2048 lds
    v_mfma_f32_16x16x32_bf16 v[144:147], v[208:211], a[36:39], v[144:147]
    ds_read_b128 a[60:63], v233 offset:20480
    v_mfma_f32_16x16x32_bf16 v[148:151], v[212:215], a[36:39], v[148:151]
    buffer_load_dwordx4 v227, s[12:15], s45 offen offset:3072 lds
    v_mfma_f32_16x16x32_bf16 v[152:155], v[216:219], a[36:39], v[152:155]
    v_mfma_f32_16x16x32_bf16 v[156:159], v[220:223], a[36:39], v[156:159]
    s_waitcnt lgkmcnt(5)
    v_mfma_f32_16x16x32_bf16 v[0:3], v[192:195], a[40:43], 0
    s_add_u32 m0, s87, 102400
    ds_read_b128 a[0:3], v233 offset:22528
    v_mfma_f32_16x16x32_bf16 v[4:7], v[196:199], a[40:43], 0
    buffer_load_dwordx4 v228, s[12:15], s45 offen lds
    v_mfma_f32_16x16x32_bf16 v[8:11], v[200:203], a[40:43], 0
    v_mfma_f32_16x16x32_bf16 v[12:15], v[204:207], a[40:43], 0
    s_waitcnt lgkmcnt(5)
    v_mfma_f32_16x16x32_bf16 v[16:19], v[192:195], a[44:47], 0
    s_add_u32 s46, s43, 2
    ds_read_b128 a[4:7], v233 offset:24576
    v_mfma_f32_16x16x32_bf16 v[20:23], v[196:199], a[44:47], 0
    s_cmp_ge_u32 s46, 9
    s_cselect_b32 s39, 9, 0
    v_mfma_f32_16x16x32_bf16 v[24:27], v[200:203], a[44:47], 0
    s_sub_u32 s46, s46, s39
    v_mfma_f32_16x16x32_bf16 v[28:31], v[204:207], a[44:47], 0
    s_waitcnt lgkmcnt(5)
    v_mfma_f32_16x16x32_bf16 v[32:35], v[192:195], a[48:51], 0
    s_lshl_b32 s46, s46, 19
    ds_read_b128 a[8:11], v233 offset:26624
    v_mfma_f32_16x16x32_bf16 v[36:39], v[196:199], a[48:51], 0
    s_add_u32 s46, s46, s89
    v_mfma_f32_16x16x32_bf16 v[40:43], v[200:203], a[48:51], 0
    s_add_u32 m0, s88, 16384
    v_mfma_f32_16x16x32_bf16 v[44:47], v[204:207], a[48:51], 0
    s_waitcnt lgkmcnt(5)
    buffer_load_dwordx4 v229, s[16:19], s46 offen lds
    v_mfma_f32_16x16x32_bf16 v[48:51], v[192:195], a[52:55], 0
    ds_read_b128 a[12:15], v233 offset:28672
    v_mfma_f32_16x16x32_bf16 v[52:55], v[196:199], a[52:55], 0
    buffer_load_dwordx4 v230, s[16:19], s46 offen offset:1024 lds
    v_mfma_f32_16x16x32_bf16 v[56:59], v[200:203], a[52:55], 0
    v_mfma_f32_16x16x32_bf16 v[60:63], v[204:207], a[52:55], 0
    s_waitcnt lgkmcnt(5)
    v_mfma_f32_16x16x32_bf16 v[64:67], v[192:195], a[56:59], 0
    s_add_u32 m0, s52, 0
    v_mfma_f32_16x16x32_bf16 v[68:71], v[196:199], a[56:59], 0
    buffer_load_dwordx4 v164, s[4:7], s29 offen nt lds
    v_mfma_f32_16x16x32_bf16 v[72:75], v[200:203], a[56:59], 0
    v_mfma_f32_16x16x32_bf16 v[76:79], v[204:207], a[56:59], 0
    s_waitcnt lgkmcnt(4)
    v_mfma_f32_16x16x32_bf16 v[0:3], v[208:211], a[60:63], v[0:3]
    v_mfma_f32_16x16x32_bf16 v[4:7], v[212:215], a[60:63], v[4:7]
    v_mfma_f32_16x16x32_bf16 v[8:11], v[216:219], a[60:63], v[8:11]
    s_waitcnt vmcnt(8)
    s_waitcnt lgkmcnt(0)
    s_barrier
    ds_read_b128 a[16:19], v232 offset:40960
    ds_read_b64_tr_b16 v[192:193], v240 offset:0
    ds_read_b64_tr_b16 v[194:195], v240 offset:1024
    v_mfma_f32_16x16x32_bf16 v[12:15], v[220:223], a[60:63], v[12:15]
    ds_read_b128 a[20:23], v232 offset:43008
    ds_read_b64_tr_b16 v[196:197], v240 offset:8
    ds_read_b64_tr_b16 v[198:199], v240 offset:1032
    v_mfma_f32_16x16x32_bf16 v[16:19], v[208:211], a[0:3], v[16:19]
    s_add_u32 s45, s43, 2
    ds_read_b128 a[24:27], v232 offset:45056
    ds_read_b64_tr_b16 v[200:201], v241 offset:0
    ds_read_b64_tr_b16 v[202:203], v241 offset:1024
    v_mfma_f32_16x16x32_bf16 v[20:23], v[212:215], a[0:3], v[20:23]
    s_cmp_ge_u32 s45, 9
    s_cselect_b32 s39, 9, 0
    ds_read_b64_tr_b16 v[204:205], v241 offset:8
    ds_read_b64_tr_b16 v[206:207], v241 offset:1032
    v_mfma_f32_16x16x32_bf16 v[24:27], v[216:219], a[0:3], v[24:27]
    s_sub_u32 s45, s45, s39
    v_mfma_f32_16x16x32_bf16 v[28:31], v[220:223], a[0:3], v[28:31]
    s_lshl_b32 s45, s45, 7
    v_mfma_f32_16x16x32_bf16 v[32:35], v[208:211], a[4:7], v[32:35]
    s_add_u32 s45, s45, s44
    ds_read_b128 a[28:31], v232 offset:47104
    v_mfma_f32_16x16x32_bf16 v[36:39], v[212:215], a[4:7], v[36:39]
    s_add_u32 m0, s87, 118784
    s_nop 0
    buffer_load_dwordx4 v224, s[12:15], s45 offen lds
    v_mfma_f32_16x16x32_bf16 v[40:43], v[216:219], a[4:7], v[40:43]
    v_mfma_f32_16x16x32_bf16 v[44:47], v[220:223], a[4:7], v[44:47]
    buffer_load_dwordx4 v225, s[12:15], s45 offen offset:1024 lds
    v_mfma_f32_16x16x32_bf16 v[48:51], v[208:211], a[8:11], v[48:51]
    ds_read_b128 a[32:35], v232 offset:49152
    v_mfma_f32_16x16x32_bf16 v[52:55], v[212:215], a[8:11], v[52:55]
    buffer_load_dwordx4 v226, s[12:15], s45 offen offset:2048 lds
    v_mfma_f32_16x16x32_bf16 v[56:59], v[216:219], a[8:11], v[56:59]
    v_mfma_f32_16x16x32_bf16 v[60:63], v[220:223], a[8:11], v[60:63]
    buffer_load_dwordx4 v227, s[12:15], s45 offen offset:3072 lds
    v_mfma_f32_16x16x32_bf16 v[64:67], v[208:211], a[12:15], v[64:67]
    ds_read_b128 a[36:39], v233 offset:40960
    ds_read_b64_tr_b16 v[208:209], v242 offset:0
    ds_read_b64_tr_b16 v[210:211], v242 offset:1024
    v_mfma_f32_16x16x32_bf16 v[68:71], v[212:215], a[12:15], v[68:71]
    s_add_u32 m0, s87, 122880
    s_nop 0
    buffer_load_dwordx4 v228, s[12:15], s45 offen lds
    ds_read_b64_tr_b16 v[212:213], v242 offset:8
    ds_read_b64_tr_b16 v[214:215], v242 offset:1032
    v_mfma_f32_16x16x32_bf16 v[72:75], v[216:219], a[12:15], v[72:75]
    ds_read_b64_tr_b16 v[216:217], v243 offset:0
    ds_read_b64_tr_b16 v[218:219], v243 offset:1024
    v_mfma_f32_16x16x32_bf16 v[76:79], v[220:223], a[12:15], v[76:79]
    s_waitcnt lgkmcnt(15)
    ds_read_b64_tr_b16 v[220:221], v243 offset:8
    ds_read_b64_tr_b16 v[222:223], v243 offset:1032
    v_mfma_f32_16x16x32_bf16 v[80:83], v[192:195], a[16:19], v[80:83]
    s_waitcnt lgkmcnt(15)
    ds_read_b128 a[40:43], v233 offset:43008
    v_mfma_f32_16x16x32_bf16 v[84:87], v[196:199], a[16:19], v[84:87]
    s_waitcnt lgkmcnt(14)
    v_mfma_f32_16x16x32_bf16 v[88:91], v[200:203], a[16:19], v[88:91]
    s_waitcnt lgkmcnt(12)
    v_mfma_f32_16x16x32_bf16 v[92:95], v[204:207], a[16:19], v[92:95]
    s_add_u32 s46, s43, 2
    v_mfma_f32_16x16x32_bf16 v[96:99], v[192:195], a[20:23], v[96:99]
    s_cmp_ge_u32 s46, 9
    s_cselect_b32 s39, 9, 0
    ds_read_b128 a[44:47], v233 offset:45056
    v_mfma_f32_16x16x32_bf16 v[100:103], v[196:199], a[20:23], v[100:103]
    s_sub_u32 s46, s46, s39
    v_mfma_f32_16x16x32_bf16 v[104:107], v[200:203], a[20:23], v[104:107]
    s_lshl_b32 s46, s46, 19
    v_mfma_f32_16x16x32_bf16 v[108:111], v[204:207], a[20:23], v[108:111]
    s_add_u32 s46, s46, s89
    v_mfma_f32_16x16x32_bf16 v[112:115], v[192:195], a[24:27], v[112:115]
    s_add_u32 s46, s46, 262144
    ds_read_b128 a[48:51], v233 offset:47104
    v_mfma_f32_16x16x32_bf16 v[116:119], v[196:199], a[24:27], v[116:119]
    s_add_u32 m0, s88, 40960
    s_nop 0
    buffer_load_dwordx4 v229, s[16:19], s46 offen lds
    v_mfma_f32_16x16x32_bf16 v[120:123], v[200:203], a[24:27], v[120:123]
    v_mfma_f32_16x16x32_bf16 v[124:127], v[204:207], a[24:27], v[124:127]
    s_waitcnt lgkmcnt(13)
    buffer_load_dwordx4 v230, s[16:19], s46 offen offset:1024 lds
    v_mfma_f32_16x16x32_bf16 v[128:131], v[192:195], a[28:31], v[128:131]
    ds_read_b128 a[52:55], v233 offset:49152
    v_mfma_f32_16x16x32_bf16 v[132:135], v[196:199], a[28:31], v[132:135]
    v_mfma_f32_16x16x32_bf16 v[136:139], v[200:203], a[28:31], v[136:139]
    v_mfma_f32_16x16x32_bf16 v[140:143], v[204:207], a[28:31], v[140:143]
    s_waitcnt lgkmcnt(13)
    v_mfma_f32_16x16x32_bf16 v[144:147], v[192:195], a[32:35], v[144:147]
    v_mfma_f32_16x16x32_bf16 v[148:151], v[196:199], a[32:35], v[148:151]
    v_mfma_f32_16x16x32_bf16 v[152:155], v[200:203], a[32:35], v[152:155]
    v_mfma_f32_16x16x32_bf16 v[156:159], v[204:207], a[32:35], v[156:159]
    s_waitcnt lgkmcnt(10)
    v_mfma_f32_16x16x32_bf16 v[80:83], v[208:211], a[36:39], v[80:83]
    s_waitcnt lgkmcnt(8)
    v_mfma_f32_16x16x32_bf16 v[84:87], v[212:215], a[36:39], v[84:87]
    s_waitcnt lgkmcnt(6)
    v_mfma_f32_16x16x32_bf16 v[88:91], v[216:219], a[36:39], v[88:91]
    s_waitcnt vmcnt(10)
    s_waitcnt lgkmcnt(0)
    s_barrier
    ds_read_b128 a[56:59], v232 offset:0
    v_mfma_f32_16x16x32_bf16 v[92:95], v[220:223], a[36:39], v[92:95]
    ds_read_b128 a[60:63], v232 offset:2048
    v_mfma_f32_16x16x32_bf16 v[96:99], v[208:211], a[40:43], v[96:99]
    s_add_u32 s45, s43, 2
    ds_read_b128 a[0:3], v232 offset:4096
    v_mfma_f32_16x16x32_bf16 v[100:103], v[212:215], a[40:43], v[100:103]
    s_cmp_ge_u32 s45, 9
    s_cselect_b32 s39, 9, 0
    v_mfma_f32_16x16x32_bf16 v[104:107], v[216:219], a[40:43], v[104:107]
    s_sub_u32 s45, s45, s39
    v_mfma_f32_16x16x32_bf16 v[108:111], v[220:223], a[40:43], v[108:111]
    s_lshl_b32 s45, s45, 7
    v_mfma_f32_16x16x32_bf16 v[112:115], v[208:211], a[44:47], v[112:115]
    s_add_u32 s45, s45, s44
    ds_read_b128 a[4:7], v232 offset:6144
    v_mfma_f32_16x16x32_bf16 v[116:119], v[212:215], a[44:47], v[116:119]
    s_add_u32 s45, s45, 737280
    v_mfma_f32_16x16x32_bf16 v[120:123], v[216:219], a[44:47], v[120:123]
    s_add_u32 m0, s87, 139264
    v_mfma_f32_16x16x32_bf16 v[124:127], v[220:223], a[44:47], v[124:127]
    buffer_load_dwordx4 v224, s[12:15], s45 offen lds
    v_mfma_f32_16x16x32_bf16 v[128:131], v[208:211], a[48:51], v[128:131]
    ds_read_b128 a[8:11], v232 offset:8192
    v_mfma_f32_16x16x32_bf16 v[132:135], v[212:215], a[48:51], v[132:135]
    buffer_load_dwordx4 v225, s[12:15], s45 offen offset:1024 lds
    v_mfma_f32_16x16x32_bf16 v[136:139], v[216:219], a[48:51], v[136:139]
    v_mfma_f32_16x16x32_bf16 v[140:143], v[220:223], a[48:51], v[140:143]
    buffer_load_dwordx4 v226, s[12:15], s45 offen offset:2048 lds
    v_mfma_f32_16x16x32_bf16 v[144:147], v[208:211], a[52:55], v[144:147]
    ds_read_b128 a[12:15], v233 offset:0
    v_mfma_f32_16x16x32_bf16 v[148:151], v[212:215], a[52:55], v[148:151]
    buffer_load_dwordx4 v227, s[12:15], s45 offen offset:3072 lds
    v_mfma_f32_16x16x32_bf16 v[152:155], v[216:219], a[52:55], v[152:155]
    v_mfma_f32_16x16x32_bf16 v[156:159], v[220:223], a[52:55], v[156:159]
    s_waitcnt lgkmcnt(5)
    v_mfma_f32_16x16x32_bf16 v[0:3], v[192:195], a[56:59], v[0:3]
    s_add_u32 m0, s87, 143360
    ds_read_b128 a[16:19], v233 offset:2048
    v_mfma_f32_16x16x32_bf16 v[4:7], v[196:199], a[56:59], v[4:7]
    buffer_load_dwordx4 v228, s[12:15], s45 offen lds
    v_mfma_f32_16x16x32_bf16 v[8:11], v[200:203], a[56:59], v[8:11]
    v_mfma_f32_16x16x32_bf16 v[12:15], v[204:207], a[56:59], v[12:15]
    s_waitcnt lgkmcnt(5)
    v_mfma_f32_16x16x32_bf16 v[16:19], v[192:195], a[60:63], v[16:19]
    s_add_u32 s46, s43, 3
    ds_read_b128 a[20:23], v233 offset:4096
    v_mfma_f32_16x16x32_bf16 v[20:23], v[196:199], a[60:63], v[20:23]
    s_cmp_ge_u32 s46, 9
    s_cselect_b32 s39, 9, 0
    v_mfma_f32_16x16x32_bf16 v[24:27], v[200:203], a[60:63], v[24:27]
    s_sub_u32 s46, s46, s39
    v_mfma_f32_16x16x32_bf16 v[28:31], v[204:207], a[60:63], v[28:31]
    s_waitcnt lgkmcnt(5)
    v_mfma_f32_16x16x32_bf16 v[32:35], v[192:195], a[0:3], v[32:35]
    s_lshl_b32 s46, s46, 19
    ds_read_b128 a[24:27], v233 offset:6144
    v_mfma_f32_16x16x32_bf16 v[36:39], v[196:199], a[0:3], v[36:39]
    s_add_u32 s46, s46, s89
    v_mfma_f32_16x16x32_bf16 v[40:43], v[200:203], a[0:3], v[40:43]
    s_add_u32 m0, s88, 65536
    v_mfma_f32_16x16x32_bf16 v[44:47], v[204:207], a[0:3], v[44:47]
    s_waitcnt lgkmcnt(5)
    buffer_load_dwordx4 v229, s[16:19], s46 offen lds
    v_mfma_f32_16x16x32_bf16 v[48:51], v[192:195], a[4:7], v[48:51]
    ds_read_b128 a[28:31], v233 offset:8192
    v_mfma_f32_16x16x32_bf16 v[52:55], v[196:199], a[4:7], v[52:55]
    buffer_load_dwordx4 v230, s[16:19], s46 offen offset:1024 lds
    v_mfma_f32_16x16x32_bf16 v[56:59], v[200:203], a[4:7], v[56:59]
    v_mfma_f32_16x16x32_bf16 v[60:63], v[204:207], a[4:7], v[60:63]
    s_waitcnt lgkmcnt(5)
    v_mfma_f32_16x16x32_bf16 v[64:67], v[192:195], a[8:11], v[64:67]
    s_add_u32 m0, s52, 0
    v_mfma_f32_16x16x32_bf16 v[68:71], v[196:199], a[8:11], v[68:71]
    buffer_load_dwordx4 v165, s[4:7], s29 offen offset:1024 nt lds
    v_mfma_f32_16x16x32_bf16 v[72:75], v[200:203], a[8:11], v[72:75]
    v_mfma_f32_16x16x32_bf16 v[76:79], v[204:207], a[8:11], v[76:79]
    s_waitcnt lgkmcnt(4)
    v_mfma_f32_16x16x32_bf16 v[0:3], v[208:211], a[12:15], v[0:3]
    v_mfma_f32_16x16x32_bf16 v[4:7], v[212:215], a[12:15], v[4:7]
    v_mfma_f32_16x16x32_bf16 v[8:11], v[216:219], a[12:15], v[8:11]
    s_waitcnt vmcnt(8)
    s_waitcnt lgkmcnt(0)
    s_barrier
    ds_read_b128 a[32:35], v232 offset:20480
    ds_read_b64_tr_b16 v[192:193], v236 offset:0
    ds_read_b64_tr_b16 v[194:195], v236 offset:1024
    v_mfma_f32_16x16x32_bf16 v[12:15], v[220:223], a[12:15], v[12:15]
    ds_read_b128 a[36:39], v232 offset:22528
    ds_read_b64_tr_b16 v[196:197], v236 offset:8
    ds_read_b64_tr_b16 v[198:199], v236 offset:1032
    v_mfma_f32_16x16x32_bf16 v[16:19], v[208:211], a[16:19], v[16:19]
    s_add_u32 s45, s43, 3
    ds_read_b128 a[40:43], v232 offset:24576
    ds_read_b64_tr_b16 v[200:201], v237 offset:0
    ds_read_b64_tr_b16 v[202:203], v237 offset:1024
    v_mfma_f32_16x16x32_bf16 v[20:23], v[212:215], a[16:19], v[20:23]
    s_cmp_ge_u32 s45, 9
    s_cselect_b32 s39, 9, 0
    ds_read_b64_tr_b16 v[204:205], v237 offset:8
    ds_read_b64_tr_b16 v[206:207], v237 offset:1032
    v_mfma_f32_16x16x32_bf16 v[24:27], v[216:219], a[16:19], v[24:27]
    s_sub_u32 s45, s45, s39
    v_mfma_f32_16x16x32_bf16 v[28:31], v[220:223], a[16:19], v[28:31]
    s_lshl_b32 s45, s45, 7
    v_mfma_f32_16x16x32_bf16 v[32:35], v[208:211], a[20:23], v[32:35]
    s_add_u32 s45, s45, s44
    ds_read_b128 a[44:47], v232 offset:26624
    v_mfma_f32_16x16x32_bf16 v[36:39], v[212:215], a[20:23], v[36:39]
    s_add_u32 m0, s87, 98304
    s_nop 0
    buffer_load_dwordx4 v224, s[12:15], s45 offen lds
    v_mfma_f32_16x16x32_bf16 v[40:43], v[216:219], a[20:23], v[40:43]
    v_mfma_f32_16x16x32_bf16 v[44:47], v[220:223], a[20:23], v[44:47]
    buffer_load_dwordx4 v225, s[12:15], s45 offen offset:1024 lds
    v_mfma_f32_16x16x32_bf16 v[48:51], v[208:211], a[24:27], v[48:51]
    ds_read_b128 a[48:51], v232 offset:28672
    v_mfma_f32_16x16x32_bf16 v[52:55], v[212:215], a[24:27], v[52:55]
    buffer_load_dwordx4 v226, s[12:15], s45 offen offset:2048 lds
    v_mfma_f32_16x16x32_bf16 v[56:59], v[216:219], a[24:27], v[56:59]
    v_mfma_f32_16x16x32_bf16 v[60:63], v[220:223], a[24:27], v[60:63]
    buffer_load_dwordx4 v227, s[12:15], s45 offen offset:3072 lds
    v_mfma_f32_16x16x32_bf16 v[64:67], v[208:211], a[28:31], v[64:67]
    ds_read_b128 a[52:55], v233 offset:20480
    ds_read_b64_tr_b16 v[208:209], v238 offset:0
    ds_read_b64_tr_b16 v[210:211], v238 offset:1024
    v_mfma_f32_16x16x32_bf16 v[68:71], v[212:215], a[28:31], v[68:71]
    s_add_u32 m0, s87, 102400
    s_nop 0
    buffer_load_dwordx4 v228, s[12:15], s45 offen lds
    ds_read_b64_tr_b16 v[212:213], v238 offset:8
    ds_read_b64_tr_b16 v[214:215], v238 offset:1032
    v_mfma_f32_16x16x32_bf16 v[72:75], v[216:219], a[28:31], v[72:75]
    ds_read_b64_tr_b16 v[216:217], v239 offset:0
    ds_read_b64_tr_b16 v[218:219], v239 offset:1024
    v_mfma_f32_16x16x32_bf16 v[76:79], v[220:223], a[28:31], v[76:79]
    s_waitcnt lgkmcnt(15)
    ds_read_b64_tr_b16 v[220:221], v239 offset:8
    ds_read_b64_tr_b16 v[222:223], v239 offset:1032
    v_mfma_f32_16x16x32_bf16 v[80:83], v[192:195], a[32:35], v[80:83]
    s_waitcnt lgkmcnt(15)
    ds_read_b128 a[56:59], v233 offset:22528
    v_mfma_f32_16x16x32_bf16 v[84:87], v[196:199], a[32:35], v[84:87]
    s_waitcnt lgkmcnt(14)
    v_mfma_f32_16x16x32_bf16 v[88:91], v[200:203], a[32:35], v[88:91]
    s_waitcnt lgkmcnt(12)
    v_mfma_f32_16x16x32_bf16 v[92:95], v[204:207], a[32:35], v[92:95]
    s_add_u32 s46, s43, 3
    v_mfma_f32_16x16x32_bf16 v[96:99], v[192:195], a[36:39], v[96:99]
    s_cmp_ge_u32 s46, 9
    s_cselect_b32 s39, 9, 0
    ds_read_b128 a[60:63], v233 offset:24576
    v_mfma_f32_16x16x32_bf16 v[100:103], v[196:199], a[36:39], v[100:103]
    s_sub_u32 s46, s46, s39
    v_mfma_f32_16x16x32_bf16 v[104:107], v[200:203], a[36:39], v[104:107]
    s_lshl_b32 s46, s46, 19
    v_mfma_f32_16x16x32_bf16 v[108:111], v[204:207], a[36:39], v[108:111]
    s_add_u32 s46, s46, s89
    v_mfma_f32_16x16x32_bf16 v[112:115], v[192:195], a[40:43], v[112:115]
    s_add_u32 s46, s46, 262144
    ds_read_b128 a[0:3], v233 offset:26624
    v_mfma_f32_16x16x32_bf16 v[116:119], v[196:199], a[40:43], v[116:119]
    s_add_u32 m0, s88, 90112
    s_nop 0
    buffer_load_dwordx4 v229, s[16:19], s46 offen lds
    v_mfma_f32_16x16x32_bf16 v[120:123], v[200:203], a[40:43], v[120:123]
    v_mfma_f32_16x16x32_bf16 v[124:127], v[204:207], a[40:43], v[124:127]
    s_waitcnt lgkmcnt(13)
    buffer_load_dwordx4 v230, s[16:19], s46 offen offset:1024 lds
    v_mfma_f32_16x16x32_bf16 v[128:131], v[192:195], a[44:47], v[128:131]
    ds_read_b128 a[4:7], v233 offset:28672
    v_mfma_f32_16x16x32_bf16 v[132:135], v[196:199], a[44:47], v[132:135]
    v_mfma_f32_16x16x32_bf16 v[136:139], v[200:203], a[44:47], v[136:139]
    v_mfma_f32_16x16x32_bf16 v[140:143], v[204:207], a[44:47], v[140:143]
    s_waitcnt lgkmcnt(13)
    v_mfma_f32_16x16x32_bf16 v[144:147], v[192:195], a[48:51], v[144:147]
    v_mfma_f32_16x16x32_bf16 v[148:151], v[196:199], a[48:51], v[148:151]
    v_mfma_f32_16x16x32_bf16 v[152:155], v[200:203], a[48:51], v[152:155]
    v_mfma_f32_16x16x32_bf16 v[156:159], v[204:207], a[48:51], v[156:159]
    s_waitcnt lgkmcnt(10)
    v_mfma_f32_16x16x32_bf16 v[80:83], v[208:211], a[52:55], v[80:83]
    s_waitcnt lgkmcnt(8)
    v_mfma_f32_16x16x32_bf16 v[84:87], v[212:215], a[52:55], v[84:87]
    s_waitcnt lgkmcnt(6)
    v_mfma_f32_16x16x32_bf16 v[88:91], v[216:219], a[52:55], v[88:91]
    s_waitcnt vmcnt(10)
    s_waitcnt lgkmcnt(0)
    s_barrier
    ds_read_b128 a[8:11], v232 offset:40960
    v_mfma_f32_16x16x32_bf16 v[92:95], v[220:223], a[52:55], v[92:95]
    ds_read_b128 a[12:15], v232 offset:43008
    v_mfma_f32_16x16x32_bf16 v[96:99], v[208:211], a[56:59], v[96:99]
    s_add_u32 s45, s43, 3
    ds_read_b128 a[16:19], v232 offset:45056
    v_mfma_f32_16x16x32_bf16 v[100:103], v[212:215], a[56:59], v[100:103]
    s_cmp_ge_u32 s45, 9
    s_cselect_b32 s39, 9, 0
    v_mfma_f32_16x16x32_bf16 v[104:107], v[216:219], a[56:59], v[104:107]
    s_sub_u32 s45, s45, s39
    v_mfma_f32_16x16x32_bf16 v[108:111], v[220:223], a[56:59], v[108:111]
    s_lshl_b32 s45, s45, 7
    v_mfma_f32_16x16x32_bf16 v[112:115], v[208:211], a[60:63], v[112:115]
    s_add_u32 s45, s45, s44
    ds_read_b128 a[20:23], v232 offset:47104
    v_mfma_f32_16x16x32_bf16 v[116:119], v[212:215], a[60:63], v[116:119]
    s_add_u32 s45, s45, 737280
    v_mfma_f32_16x16x32_bf16 v[120:123], v[216:219], a[60:63], v[120:123]
    s_add_u32 m0, s87, 118784
    v_mfma_f32_16x16x32_bf16 v[124:127], v[220:223], a[60:63], v[124:127]
    buffer_load_dwordx4 v224, s[12:15], s45 offen lds
    v_mfma_f32_16x16x32_bf16 v[128:131], v[208:211], a[0:3], v[128:131]
    ds_read_b128 a[24:27], v232 offset:49152
    v_mfma_f32_16x16x32_bf16 v[132:135], v[212:215], a[0:3], v[132:135]
    buffer_load_dwordx4 v225, s[12:15], s45 offen offset:1024 lds
    v_mfma_f32_16x16x32_bf16 v[136:139], v[216:219], a[0:3], v[136:139]
    v_mfma_f32_16x16x32_bf16 v[140:143], v[220:223], a[0:3], v[140:143]
    buffer_load_dwordx4 v226, s[12:15], s45 offen offset:2048 lds
    v_mfma_f32_16x16x32_bf16 v[144:147], v[208:211], a[4:7], v[144:147]
    ds_read_b128 a[28:31], v233 offset:40960
    v_mfma_f32_16x16x32_bf16 v[148:151], v[212:215], a[4:7], v[148:151]
    buffer_load_dwordx4 v227, s[12:15], s45 offen offset:3072 lds
    v_mfma_f32_16x16x32_bf16 v[152:155], v[216:219], a[4:7], v[152:155]
    v_mfma_f32_16x16x32_bf16 v[156:159], v[220:223], a[4:7], v[156:159]
    s_waitcnt lgkmcnt(5)
    v_mfma_f32_16x16x32_bf16 v[0:3], v[192:195], a[8:11], v[0:3]
    s_add_u32 m0, s87, 122880
    ds_read_b128 a[32:35], v233 offset:43008
    v_mfma_f32_16x16x32_bf16 v[4:7], v[196:199], a[8:11], v[4:7]
    buffer_load_dwordx4 v228, s[12:15], s45 offen lds
    v_mfma_f32_16x16x32_bf16 v[8:11], v[200:203], a[8:11], v[8:11]
    v_mfma_f32_16x16x32_bf16 v[12:15], v[204:207], a[8:11], v[12:15]
    s_waitcnt lgkmcnt(5)
    v_mfma_f32_16x16x32_bf16 v[16:19], v[192:195], a[12:15], v[16:19]
    s_add_u32 s46, s43, 4
    ds_read_b128 a[36:39], v233 offset:45056
    v_mfma_f32_16x16x32_bf16 v[20:23], v[196:199], a[12:15], v[20:23]
    s_cmp_ge_u32 s46, 9
    s_cselect_b32 s39, 9, 0
    v_mfma_f32_16x16x32_bf16 v[24:27], v[200:203], a[12:15], v[24:27]
    s_sub_u32 s46, s46, s39
    v_mfma_f32_16x16x32_bf16 v[28:31], v[204:207], a[12:15], v[28:31]
    s_waitcnt lgkmcnt(5)
    v_mfma_f32_16x16x32_bf16 v[32:35], v[192:195], a[16:19], v[32:35]
    s_lshl_b32 s46, s46, 19
    ds_read_b128 a[40:43], v233 offset:47104
    v_mfma_f32_16x16x32_bf16 v[36:39], v[196:199], a[16:19], v[36:39]
    s_add_u32 s46, s46, s89
    v_mfma_f32_16x16x32_bf16 v[40:43], v[200:203], a[16:19], v[40:43]
    s_add_u32 m0, s88, 16384
    v_mfma_f32_16x16x32_bf16 v[44:47], v[204:207], a[16:19], v[44:47]
    s_waitcnt lgkmcnt(5)
    buffer_load_dwordx4 v229, s[16:19], s46 offen lds
    v_mfma_f32_16x16x32_bf16 v[48:51], v[192:195], a[20:23], v[48:51]
    ds_read_b128 a[44:47], v233 offset:49152
    v_mfma_f32_16x16x32_bf16 v[52:55], v[196:199], a[20:23], v[52:55]
    buffer_load_dwordx4 v230, s[16:19], s46 offen offset:1024 lds
    v_mfma_f32_16x16x32_bf16 v[56:59], v[200:203], a[20:23], v[56:59]
    v_mfma_f32_16x16x32_bf16 v[60:63], v[204:207], a[20:23], v[60:63]
    s_waitcnt lgkmcnt(5)
    v_mfma_f32_16x16x32_bf16 v[64:67], v[192:195], a[24:27], v[64:67]
    s_add_u32 m0, s52, 0
    v_mfma_f32_16x16x32_bf16 v[68:71], v[196:199], a[24:27], v[68:71]
    buffer_load_dwordx4 v166, s[4:7], s29 offen offset:2048 nt lds
    v_mfma_f32_16x16x32_bf16 v[72:75], v[200:203], a[24:27], v[72:75]
    v_mfma_f32_16x16x32_bf16 v[76:79], v[204:207], a[24:27], v[76:79]
    s_waitcnt lgkmcnt(4)
    v_mfma_f32_16x16x32_bf16 v[0:3], v[208:211], a[28:31], v[0:3]
    v_mfma_f32_16x16x32_bf16 v[4:7], v[212:215], a[28:31], v[4:7]
    v_mfma_f32_16x16x32_bf16 v[8:11], v[216:219], a[28:31], v[8:11]
    s_waitcnt vmcnt(8)
    s_waitcnt lgkmcnt(0)
    s_barrier
    ds_read_b128 a[48:51], v232 offset:0
    ds_read_b64_tr_b16 v[192:193], v240 offset:0
    ds_read_b64_tr_b16 v[194:195], v240 offset:1024
    v_mfma_f32_16x16x32_bf16 v[12:15], v[220:223], a[28:31], v[12:15]
    ds_read_b128 a[52:55], v232 offset:2048
    ds_read_b64_tr_b16 v[196:197], v240 offset:8
    ds_read_b64_tr_b16 v[198:199], v240 offset:1032
    v_mfma_f32_16x16x32_bf16 v[16:19], v[208:211], a[32:35], v[16:19]
    s_add_u32 s45, s43, 4
    ds_read_b128 a[56:59], v232 offset:4096
    ds_read_b64_tr_b16 v[200:201], v241 offset:0
    ds_read_b64_tr_b16 v[202:203], v241 offset:1024
    v_mfma_f32_16x16x32_bf16 v[20:23], v[212:215], a[32:35], v[20:23]
    s_cmp_ge_u32 s45, 9
    s_cselect_b32 s39, 9, 0
    ds_read_b64_tr_b16 v[204:205], v241 offset:8
    ds_read_b64_tr_b16 v[206:207], v241 offset:1032
    v_mfma_f32_16x16x32_bf16 v[24:27], v[216:219], a[32:35], v[24:27]
    s_sub_u32 s45, s45, s39
    v_mfma_f32_16x16x32_bf16 v[28:31], v[220:223], a[32:35], v[28:31]
    s_lshl_b32 s45, s45, 7
    v_mfma_f32_16x16x32_bf16 v[32:35], v[208:211], a[36:39], v[32:35]
    s_add_u32 s45, s45, s44
    ds_read_b128 a[60:63], v232 offset:6144
    v_mfma_f32_16x16x32_bf16 v[36:39], v[212:215], a[36:39], v[36:39]
    s_add_u32 m0, s87, 139264
    s_nop 0
    buffer_load_dwordx4 v224, s[12:15], s45 offen lds
    v_mfma_f32_16x16x32_bf16 v[40:43], v[216:219], a[36:39], v[40:43]
    v_mfma_f32_16x16x32_bf16 v[44:47], v[220:223], a[36:39], v[44:47]
    buffer_load_dwordx4 v225, s[12:15], s45 offen offset:1024 lds
    v_mfma_f32_16x16x32_bf16 v[48:51], v[208:211], a[40:43], v[48:51]
    ds_read_b128 a[0:3], v232 offset:8192
    v_mfma_f32_16x16x32_bf16 v[52:55], v[212:215], a[40:43], v[52:55]
    buffer_load_dwordx4 v226, s[12:15], s45 offen offset:2048 lds
    v_mfma_f32_16x16x32_bf16 v[56:59], v[216:219], a[40:43], v[56:59]
    v_mfma_f32_16x16x32_bf16 v[60:63], v[220:223], a[40:43], v[60:63]
    buffer_load_dwordx4 v227, s[12:15], s45 offen offset:3072 lds
    v_mfma_f32_16x16x32_bf16 v[64:67], v[208:211], a[44:47], v[64:67]
    ds_read_b128 a[4:7], v233 offset:0
    ds_read_b64_tr_b16 v[208:209], v242 offset:0
    ds_read_b64_tr_b16 v[210:211], v242 offset:1024
    v_mfma_f32_16x16x32_bf16 v[68:71], v[212:215], a[44:47], v[68:71]
    s_add_u32 m0, s87, 143360
    s_nop 0
    buffer_load_dwordx4 v228, s[12:15], s45 offen lds
    ds_read_b64_tr_b16 v[212:213], v242 offset:8
    ds_read_b64_tr_b16 v[214:215], v242 offset:1032
    v_mfma_f32_16x16x32_bf16 v[72:75], v[216:219], a[44:47], v[72:75]
    ds_read_b64_tr_b16 v[216:217], v243 offset:0
    ds_read_b64_tr_b16 v[218:219], v243 offset:1024
    v_mfma_f32_16x16x32_bf16 v[76:79], v[220:223], a[44:47], v[76:79]
    s_waitcnt lgkmcnt(15)
    ds_read_b64_tr_b16 v[220:221], v243 offset:8
    ds_read_b64_tr_b16 v[222:223], v243 offset:1032
    v_mfma_f32_16x16x32_bf16 v[80:83], v[192:195], a[48:51], v[80:83]
    s_waitcnt lgkmcnt(15)
    ds_read_b128 a[8:11], v233 offset:2048
    v_mfma_f32_16x16x32_bf16 v[84:87], v[196:199], a[48:51], v[84:87]
    s_waitcnt lgkmcnt(14)
    v_mfma_f32_16x16x32_bf16 v[88:91], v[200:203], a[48:51], v[88:91]
    s_waitcnt lgkmcnt(12)
    v_mfma_f32_16x16x32_bf16 v[92:95], v[204:207], a[48:51], v[92:95]
    s_add_u32 s46, s43, 4
    v_mfma_f32_16x16x32_bf16 v[96:99], v[192:195], a[52:55], v[96:99]
    s_cmp_ge_u32 s46, 9
    s_cselect_b32 s39, 9, 0
    ds_read_b128 a[12:15], v233 offset:4096
    v_mfma_f32_16x16x32_bf16 v[100:103], v[196:199], a[52:55], v[100:103]
    s_sub_u32 s46, s46, s39
    v_mfma_f32_16x16x32_bf16 v[104:107], v[200:203], a[52:55], v[104:107]
    s_lshl_b32 s46, s46, 19
    v_mfma_f32_16x16x32_bf16 v[108:111], v[204:207], a[52:55], v[108:111]
    s_add_u32 s46, s46, s89
    v_mfma_f32_16x16x32_bf16 v[112:115], v[192:195], a[56:59], v[112:115]
    s_add_u32 s46, s46, 262144
    ds_read_b128 a[16:19], v233 offset:6144
    v_mfma_f32_16x16x32_bf16 v[116:119], v[196:199], a[56:59], v[116:119]
    s_add_u32 m0, s88, 40960
    s_nop 0
    buffer_load_dwordx4 v229, s[16:19], s46 offen lds
    v_mfma_f32_16x16x32_bf16 v[120:123], v[200:203], a[56:59], v[120:123]
    v_mfma_f32_16x16x32_bf16 v[124:127], v[204:207], a[56:59], v[124:127]
    s_waitcnt lgkmcnt(13)
    buffer_load_dwordx4 v230, s[16:19], s46 offen offset:1024 lds
    v_mfma_f32_16x16x32_bf16 v[128:131], v[192:195], a[60:63], v[128:131]
    ds_read_b128 a[20:23], v233 offset:8192
    v_mfma_f32_16x16x32_bf16 v[132:135], v[196:199], a[60:63], v[132:135]
    v_mfma_f32_16x16x32_bf16 v[136:139], v[200:203], a[60:63], v[136:139]
    v_mfma_f32_16x16x32_bf16 v[140:143], v[204:207], a[60:63], v[140:143]
    s_waitcnt lgkmcnt(13)
    v_mfma_f32_16x16x32_bf16 v[144:147], v[192:195], a[0:3], v[144:147]
    v_mfma_f32_16x16x32_bf16 v[148:151], v[196:199], a[0:3], v[148:151]
    v_mfma_f32_16x16x32_bf16 v[152:155], v[200:203], a[0:3], v[152:155]
    v_mfma_f32_16x16x32_bf16 v[156:159], v[204:207], a[0:3], v[156:159]
    s_waitcnt lgkmcnt(10)
    v_mfma_f32_16x16x32_bf16 v[80:83], v[208:211], a[4:7], v[80:83]
    s_waitcnt lgkmcnt(8)
    v_mfma_f32_16x16x32_bf16 v[84:87], v[212:215], a[4:7], v[84:87]
    s_waitcnt lgkmcnt(6)
    v_mfma_f32_16x16x32_bf16 v[88:91], v[216:219], a[4:7], v[88:91]
    s_waitcnt vmcnt(10)
    s_waitcnt lgkmcnt(0)
    s_barrier
    ds_read_b128 a[24:27], v232 offset:20480
    v_mfma_f32_16x16x32_bf16 v[92:95], v[220:223], a[4:7], v[92:95]
    ds_read_b128 a[28:31], v232 offset:22528
    v_mfma_f32_16x16x32_bf16 v[96:99], v[208:211], a[8:11], v[96:99]
    s_add_u32 s45, s43, 4
    ds_read_b128 a[32:35], v232 offset:24576
    v_mfma_f32_16x16x32_bf16 v[100:103], v[212:215], a[8:11], v[100:103]
    s_cmp_ge_u32 s45, 9
    s_cselect_b32 s39, 9, 0
    v_mfma_f32_16x16x32_bf16 v[104:107], v[216:219], a[8:11], v[104:107]
    s_sub_u32 s45, s45, s39
    v_mfma_f32_16x16x32_bf16 v[108:111], v[220:223], a[8:11], v[108:111]
    s_lshl_b32 s45, s45, 7
    v_mfma_f32_16x16x32_bf16 v[112:115], v[208:211], a[12:15], v[112:115]
    s_add_u32 s45, s45, s44
    ds_read_b128 a[36:39], v232 offset:26624
    v_mfma_f32_16x16x32_bf16 v[116:119], v[212:215], a[12:15], v[116:119]
    s_add_u32 s45, s45, 737280
    v_mfma_f32_16x16x32_bf16 v[120:123], v[216:219], a[12:15], v[120:123]
    s_add_u32 m0, s87, 98304
    v_mfma_f32_16x16x32_bf16 v[124:127], v[220:223], a[12:15], v[124:127]
    buffer_load_dwordx4 v224, s[12:15], s45 offen lds
    v_mfma_f32_16x16x32_bf16 v[128:131], v[208:211], a[16:19], v[128:131]
    ds_read_b128 a[40:43], v232 offset:28672
    v_mfma_f32_16x16x32_bf16 v[132:135], v[212:215], a[16:19], v[132:135]
    buffer_load_dwordx4 v225, s[12:15], s45 offen offset:1024 lds
    v_mfma_f32_16x16x32_bf16 v[136:139], v[216:219], a[16:19], v[136:139]
    v_mfma_f32_16x16x32_bf16 v[140:143], v[220:223], a[16:19], v[140:143]
    buffer_load_dwordx4 v226, s[12:15], s45 offen offset:2048 lds
    v_mfma_f32_16x16x32_bf16 v[144:147], v[208:211], a[20:23], v[144:147]
    ds_read_b128 a[44:47], v233 offset:20480
    v_mfma_f32_16x16x32_bf16 v[148:151], v[212:215], a[20:23], v[148:151]
    buffer_load_dwordx4 v227, s[12:15], s45 offen offset:3072 lds
    v_mfma_f32_16x16x32_bf16 v[152:155], v[216:219], a[20:23], v[152:155]
    v_mfma_f32_16x16x32_bf16 v[156:159], v[220:223], a[20:23], v[156:159]
    s_waitcnt lgkmcnt(5)
    v_mfma_f32_16x16x32_bf16 v[0:3], v[192:195], a[24:27], v[0:3]
    s_add_u32 m0, s87, 102400
    ds_read_b128 a[48:51], v233 offset:22528
    v_mfma_f32_16x16x32_bf16 v[4:7], v[196:199], a[24:27], v[4:7]
    buffer_load_dwordx4 v228, s[12:15], s45 offen lds
    v_mfma_f32_16x16x32_bf16 v[8:11], v[200:203], a[24:27], v[8:11]
    v_mfma_f32_16x16x32_bf16 v[12:15], v[204:207], a[24:27], v[12:15]
    s_waitcnt lgkmcnt(5)
    v_mfma_f32_16x16x32_bf16 v[16:19], v[192:195], a[28:31], v[16:19]
    s_add_u32 s46, s43, 5
    ds_read_b128 a[52:55], v233 offset:24576
    v_mfma_f32_16x16x32_bf16 v[20:23], v[196:199], a[28:31], v[20:23]
    s_cmp_ge_u32 s46, 9
    s_cselect_b32 s39, 9, 0
    v_mfma_f32_16x16x32_bf16 v[24:27], v[200:203], a[28:31], v[24:27]
    s_sub_u32 s46, s46, s39
    v_mfma_f32_16x16x32_bf16 v[28:31], v[204:207], a[28:31], v[28:31]
    s_waitcnt lgkmcnt(5)
    v_mfma_f32_16x16x32_bf16 v[32:35], v[192:195], a[32:35], v[32:35]
    s_lshl_b32 s46, s46, 19
    ds_read_b128 a[56:59], v233 offset:26624
    v_mfma_f32_16x16x32_bf16 v[36:39], v[196:199], a[32:35], v[36:39]
    s_add_u32 s46, s46, s89
    v_mfma_f32_16x16x32_bf16 v[40:43], v[200:203], a[32:35], v[40:43]
    s_add_u32 m0, s88, 65536
    v_mfma_f32_16x16x32_bf16 v[44:47], v[204:207], a[32:35], v[44:47]
    s_waitcnt lgkmcnt(5)
    buffer_load_dwordx4 v229, s[16:19], s46 offen lds
    v_mfma_f32_16x16x32_bf16 v[48:51], v[192:195], a[36:39], v[48:51]
    ds_read_b128 a[60:63], v233 offset:28672
    v_mfma_f32_16x16x32_bf16 v[52:55], v[196:199], a[36:39], v[52:55]
    buffer_load_dwordx4 v230, s[16:19], s46 offen offset:1024 lds
    v_mfma_f32_16x16x32_bf16 v[56:59], v[200:203], a[36:39], v[56:59]
    v_mfma_f32_16x16x32_bf16 v[60:63], v[204:207], a[36:39], v[60:63]
    s_waitcnt lgkmcnt(5)
    v_mfma_f32_16x16x32_bf16 v[64:67], v[192:195], a[40:43], v[64:67]
    s_add_u32 m0, s52, 0
    v_mfma_f32_16x16x32_bf16 v[68:71], v[196:199], a[40:43], v[68:71]
    buffer_load_dwordx4 v167, s[4:7], s29 offen offset:3072 nt lds
    v_mfma_f32_16x16x32_bf16 v[72:75], v[200:203], a[40:43], v[72:75]
    v_mfma_f32_16x16x32_bf16 v[76:79], v[204:207], a[40:43], v[76:79]
    s_waitcnt lgkmcnt(4)
    v_mfma_f32_16x16x32_bf16 v[0:3], v[208:211], a[44:47], v[0:3]
    v_mfma_f32_16x16x32_bf16 v[4:7], v[212:215], a[44:47], v[4:7]
    v_mfma_f32_16x16x32_bf16 v[8:11], v[216:219], a[44:47], v[8:11]
    s_waitcnt vmcnt(8)
    s_waitcnt lgkmcnt(0)
    s_barrier
    ds_read_b128 a[0:3], v232 offset:40960
    ds_read_b64_tr_b16 v[192:193], v236 offset:0
    ds_read_b64_tr_b16 v[194:195], v236 offset:1024
    v_mfma_f32_16x16x32_bf16 v[12:15], v[220:223], a[44:47], v[12:15]
    ds_read_b128 a[4:7], v232 offset:43008
    ds_read_b64_tr_b16 v[196:197], v236 offset:8
    ds_read_b64_tr_b16 v[198:199], v236 offset:1032
    v_mfma_f32_16x16x32_bf16 v[16:19], v[208:211], a[48:51], v[16:19]
    s_add_u32 s45, s43, 5
    ds_read_b128 a[8:11], v232 offset:45056
    ds_read_b64_tr_b16 v[200:201], v237 offset:0
    ds_read_b64_tr_b16 v[202:203], v237 offset:1024
    v_mfma_f32_16x16x32_bf16 v[20:23], v[212:215], a[48:51], v[20:23]
    s_cmp_ge_u32 s45, 9
    s_cselect_b32 s39, 9, 0
    ds_read_b64_tr_b16 v[204:205], v237 offset:8
    ds_read_b64_tr_b16 v[206:207], v237 offset:1032
    v_mfma_f32_16x16x32_bf16 v[24:27], v[216:219], a[48:51], v[24:27]
    s_sub_u32 s45, s45, s39
    v_mfma_f32_16x16x32_bf16 v[28:31], v[220:223], a[48:51], v[28:31]
    s_lshl_b32 s45, s45, 7
    v_mfma_f32_16x16x32_bf16 v[32:35], v[208:211], a[52:55], v[32:35]
    s_add_u32 s45, s45, s44
    ds_read_b128 a[12:15], v232 offset:47104
    v_mfma_f32_16x16x32_bf16 v[36:39], v[212:215], a[52:55], v[36:39]
    s_add_u32 m0, s87, 118784
    s_nop 0
    buffer_load_dwordx4 v224, s[12:15], s45 offen lds
    v_mfma_f32_16x16x32_bf16 v[40:43], v[216:219], a[52:55], v[40:43]
    v_mfma_f32_16x16x32_bf16 v[44:47], v[220:223], a[52:55], v[44:47]
    buffer_load_dwordx4 v225, s[12:15], s45 offen offset:1024 lds
    v_mfma_f32_16x16x32_bf16 v[48:51], v[208:211], a[56:59], v[48:51]
    ds_read_b128 a[16:19], v232 offset:49152
    v_mfma_f32_16x16x32_bf16 v[52:55], v[212:215], a[56:59], v[52:55]
    buffer_load_dwordx4 v226, s[12:15], s45 offen offset:2048 lds
    v_mfma_f32_16x16x32_bf16 v[56:59], v[216:219], a[56:59], v[56:59]
    v_mfma_f32_16x16x32_bf16 v[60:63], v[220:223], a[56:59], v[60:63]
    buffer_load_dwordx4 v227, s[12:15], s45 offen offset:3072 lds
    v_mfma_f32_16x16x32_bf16 v[64:67], v[208:211], a[60:63], v[64:67]
    ds_read_b128 a[20:23], v233 offset:40960
    ds_read_b64_tr_b16 v[208:209], v238 offset:0
    ds_read_b64_tr_b16 v[210:211], v238 offset:1024
    v_mfma_f32_16x16x32_bf16 v[68:71], v[212:215], a[60:63], v[68:71]
    s_add_u32 m0, s87, 122880
    s_nop 0
    buffer_load_dwordx4 v228, s[12:15], s45 offen lds
    ds_read_b64_tr_b16 v[212:213], v238 offset:8
    ds_read_b64_tr_b16 v[214:215], v238 offset:1032
    v_mfma_f32_16x16x32_bf16 v[72:75], v[216:219], a[60:63], v[72:75]
    ds_read_b64_tr_b16 v[216:217], v239 offset:0
    ds_read_b64_tr_b16 v[218:219], v239 offset:1024
    v_mfma_f32_16x16x32_bf16 v[76:79], v[220:223], a[60:63], v[76:79]
    s_waitcnt lgkmcnt(15)
    ds_read_b64_tr_b16 v[220:221], v239 offset:8
    ds_read_b64_tr_b16 v[222:223], v239 offset:1032
    v_mfma_f32_16x16x32_bf16 v[80:83], v[192:195], a[0:3], v[80:83]
    s_waitcnt lgkmcnt(15)
    ds_read_b128 a[24:27], v233 offset:43008
    v_mfma_f32_16x16x32_bf16 v[84:87], v[196:199], a[0:3], v[84:87]
    s_waitcnt lgkmcnt(14)
    v_mfma_f32_16x16x32_bf16 v[88:91], v[200:203], a[0:3], v[88:91]
    s_waitcnt lgkmcnt(12)
    v_mfma_f32_16x16x32_bf16 v[92:95], v[204:207], a[0:3], v[92:95]
    s_add_u32 s46, s43, 5
    v_mfma_f32_16x16x32_bf16 v[96:99], v[192:195], a[4:7], v[96:99]
    s_cmp_ge_u32 s46, 9
    s_cselect_b32 s39, 9, 0
    ds_read_b128 a[28:31], v233 offset:45056
    v_mfma_f32_16x16x32_bf16 v[100:103], v[196:199], a[4:7], v[100:103]
    s_sub_u32 s46, s46, s39
    v_mfma_f32_16x16x32_bf16 v[104:107], v[200:203], a[4:7], v[104:107]
    s_lshl_b32 s46, s46, 19
    v_mfma_f32_16x16x32_bf16 v[108:111], v[204:207], a[4:7], v[108:111]
    s_add_u32 s46, s46, s89
    v_mfma_f32_16x16x32_bf16 v[112:115], v[192:195], a[8:11], v[112:115]
    s_add_u32 s46, s46, 262144
    ds_read_b128 a[32:35], v233 offset:47104
    v_mfma_f32_16x16x32_bf16 v[116:119], v[196:199], a[8:11], v[116:119]
    s_add_u32 m0, s88, 90112
    s_nop 0
    buffer_load_dwordx4 v229, s[16:19], s46 offen lds
    v_mfma_f32_16x16x32_bf16 v[120:123], v[200:203], a[8:11], v[120:123]
    v_mfma_f32_16x16x32_bf16 v[124:127], v[204:207], a[8:11], v[124:127]
    s_waitcnt lgkmcnt(13)
    buffer_load_dwordx4 v230, s[16:19], s46 offen offset:1024 lds
    v_mfma_f32_16x16x32_bf16 v[128:131], v[192:195], a[12:15], v[128:131]
    ds_read_b128 a[36:39], v233 offset:49152
    v_mfma_f32_16x16x32_bf16 v[132:135], v[196:199], a[12:15], v[132:135]
    v_mfma_f32_16x16x32_bf16 v[136:139], v[200:203], a[12:15], v[136:139]
    v_mfma_f32_16x16x32_bf16 v[140:143], v[204:207], a[12:15], v[140:143]
    s_waitcnt lgkmcnt(13)
    v_mfma_f32_16x16x32_bf16 v[144:147], v[192:195], a[16:19], v[144:147]
    v_mfma_f32_16x16x32_bf16 v[148:151], v[196:199], a[16:19], v[148:151]
    v_mfma_f32_16x16x32_bf16 v[152:155], v[200:203], a[16:19], v[152:155]
    v_mfma_f32_16x16x32_bf16 v[156:159], v[204:207], a[16:19], v[156:159]
    s_waitcnt lgkmcnt(10)
    v_mfma_f32_16x16x32_bf16 v[80:83], v[208:211], a[20:23], v[80:83]
    s_waitcnt lgkmcnt(8)
    v_mfma_f32_16x16x32_bf16 v[84:87], v[212:215], a[20:23], v[84:87]
    s_waitcnt lgkmcnt(6)
    v_mfma_f32_16x16x32_bf16 v[88:91], v[216:219], a[20:23], v[88:91]
    s_waitcnt vmcnt(10)
    s_waitcnt lgkmcnt(0)
    s_barrier
    ds_read_b128 a[40:43], v232 offset:0
    v_mfma_f32_16x16x32_bf16 v[92:95], v[220:223], a[20:23], v[92:95]
    ds_read_b128 a[44:47], v232 offset:2048
    v_mfma_f32_16x16x32_bf16 v[96:99], v[208:211], a[24:27], v[96:99]
    s_add_u32 s45, s43, 5
    ds_read_b128 a[48:51], v232 offset:4096
    v_mfma_f32_16x16x32_bf16 v[100:103], v[212:215], a[24:27], v[100:103]
    s_cmp_ge_u32 s45, 9
    s_cselect_b32 s39, 9, 0
    v_mfma_f32_16x16x32_bf16 v[104:107], v[216:219], a[24:27], v[104:107]
    s_sub_u32 s45, s45, s39
    v_mfma_f32_16x16x32_bf16 v[108:111], v[220:223], a[24:27], v[108:111]
    s_lshl_b32 s45, s45, 7
    v_mfma_f32_16x16x32_bf16 v[112:115], v[208:211], a[28:31], v[112:115]
    s_add_u32 s45, s45, s44
    ds_read_b128 a[52:55], v232 offset:6144
    v_mfma_f32_16x16x32_bf16 v[116:119], v[212:215], a[28:31], v[116:119]
    s_add_u32 s45, s45, 737280
    v_mfma_f32_16x16x32_bf16 v[120:123], v[216:219], a[28:31], v[120:123]
    s_add_u32 m0, s87, 139264
    v_mfma_f32_16x16x32_bf16 v[124:127], v[220:223], a[28:31], v[124:127]
    buffer_load_dwordx4 v224, s[12:15], s45 offen lds
    v_mfma_f32_16x16x32_bf16 v[128:131], v[208:211], a[32:35], v[128:131]
    ds_read_b128 a[56:59], v232 offset:8192
    v_mfma_f32_16x16x32_bf16 v[132:135], v[212:215], a[32:35], v[132:135]
    buffer_load_dwordx4 v225, s[12:15], s45 offen offset:1024 lds
    v_mfma_f32_16x16x32_bf16 v[136:139], v[216:219], a[32:35], v[136:139]
    v_mfma_f32_16x16x32_bf16 v[140:143], v[220:223], a[32:35], v[140:143]
    buffer_load_dwordx4 v226, s[12:15], s45 offen offset:2048 lds
    v_mfma_f32_16x16x32_bf16 v[144:147], v[208:211], a[36:39], v[144:147]
    ds_read_b128 a[60:63], v233 offset:0
    v_mfma_f32_16x16x32_bf16 v[148:151], v[212:215], a[36:39], v[148:151]
    buffer_load_dwordx4 v227, s[12:15], s45 offen offset:3072 lds
    v_mfma_f32_16x16x32_bf16 v[152:155], v[216:219], a[36:39], v[152:155]
    v_mfma_f32_16x16x32_bf16 v[156:159], v[220:223], a[36:39], v[156:159]
    s_waitcnt lgkmcnt(5)
    v_mfma_f32_16x16x32_bf16 v[0:3], v[192:195], a[40:43], v[0:3]
    s_add_u32 m0, s87, 143360
    ds_read_b128 a[0:3], v233 offset:2048
    v_mfma_f32_16x16x32_bf16 v[4:7], v[196:199], a[40:43], v[4:7]
    buffer_load_dwordx4 v228, s[12:15], s45 offen lds
    v_mfma_f32_16x16x32_bf16 v[8:11], v[200:203], a[40:43], v[8:11]
    v_mfma_f32_16x16x32_bf16 v[12:15], v[204:207], a[40:43], v[12:15]
    s_waitcnt lgkmcnt(5)
    v_mfma_f32_16x16x32_bf16 v[16:19], v[192:195], a[44:47], v[16:19]
    s_add_u32 s46, s43, 6
    ds_read_b128 a[4:7], v233 offset:4096
    v_mfma_f32_16x16x32_bf16 v[20:23], v[196:199], a[44:47], v[20:23]
    s_cmp_ge_u32 s46, 9
    s_cselect_b32 s39, 9, 0
    v_mfma_f32_16x16x32_bf16 v[24:27], v[200:203], a[44:47], v[24:27]
    s_sub_u32 s46, s46, s39
    v_mfma_f32_16x16x32_bf16 v[28:31], v[204:207], a[44:47], v[28:31]
    s_waitcnt lgkmcnt(5)
    v_mfma_f32_16x16x32_bf16 v[32:35], v[192:195], a[48:51], v[32:35]
    s_lshl_b32 s46, s46, 19
    ds_read_b128 a[8:11], v233 offset:6144
    v_mfma_f32_16x16x32_bf16 v[36:39], v[196:199], a[48:51], v[36:39]
    s_add_u32 s46, s46, s89
    v_mfma_f32_16x16x32_bf16 v[40:43], v[200:203], a[48:51], v[40:43]
    s_add_u32 m0, s88, 16384
    v_mfma_f32_16x16x32_bf16 v[44:47], v[204:207], a[48:51], v[44:47]
    s_waitcnt lgkmcnt(5)
    buffer_load_dwordx4 v229, s[16:19], s46 offen lds
    v_mfma_f32_16x16x32_bf16 v[48:51], v[192:195], a[52:55], v[48:51]
    ds_read_b128 a[12:15], v233 offset:8192
    v_mfma_f32_16x16x32_bf16 v[52:55], v[196:199], a[52:55], v[52:55]
    buffer_load_dwordx4 v230, s[16:19], s46 offen offset:1024 lds
    v_mfma_f32_16x16x32_bf16 v[56:59], v[200:203], a[52:55], v[56:59]
    v_mfma_f32_16x16x32_bf16 v[60:63], v[204:207], a[52:55], v[60:63]
    s_waitcnt lgkmcnt(5)
    v_mfma_f32_16x16x32_bf16 v[64:67], v[192:195], a[56:59], v[64:67]
    s_add_u32 m0, s53, 0
    v_mfma_f32_16x16x32_bf16 v[68:71], v[196:199], a[56:59], v[68:71]
    buffer_load_dwordx4 v168, s[8:11], s29 offen nt lds
    v_mfma_f32_16x16x32_bf16 v[72:75], v[200:203], a[56:59], v[72:75]
    v_mfma_f32_16x16x32_bf16 v[76:79], v[204:207], a[56:59], v[76:79]
    s_waitcnt lgkmcnt(4)
    v_mfma_f32_16x16x32_bf16 v[0:3], v[208:211], a[60:63], v[0:3]
    v_mfma_f32_16x16x32_bf16 v[4:7], v[212:215], a[60:63], v[4:7]
    v_mfma_f32_16x16x32_bf16 v[8:11], v[216:219], a[60:63], v[8:11]
    s_waitcnt vmcnt(8)
    s_waitcnt lgkmcnt(0)
    s_barrier
    ds_read_b128 a[16:19], v232 offset:20480
    ds_read_b64_tr_b16 v[192:193], v240 offset:0
    ds_read_b64_tr_b16 v[194:195], v240 offset:1024
    v_mfma_f32_16x16x32_bf16 v[12:15], v[220:223], a[60:63], v[12:15]
    ds_read_b128 a[20:23], v232 offset:22528
    ds_read_b64_tr_b16 v[196:197], v240 offset:8
    ds_read_b64_tr_b16 v[198:199], v240 offset:1032
    v_mfma_f32_16x16x32_bf16 v[16:19], v[208:211], a[0:3], v[16:19]
    s_add_u32 s45, s43, 6
    ds_read_b128 a[24:27], v232 offset:24576
    ds_read_b64_tr_b16 v[200:201], v241 offset:0
    ds_read_b64_tr_b16 v[202:203], v241 offset:1024
    v_mfma_f32_16x16x32_bf16 v[20:23], v[212:215], a[0:3], v[20:23]
    s_cmp_ge_u32 s45, 9
    s_cselect_b32 s39, 9, 0
    ds_read_b64_tr_b16 v[204:205], v241 offset:8
    ds_read_b64_tr_b16 v[206:207], v241 offset:1032
    v_mfma_f32_16x16x32_bf16 v[24:27], v[216:219], a[0:3], v[24:27]
    s_sub_u32 s45, s45, s39
    v_mfma_f32_16x16x32_bf16 v[28:31], v[220:223], a[0:3], v[28:31]
    s_lshl_b32 s45, s45, 7
    v_mfma_f32_16x16x32_bf16 v[32:35], v[208:211], a[4:7], v[32:35]
    s_add_u32 s45, s45, s44
    ds_read_b128 a[28:31], v232 offset:26624
    v_mfma_f32_16x16x32_bf16 v[36:39], v[212:215], a[4:7], v[36:39]
    s_add_u32 m0, s87, 98304
    s_nop 0
    buffer_load_dwordx4 v224, s[12:15], s45 offen lds
    v_mfma_f32_16x16x32_bf16 v[40:43], v[216:219], a[4:7], v[40:43]
    v_mfma_f32_16x16x32_bf16 v[44:47], v[220:223], a[4:7], v[44:47]
    buffer_load_dwordx4 v225, s[12:15], s45 offen offset:1024 lds
    v_mfma_f32_16x16x32_bf16 v[48:51], v[208:211], a[8:11], v[48:51]
    ds_read_b128 a[32:35], v232 offset:28672
    v_mfma_f32_16x16x32_bf16 v[52:55], v[212:215], a[8:11], v[52:55]
    buffer_load_dwordx4 v226, s[12:15], s45 offen offset:2048 lds
    v_mfma_f32_16x16x32_bf16 v[56:59], v[216:219], a[8:11], v[56:59]
    v_mfma_f32_16x16x32_bf16 v[60:63], v[220:223], a[8:11], v[60:63]
    buffer_load_dwordx4 v227, s[12:15], s45 offen offset:3072 lds
    v_mfma_f32_16x16x32_bf16 v[64:67], v[208:211], a[12:15], v[64:67]
    ds_read_b128 a[36:39], v233 offset:20480
    ds_read_b64_tr_b16 v[208:209], v242 offset:0
    ds_read_b64_tr_b16 v[210:211], v242 offset:1024
    v_mfma_f32_16x16x32_bf16 v[68:71], v[212:215], a[12:15], v[68:71]
    s_add_u32 m0, s87, 102400
    s_nop 0
    buffer_load_dwordx4 v228, s[12:15], s45 offen lds
    ds_read_b64_tr_b16 v[212:213], v242 offset:8
    ds_read_b64_tr_b16 v[214:215], v242 offset:1032
    v_mfma_f32_16x16x32_bf16 v[72:75], v[216:219], a[12:15], v[72:75]
    ds_read_b64_tr_b16 v[216:217], v243 offset:0
    ds_read_b64_tr_b16 v[218:219], v243 offset:1024
    v_mfma_f32_16x16x32_bf16 v[76:79], v[220:223], a[12:15], v[76:79]
    s_waitcnt lgkmcnt(15)
    ds_read_b64_tr_b16 v[220:221], v243 offset:8
    ds_read_b64_tr_b16 v[222:223], v243 offset:1032
    v_mfma_f32_16x16x32_bf16 v[80:83], v[192:195], a[16:19], v[80:83]
    s_waitcnt lgkmcnt(15)
    ds_read_b128 a[40:43], v233 offset:22528
    v_mfma_f32_16x16x32_bf16 v[84:87], v[196:199], a[16:19], v[84:87]
    s_waitcnt lgkmcnt(14)
    v_mfma_f32_16x16x32_bf16 v[88:91], v[200:203], a[16:19], v[88:91]
    s_waitcnt lgkmcnt(12)
    v_mfma_f32_16x16x32_bf16 v[92:95], v[204:207], a[16:19], v[92:95]
    s_add_u32 s46, s43, 6
    v_mfma_f32_16x16x32_bf16 v[96:99], v[192:195], a[20:23], v[96:99]
    s_cmp_ge_u32 s46, 9
    s_cselect_b32 s39, 9, 0
    ds_read_b128 a[44:47], v233 offset:24576
    v_mfma_f32_16x16x32_bf16 v[100:103], v[196:199], a[20:23], v[100:103]
    s_sub_u32 s46, s46, s39
    v_mfma_f32_16x16x32_bf16 v[104:107], v[200:203], a[20:23], v[104:107]
    s_lshl_b32 s46, s46, 19
    v_mfma_f32_16x16x32_bf16 v[108:111], v[204:207], a[20:23], v[108:111]
    s_add_u32 s46, s46, s89
    v_mfma_f32_16x16x32_bf16 v[112:115], v[192:195], a[24:27], v[112:115]
    s_add_u32 s46, s46, 262144
    ds_read_b128 a[48:51], v233 offset:26624
    v_mfma_f32_16x16x32_bf16 v[116:119], v[196:199], a[24:27], v[116:119]
    s_add_u32 m0, s88, 40960
    s_nop 0
    buffer_load_dwordx4 v229, s[16:19], s46 offen lds
    v_mfma_f32_16x16x32_bf16 v[120:123], v[200:203], a[24:27], v[120:123]
    v_mfma_f32_16x16x32_bf16 v[124:127], v[204:207], a[24:27], v[124:127]
    s_waitcnt lgkmcnt(13)
    buffer_load_dwordx4 v230, s[16:19], s46 offen offset:1024 lds
    v_mfma_f32_16x16x32_bf16 v[128:131], v[192:195], a[28:31], v[128:131]
    ds_read_b128 a[52:55], v233 offset:28672
    v_mfma_f32_16x16x32_bf16 v[132:135], v[196:199], a[28:31], v[132:135]
    v_mfma_f32_16x16x32_bf16 v[136:139], v[200:203], a[28:31], v[136:139]
    v_mfma_f32_16x16x32_bf16 v[140:143], v[204:207], a[28:31], v[140:143]
    s_waitcnt lgkmcnt(13)
    v_mfma_f32_16x16x32_bf16 v[144:147], v[192:195], a[32:35], v[144:147]
    v_mfma_f32_16x16x32_bf16 v[148:151], v[196:199], a[32:35], v[148:151]
    v_mfma_f32_16x16x32_bf16 v[152:155], v[200:203], a[32:35], v[152:155]
    v_mfma_f32_16x16x32_bf16 v[156:159], v[204:207], a[32:35], v[156:159]
    s_waitcnt lgkmcnt(10)
    v_mfma_f32_16x16x32_bf16 v[80:83], v[208:211], a[36:39], v[80:83]
    s_waitcnt lgkmcnt(8)
    v_mfma_f32_16x16x32_bf16 v[84:87], v[212:215], a[36:39], v[84:87]
    s_waitcnt lgkmcnt(6)
    v_mfma_f32_16x16x32_bf16 v[88:91], v[216:219], a[36:39], v[88:91]
    s_waitcnt vmcnt(10)
    s_waitcnt lgkmcnt(0)
    s_barrier
    ds_read_b128 a[56:59], v232 offset:40960
    v_mfma_f32_16x16x32_bf16 v[92:95], v[220:223], a[36:39], v[92:95]
    ds_read_b128 a[60:63], v232 offset:43008
    v_mfma_f32_16x16x32_bf16 v[96:99], v[208:211], a[40:43], v[96:99]
    s_add_u32 s45, s43, 6
    ds_read_b128 a[0:3], v232 offset:45056
    v_mfma_f32_16x16x32_bf16 v[100:103], v[212:215], a[40:43], v[100:103]
    s_cmp_ge_u32 s45, 9
    s_cselect_b32 s39, 9, 0
    v_mfma_f32_16x16x32_bf16 v[104:107], v[216:219], a[40:43], v[104:107]
    s_sub_u32 s45, s45, s39
    v_mfma_f32_16x16x32_bf16 v[108:111], v[220:223], a[40:43], v[108:111]
    s_lshl_b32 s45, s45, 7
    v_mfma_f32_16x16x32_bf16 v[112:115], v[208:211], a[44:47], v[112:115]
    s_add_u32 s45, s45, s44
    ds_read_b128 a[4:7], v232 offset:47104
    v_mfma_f32_16x16x32_bf16 v[116:119], v[212:215], a[44:47], v[116:119]
    s_add_u32 s45, s45, 737280
    v_mfma_f32_16x16x32_bf16 v[120:123], v[216:219], a[44:47], v[120:123]
    s_add_u32 m0, s87, 118784
    v_mfma_f32_16x16x32_bf16 v[124:127], v[220:223], a[44:47], v[124:127]
    buffer_load_dwordx4 v224, s[12:15], s45 offen lds
    v_mfma_f32_16x16x32_bf16 v[128:131], v[208:211], a[48:51], v[128:131]
    ds_read_b128 a[8:11], v232 offset:49152
    v_mfma_f32_16x16x32_bf16 v[132:135], v[212:215], a[48:51], v[132:135]
    buffer_load_dwordx4 v225, s[12:15], s45 offen offset:1024 lds
    v_mfma_f32_16x16x32_bf16 v[136:139], v[216:219], a[48:51], v[136:139]
    v_mfma_f32_16x16x32_bf16 v[140:143], v[220:223], a[48:51], v[140:143]
    buffer_load_dwordx4 v226, s[12:15], s45 offen offset:2048 lds
    v_mfma_f32_16x16x32_bf16 v[144:147], v[208:211], a[52:55], v[144:147]
    ds_read_b128 a[12:15], v233 offset:40960
    v_mfma_f32_16x16x32_bf16 v[148:151], v[212:215], a[52:55], v[148:151]
    buffer_load_dwordx4 v227, s[12:15], s45 offen offset:3072 lds
    v_mfma_f32_16x16x32_bf16 v[152:155], v[216:219], a[52:55], v[152:155]
    v_mfma_f32_16x16x32_bf16 v[156:159], v[220:223], a[52:55], v[156:159]
    s_waitcnt lgkmcnt(5)
    v_mfma_f32_16x16x32_bf16 v[0:3], v[192:195], a[56:59], v[0:3]
    s_add_u32 m0, s87, 122880
    ds_read_b128 a[16:19], v233 offset:43008
    v_mfma_f32_16x16x32_bf16 v[4:7], v[196:199], a[56:59], v[4:7]
    buffer_load_dwordx4 v228, s[12:15], s45 offen lds
    v_mfma_f32_16x16x32_bf16 v[8:11], v[200:203], a[56:59], v[8:11]
    v_mfma_f32_16x16x32_bf16 v[12:15], v[204:207], a[56:59], v[12:15]
    s_waitcnt lgkmcnt(5)
    v_mfma_f32_16x16x32_bf16 v[16:19], v[192:195], a[60:63], v[16:19]
    s_add_u32 s46, s43, 7
    ds_read_b128 a[20:23], v233 offset:45056
    v_mfma_f32_16x16x32_bf16 v[20:23], v[196:199], a[60:63], v[20:23]
    s_cmp_ge_u32 s46, 9
    s_cselect_b32 s39, 9, 0
    v_mfma_f32_16x16x32_bf16 v[24:27], v[200:203], a[60:63], v[24:27]
    s_sub_u32 s46, s46, s39
    v_mfma_f32_16x16x32_bf16 v[28:31], v[204:207], a[60:63], v[28:31]
    s_waitcnt lgkmcnt(5)
    v_mfma_f32_16x16x32_bf16 v[32:35], v[192:195], a[0:3], v[32:35]
    s_lshl_b32 s46, s46, 19
    ds_read_b128 a[24:27], v233 offset:47104
    v_mfma_f32_16x16x32_bf16 v[36:39], v[196:199], a[0:3], v[36:39]
    s_add_u32 s46, s46, s89
    v_mfma_f32_16x16x32_bf16 v[40:43], v[200:203], a[0:3], v[40:43]
    s_add_u32 m0, s88, 65536
    v_mfma_f32_16x16x32_bf16 v[44:47], v[204:207], a[0:3], v[44:47]
    s_waitcnt lgkmcnt(5)
    buffer_load_dwordx4 v229, s[16:19], s46 offen lds
    v_mfma_f32_16x16x32_bf16 v[48:51], v[192:195], a[4:7], v[48:51]
    ds_read_b128 a[28:31], v233 offset:49152
    v_mfma_f32_16x16x32_bf16 v[52:55], v[196:199], a[4:7], v[52:55]
    buffer_load_dwordx4 v230, s[16:19], s46 offen offset:1024 lds
    v_mfma_f32_16x16x32_bf16 v[56:59], v[200:203], a[4:7], v[56:59]
    v_mfma_f32_16x16x32_bf16 v[60:63], v[204:207], a[4:7], v[60:63]
    s_waitcnt lgkmcnt(5)
    v_mfma_f32_16x16x32_bf16 v[64:67], v[192:195], a[8:11], v[64:67]
    s_add_u32 m0, s53, 0
    v_mfma_f32_16x16x32_bf16 v[68:71], v[196:199], a[8:11], v[68:71]
    buffer_load_dwordx4 v169, s[8:11], s29 offen offset:1024 nt lds
    v_mfma_f32_16x16x32_bf16 v[72:75], v[200:203], a[8:11], v[72:75]
    v_mfma_f32_16x16x32_bf16 v[76:79], v[204:207], a[8:11], v[76:79]
    s_waitcnt lgkmcnt(4)
    v_mfma_f32_16x16x32_bf16 v[0:3], v[208:211], a[12:15], v[0:3]
    v_mfma_f32_16x16x32_bf16 v[4:7], v[212:215], a[12:15], v[4:7]
    v_mfma_f32_16x16x32_bf16 v[8:11], v[216:219], a[12:15], v[8:11]
    s_waitcnt vmcnt(8)
    s_waitcnt lgkmcnt(0)
    s_barrier
    ds_read_b128 a[32:35], v232 offset:0
    ds_read_b64_tr_b16 v[192:193], v236 offset:0
    ds_read_b64_tr_b16 v[194:195], v236 offset:1024
    v_mfma_f32_16x16x32_bf16 v[12:15], v[220:223], a[12:15], v[12:15]
    ds_read_b128 a[36:39], v232 offset:2048
    ds_read_b64_tr_b16 v[196:197], v236 offset:8
    ds_read_b64_tr_b16 v[198:199], v236 offset:1032
    v_mfma_f32_16x16x32_bf16 v[16:19], v[208:211], a[16:19], v[16:19]
    s_add_u32 s45, s43, 7
    ds_read_b128 a[40:43], v232 offset:4096
    ds_read_b64_tr_b16 v[200:201], v237 offset:0
    ds_read_b64_tr_b16 v[202:203], v237 offset:1024
    v_mfma_f32_16x16x32_bf16 v[20:23], v[212:215], a[16:19], v[20:23]
    s_cmp_ge_u32 s45, 9
    s_cselect_b32 s39, 9, 0
    ds_read_b64_tr_b16 v[204:205], v237 offset:8
    ds_read_b64_tr_b16 v[206:207], v237 offset:1032
    v_mfma_f32_16x16x32_bf16 v[24:27], v[216:219], a[16:19], v[24:27]
    s_sub_u32 s45, s45, s39
    v_mfma_f32_16x16x32_bf16 v[28:31], v[220:223], a[16:19], v[28:31]
    s_lshl_b32 s45, s45, 7
    v_mfma_f32_16x16x32_bf16 v[32:35], v[208:211], a[20:23], v[32:35]
    s_add_u32 s45, s45, s44
    ds_read_b128 a[44:47], v232 offset:6144
    v_mfma_f32_16x16x32_bf16 v[36:39], v[212:215], a[20:23], v[36:39]
    s_add_u32 m0, s87, 139264
    s_nop 0
    buffer_load_dwordx4 v224, s[12:15], s45 offen lds
    v_mfma_f32_16x16x32_bf16 v[40:43], v[216:219], a[20:23], v[40:43]
    v_mfma_f32_16x16x32_bf16 v[44:47], v[220:223], a[20:23], v[44:47]
    buffer_load_dwordx4 v225, s[12:15], s45 offen offset:1024 lds
    v_mfma_f32_16x16x32_bf16 v[48:51], v[208:211], a[24:27], v[48:51]
    ds_read_b128 a[48:51], v232 offset:8192
    v_mfma_f32_16x16x32_bf16 v[52:55], v[212:215], a[24:27], v[52:55]
    buffer_load_dwordx4 v226, s[12:15], s45 offen offset:2048 lds
    v_mfma_f32_16x16x32_bf16 v[56:59], v[216:219], a[24:27], v[56:59]
    v_mfma_f32_16x16x32_bf16 v[60:63], v[220:223], a[24:27], v[60:63]
    buffer_load_dwordx4 v227, s[12:15], s45 offen offset:3072 lds
    v_mfma_f32_16x16x32_bf16 v[64:67], v[208:211], a[28:31], v[64:67]
    ds_read_b128 a[52:55], v233 offset:0
    ds_read_b64_tr_b16 v[208:209], v238 offset:0
    ds_read_b64_tr_b16 v[210:211], v238 offset:1024
    v_mfma_f32_16x16x32_bf16 v[68:71], v[212:215], a[28:31], v[68:71]
    s_add_u32 m0, s87, 143360
    s_nop 0
    buffer_load_dwordx4 v228, s[12:15], s45 offen lds
    ds_read_b64_tr_b16 v[212:213], v238 offset:8
    ds_read_b64_tr_b16 v[214:215], v238 offset:1032
    v_mfma_f32_16x16x32_bf16 v[72:75], v[216:219], a[28:31], v[72:75]
    ds_read_b64_tr_b16 v[216:217], v239 offset:0
    ds_read_b64_tr_b16 v[218:219], v239 offset:1024
    v_mfma_f32_16x16x32_bf16 v[76:79], v[220:223], a[28:31], v[76:79]
    s_waitcnt lgkmcnt(15)
    ds_read_b64_tr_b16 v[220:221], v239 offset:8
    ds_read_b64_tr_b16 v[222:223], v239 offset:1032
    v_mfma_f32_16x16x32_bf16 v[80:83], v[192:195], a[32:35], v[80:83]
    s_waitcnt lgkmcnt(15)
    ds_read_b128 a[56:59], v233 offset:2048
    v_mfma_f32_16x16x32_bf16 v[84:87], v[196:199], a[32:35], v[84:87]
    s_waitcnt lgkmcnt(14)
    v_mfma_f32_16x16x32_bf16 v[88:91], v[200:203], a[32:35], v[88:91]
    s_waitcnt lgkmcnt(12)
    v_mfma_f32_16x16x32_bf16 v[92:95], v[204:207], a[32:35], v[92:95]
    s_add_u32 s46, s43, 7
    v_mfma_f32_16x16x32_bf16 v[96:99], v[192:195], a[36:39], v[96:99]
    s_cmp_ge_u32 s46, 9
    s_cselect_b32 s39, 9, 0
    ds_read_b128 a[60:63], v233 offset:4096
    v_mfma_f32_16x16x32_bf16 v[100:103], v[196:199], a[36:39], v[100:103]
    s_sub_u32 s46, s46, s39
    v_mfma_f32_16x16x32_bf16 v[104:107], v[200:203], a[36:39], v[104:107]
    s_lshl_b32 s46, s46, 19
    v_mfma_f32_16x16x32_bf16 v[108:111], v[204:207], a[36:39], v[108:111]
    s_add_u32 s46, s46, s89
    v_mfma_f32_16x16x32_bf16 v[112:115], v[192:195], a[40:43], v[112:115]
    s_add_u32 s46, s46, 262144
    ds_read_b128 a[0:3], v233 offset:6144
    v_mfma_f32_16x16x32_bf16 v[116:119], v[196:199], a[40:43], v[116:119]
    s_add_u32 m0, s88, 90112
    s_nop 0
    buffer_load_dwordx4 v229, s[16:19], s46 offen lds
    v_mfma_f32_16x16x32_bf16 v[120:123], v[200:203], a[40:43], v[120:123]
    v_mfma_f32_16x16x32_bf16 v[124:127], v[204:207], a[40:43], v[124:127]
    s_waitcnt lgkmcnt(13)
    buffer_load_dwordx4 v230, s[16:19], s46 offen offset:1024 lds
    v_mfma_f32_16x16x32_bf16 v[128:131], v[192:195], a[44:47], v[128:131]
    ds_read_b128 a[4:7], v233 offset:8192
    v_mfma_f32_16x16x32_bf16 v[132:135], v[196:199], a[44:47], v[132:135]
    v_mfma_f32_16x16x32_bf16 v[136:139], v[200:203], a[44:47], v[136:139]
    v_mfma_f32_16x16x32_bf16 v[140:143], v[204:207], a[44:47], v[140:143]
    s_waitcnt lgkmcnt(13)
    v_mfma_f32_16x16x32_bf16 v[144:147], v[192:195], a[48:51], v[144:147]
    v_mfma_f32_16x16x32_bf16 v[148:151], v[196:199], a[48:51], v[148:151]
    v_mfma_f32_16x16x32_bf16 v[152:155], v[200:203], a[48:51], v[152:155]
    v_mfma_f32_16x16x32_bf16 v[156:159], v[204:207], a[48:51], v[156:159]
    s_waitcnt lgkmcnt(10)
    v_mfma_f32_16x16x32_bf16 v[80:83], v[208:211], a[52:55], v[80:83]
    s_waitcnt lgkmcnt(8)
    v_mfma_f32_16x16x32_bf16 v[84:87], v[212:215], a[52:55], v[84:87]
    s_waitcnt lgkmcnt(6)
    v_mfma_f32_16x16x32_bf16 v[88:91], v[216:219], a[52:55], v[88:91]
    s_waitcnt vmcnt(10)
    s_waitcnt lgkmcnt(0)
    s_barrier
    ds_read_b128 a[8:11], v232 offset:20480
    v_mfma_f32_16x16x32_bf16 v[92:95], v[220:223], a[52:55], v[92:95]
    ds_read_b128 a[12:15], v232 offset:22528
    v_mfma_f32_16x16x32_bf16 v[96:99], v[208:211], a[56:59], v[96:99]
    s_add_u32 s45, s43, 7
    ds_read_b128 a[16:19], v232 offset:24576
    v_mfma_f32_16x16x32_bf16 v[100:103], v[212:215], a[56:59], v[100:103]
    s_cmp_ge_u32 s45, 9
    s_cselect_b32 s39, 9, 0
    v_mfma_f32_16x16x32_bf16 v[104:107], v[216:219], a[56:59], v[104:107]
    s_sub_u32 s45, s45, s39
    v_mfma_f32_16x16x32_bf16 v[108:111], v[220:223], a[56:59], v[108:111]
    s_lshl_b32 s45, s45, 7
    v_mfma_f32_16x16x32_bf16 v[112:115], v[208:211], a[60:63], v[112:115]
    s_add_u32 s45, s45, s44
    ds_read_b128 a[20:23], v232 offset:26624
    v_mfma_f32_16x16x32_bf16 v[116:119], v[212:215], a[60:63], v[116:119]
    s_add_u32 s45, s45, 737280
    v_mfma_f32_16x16x32_bf16 v[120:123], v[216:219], a[60:63], v[120:123]
    s_add_u32 m0, s87, 98304
    v_mfma_f32_16x16x32_bf16 v[124:127], v[220:223], a[60:63], v[124:127]
    buffer_load_dwordx4 v224, s[12:15], s45 offen lds
    v_mfma_f32_16x16x32_bf16 v[128:131], v[208:211], a[0:3], v[128:131]
    ds_read_b128 a[24:27], v232 offset:28672
    v_mfma_f32_16x16x32_bf16 v[132:135], v[212:215], a[0:3], v[132:135]
    buffer_load_dwordx4 v225, s[12:15], s45 offen offset:1024 lds
    v_mfma_f32_16x16x32_bf16 v[136:139], v[216:219], a[0:3], v[136:139]
    v_mfma_f32_16x16x32_bf16 v[140:143], v[220:223], a[0:3], v[140:143]
    buffer_load_dwordx4 v226, s[12:15], s45 offen offset:2048 lds
    v_mfma_f32_16x16x32_bf16 v[144:147], v[208:211], a[4:7], v[144:147]
    ds_read_b128 a[28:31], v233 offset:20480
    v_mfma_f32_16x16x32_bf16 v[148:151], v[212:215], a[4:7], v[148:151]
    buffer_load_dwordx4 v227, s[12:15], s45 offen offset:3072 lds
    v_mfma_f32_16x16x32_bf16 v[152:155], v[216:219], a[4:7], v[152:155]
    v_mfma_f32_16x16x32_bf16 v[156:159], v[220:223], a[4:7], v[156:159]
    s_waitcnt lgkmcnt(5)
    v_mfma_f32_16x16x32_bf16 v[0:3], v[192:195], a[8:11], v[0:3]
    s_add_u32 m0, s87, 102400
    ds_read_b128 a[32:35], v233 offset:22528
    v_mfma_f32_16x16x32_bf16 v[4:7], v[196:199], a[8:11], v[4:7]
    buffer_load_dwordx4 v228, s[12:15], s45 offen lds
    v_mfma_f32_16x16x32_bf16 v[8:11], v[200:203], a[8:11], v[8:11]
    v_mfma_f32_16x16x32_bf16 v[12:15], v[204:207], a[8:11], v[12:15]
    s_waitcnt lgkmcnt(5)
    v_mfma_f32_16x16x32_bf16 v[16:19], v[192:195], a[12:15], v[16:19]
    s_add_u32 s46, s43, 8
    ds_read_b128 a[36:39], v233 offset:24576
    v_mfma_f32_16x16x32_bf16 v[20:23], v[196:199], a[12:15], v[20:23]
    s_cmp_ge_u32 s46, 9
    s_cselect_b32 s39, 9, 0
    v_mfma_f32_16x16x32_bf16 v[24:27], v[200:203], a[12:15], v[24:27]
    s_sub_u32 s46, s46, s39
    v_mfma_f32_16x16x32_bf16 v[28:31], v[204:207], a[12:15], v[28:31]
    s_waitcnt lgkmcnt(5)
    v_mfma_f32_16x16x32_bf16 v[32:35], v[192:195], a[16:19], v[32:35]
    s_lshl_b32 s46, s46, 19
    ds_read_b128 a[40:43], v233 offset:26624
    v_mfma_f32_16x16x32_bf16 v[36:39], v[196:199], a[16:19], v[36:39]
    s_add_u32 s46, s46, s89
    v_mfma_f32_16x16x32_bf16 v[40:43], v[200:203], a[16:19], v[40:43]
    s_add_u32 m0, s88, 16384
    v_mfma_f32_16x16x32_bf16 v[44:47], v[204:207], a[16:19], v[44:47]
    s_waitcnt lgkmcnt(5)
    buffer_load_dwordx4 v229, s[16:19], s46 offen lds
    v_mfma_f32_16x16x32_bf16 v[48:51], v[192:195], a[20:23], v[48:51]
    ds_read_b128 a[44:47], v233 offset:28672
    v_mfma_f32_16x16x32_bf16 v[52:55], v[196:199], a[20:23], v[52:55]
    buffer_load_dwordx4 v230, s[16:19], s46 offen offset:1024 lds
    v_mfma_f32_16x16x32_bf16 v[56:59], v[200:203], a[20:23], v[56:59]
    v_mfma_f32_16x16x32_bf16 v[60:63], v[204:207], a[20:23], v[60:63]
    s_waitcnt lgkmcnt(5)
    v_mfma_f32_16x16x32_bf16 v[64:67], v[192:195], a[24:27], v[64:67]
    s_add_u32 m0, s53, 0
    v_mfma_f32_16x16x32_bf16 v[68:71], v[196:199], a[24:27], v[68:71]
    buffer_load_dwordx4 v168, s[8:11], s29 offen offset:2048 nt lds
    v_mfma_f32_16x16x32_bf16 v[72:75], v[200:203], a[24:27], v[72:75]
    v_mfma_f32_16x16x32_bf16 v[76:79], v[204:207], a[24:27], v[76:79]
    s_waitcnt lgkmcnt(4)
    v_mfma_f32_16x16x32_bf16 v[0:3], v[208:211], a[28:31], v[0:3]
    v_mfma_f32_16x16x32_bf16 v[4:7], v[212:215], a[28:31], v[4:7]
    v_mfma_f32_16x16x32_bf16 v[8:11], v[216:219], a[28:31], v[8:11]
    s_waitcnt vmcnt(8)
    s_waitcnt lgkmcnt(0)
    s_barrier
    ds_read_b128 a[48:51], v232 offset:40960
    ds_read_b64_tr_b16 v[192:193], v240 offset:0
    ds_read_b64_tr_b16 v[194:195], v240 offset:1024
    v_mfma_f32_16x16x32_bf16 v[12:15], v[220:223], a[28:31], v[12:15]
    ds_read_b128 a[52:55], v232 offset:43008
    ds_read_b64_tr_b16 v[196:197], v240 offset:8
    ds_read_b64_tr_b16 v[198:199], v240 offset:1032
    v_mfma_f32_16x16x32_bf16 v[16:19], v[208:211], a[32:35], v[16:19]
    s_add_u32 s45, s43, 8
    ds_read_b128 a[56:59], v232 offset:45056
    ds_read_b64_tr_b16 v[200:201], v241 offset:0
    ds_read_b64_tr_b16 v[202:203], v241 offset:1024
    v_mfma_f32_16x16x32_bf16 v[20:23], v[212:215], a[32:35], v[20:23]
    s_cmp_ge_u32 s45, 9
    s_cselect_b32 s39, 9, 0
    ds_read_b64_tr_b16 v[204:205], v241 offset:8
    ds_read_b64_tr_b16 v[206:207], v241 offset:1032
    v_mfma_f32_16x16x32_bf16 v[24:27], v[216:219], a[32:35], v[24:27]
    s_sub_u32 s45, s45, s39
    v_mfma_f32_16x16x32_bf16 v[28:31], v[220:223], a[32:35], v[28:31]
    s_lshl_b32 s45, s45, 7
    v_mfma_f32_16x16x32_bf16 v[32:35], v[208:211], a[36:39], v[32:35]
    s_add_u32 s45, s45, s44
    ds_read_b128 a[60:63], v232 offset:47104
    v_mfma_f32_16x16x32_bf16 v[36:39], v[212:215], a[36:39], v[36:39]
    s_add_u32 m0, s87, 118784
    s_nop 0
    buffer_load_dwordx4 v224, s[12:15], s45 offen lds
    v_mfma_f32_16x16x32_bf16 v[40:43], v[216:219], a[36:39], v[40:43]
    v_mfma_f32_16x16x32_bf16 v[44:47], v[220:223], a[36:39], v[44:47]
    buffer_load_dwordx4 v225, s[12:15], s45 offen offset:1024 lds
    v_mfma_f32_16x16x32_bf16 v[48:51], v[208:211], a[40:43], v[48:51]
    ds_read_b128 a[0:3], v232 offset:49152
    v_mfma_f32_16x16x32_bf16 v[52:55], v[212:215], a[40:43], v[52:55]
    buffer_load_dwordx4 v226, s[12:15], s45 offen offset:2048 lds
    v_mfma_f32_16x16x32_bf16 v[56:59], v[216:219], a[40:43], v[56:59]
    v_mfma_f32_16x16x32_bf16 v[60:63], v[220:223], a[40:43], v[60:63]
    buffer_load_dwordx4 v227, s[12:15], s45 offen offset:3072 lds
    v_mfma_f32_16x16x32_bf16 v[64:67], v[208:211], a[44:47], v[64:67]
    ds_read_b128 a[4:7], v233 offset:40960
    ds_read_b64_tr_b16 v[208:209], v242 offset:0
    ds_read_b64_tr_b16 v[210:211], v242 offset:1024
    v_mfma_f32_16x16x32_bf16 v[68:71], v[212:215], a[44:47], v[68:71]
    s_add_u32 m0, s87, 122880
    s_nop 0
    buffer_load_dwordx4 v228, s[12:15], s45 offen lds
    ds_read_b64_tr_b16 v[212:213], v242 offset:8
    ds_read_b64_tr_b16 v[214:215], v242 offset:1032
    v_mfma_f32_16x16x32_bf16 v[72:75], v[216:219], a[44:47], v[72:75]
    ds_read_b64_tr_b16 v[216:217], v243 offset:0
    ds_read_b64_tr_b16 v[218:219], v243 offset:1024
    v_mfma_f32_16x16x32_bf16 v[76:79], v[220:223], a[44:47], v[76:79]
    s_waitcnt lgkmcnt(15)
    ds_read_b64_tr_b16 v[220:221], v243 offset:8
    ds_read_b64_tr_b16 v[222:223], v243 offset:1032
    v_mfma_f32_16x16x32_bf16 v[80:83], v[192:195], a[48:51], v[80:83]
    s_waitcnt lgkmcnt(15)
    ds_read_b128 a[8:11], v233 offset:43008
    v_mfma_f32_16x16x32_bf16 v[84:87], v[196:199], a[48:51], v[84:87]
    s_waitcnt lgkmcnt(14)
    v_mfma_f32_16x16x32_bf16 v[88:91], v[200:203], a[48:51], v[88:91]
    s_waitcnt lgkmcnt(12)
    v_mfma_f32_16x16x32_bf16 v[92:95], v[204:207], a[48:51], v[92:95]
    s_add_u32 s46, s43, 8
    v_mfma_f32_16x16x32_bf16 v[96:99], v[192:195], a[52:55], v[96:99]
    s_cmp_ge_u32 s46, 9
    s_cselect_b32 s39, 9, 0
    ds_read_b128 a[12:15], v233 offset:45056
    v_mfma_f32_16x16x32_bf16 v[100:103], v[196:199], a[52:55], v[100:103]
    s_sub_u32 s46, s46, s39
    v_mfma_f32_16x16x32_bf16 v[104:107], v[200:203], a[52:55], v[104:107]
    s_lshl_b32 s46, s46, 19
    v_mfma_f32_16x16x32_bf16 v[108:111], v[204:207], a[52:55], v[108:111]
    s_add_u32 s46, s46, s89
    v_mfma_f32_16x16x32_bf16 v[112:115], v[192:195], a[56:59], v[112:115]
    s_add_u32 s46, s46, 262144
    ds_read_b128 a[16:19], v233 offset:47104
    v_mfma_f32_16x16x32_bf16 v[116:119], v[196:199], a[56:59], v[116:119]
    s_add_u32 m0, s88, 40960
    s_nop 0
    buffer_load_dwordx4 v229, s[16:19], s46 offen lds
    v_mfma_f32_16x16x32_bf16 v[120:123], v[200:203], a[56:59], v[120:123]
    v_mfma_f32_16x16x32_bf16 v[124:127], v[204:207], a[56:59], v[124:127]
    s_waitcnt lgkmcnt(13)
    buffer_load_dwordx4 v230, s[16:19], s46 offen offset:1024 lds
    v_mfma_f32_16x16x32_bf16 v[128:131], v[192:195], a[60:63], v[128:131]
    ds_read_b128 a[20:23], v233 offset:49152
    v_mfma_f32_16x16x32_bf16 v[132:135], v[196:199], a[60:63], v[132:135]
    v_mfma_f32_16x16x32_bf16 v[136:139], v[200:203], a[60:63], v[136:139]
    v_mfma_f32_16x16x32_bf16 v[140:143], v[204:207], a[60:63], v[140:143]
    s_waitcnt lgkmcnt(13)
    v_mfma_f32_16x16x32_bf16 v[144:147], v[192:195], a[0:3], v[144:147]
    v_mfma_f32_16x16x32_bf16 v[148:151], v[196:199], a[0:3], v[148:151]
    v_mfma_f32_16x16x32_bf16 v[152:155], v[200:203], a[0:3], v[152:155]
    v_mfma_f32_16x16x32_bf16 v[156:159], v[204:207], a[0:3], v[156:159]
    s_waitcnt lgkmcnt(10)
    v_mfma_f32_16x16x32_bf16 v[80:83], v[208:211], a[4:7], v[80:83]
    s_waitcnt lgkmcnt(8)
    v_mfma_f32_16x16x32_bf16 v[84:87], v[212:215], a[4:7], v[84:87]
    s_waitcnt lgkmcnt(6)
    v_mfma_f32_16x16x32_bf16 v[88:91], v[216:219], a[4:7], v[88:91]
    s_waitcnt vmcnt(10)
    s_waitcnt lgkmcnt(0)
    s_barrier
    ds_read_b128 a[24:27], v232 offset:0
    v_mfma_f32_16x16x32_bf16 v[92:95], v[220:223], a[4:7], v[92:95]
    ds_read_b128 a[28:31], v232 offset:2048
    v_mfma_f32_16x16x32_bf16 v[96:99], v[208:211], a[8:11], v[96:99]
    s_add_u32 s45, s43, 8
    ds_read_b128 a[32:35], v232 offset:4096
    v_mfma_f32_16x16x32_bf16 v[100:103], v[212:215], a[8:11], v[100:103]
    s_cmp_ge_u32 s45, 9
    s_cselect_b32 s39, 9, 0
    v_mfma_f32_16x16x32_bf16 v[104:107], v[216:219], a[8:11], v[104:107]
    s_sub_u32 s45, s45, s39
    v_mfma_f32_16x16x32_bf16 v[108:111], v[220:223], a[8:11], v[108:111]
    s_lshl_b32 s45, s45, 7
    v_mfma_f32_16x16x32_bf16 v[112:115], v[208:211], a[12:15], v[112:115]
    s_add_u32 s45, s45, s44
    ds_read_b128 a[36:39], v232 offset:6144
    v_mfma_f32_16x16x32_bf16 v[116:119], v[212:215], a[12:15], v[116:119]
    s_add_u32 s45, s45, 737280
    v_mfma_f32_16x16x32_bf16 v[120:123], v[216:219], a[12:15], v[120:123]
    s_add_u32 m0, s87, 139264
    v_mfma_f32_16x16x32_bf16 v[124:127], v[220:223], a[12:15], v[124:127]
    buffer_load_dwordx4 v224, s[12:15], s45 offen lds
    v_mfma_f32_16x16x32_bf16 v[128:131], v[208:211], a[16:19], v[128:131]
    ds_read_b128 a[40:43], v232 offset:8192
    v_mfma_f32_16x16x32_bf16 v[132:135], v[212:215], a[16:19], v[132:135]
    buffer_load_dwordx4 v225, s[12:15], s45 offen offset:1024 lds
    v_mfma_f32_16x16x32_bf16 v[136:139], v[216:219], a[16:19], v[136:139]
    v_mfma_f32_16x16x32_bf16 v[140:143], v[220:223], a[16:19], v[140:143]
    buffer_load_dwordx4 v226, s[12:15], s45 offen offset:2048 lds
    v_mfma_f32_16x16x32_bf16 v[144:147], v[208:211], a[20:23], v[144:147]
    ds_read_b128 a[44:47], v233 offset:0
    v_mfma_f32_16x16x32_bf16 v[148:151], v[212:215], a[20:23], v[148:151]
    buffer_load_dwordx4 v227, s[12:15], s45 offen offset:3072 lds
    v_mfma_f32_16x16x32_bf16 v[152:155], v[216:219], a[20:23], v[152:155]
    v_mfma_f32_16x16x32_bf16 v[156:159], v[220:223], a[20:23], v[156:159]
    s_waitcnt lgkmcnt(5)
    v_mfma_f32_16x16x32_bf16 v[0:3], v[192:195], a[24:27], v[0:3]
    s_add_u32 m0, s87, 143360
    ds_read_b128 a[48:51], v233 offset:2048
    v_mfma_f32_16x16x32_bf16 v[4:7], v[196:199], a[24:27], v[4:7]
    buffer_load_dwordx4 v228, s[12:15], s45 offen lds
    v_mfma_f32_16x16x32_bf16 v[8:11], v[200:203], a[24:27], v[8:11]
    v_mfma_f32_16x16x32_bf16 v[12:15], v[204:207], a[24:27], v[12:15]
    s_waitcnt lgkmcnt(5)
    v_mfma_f32_16x16x32_bf16 v[16:19], v[192:195], a[28:31], v[16:19]
    s_add_u32 m0, s53, 0
    ds_read_b128 a[52:55], v233 offset:4096
    v_mfma_f32_16x16x32_bf16 v[20:23], v[196:199], a[28:31], v[20:23]
    buffer_load_dwordx4 v169, s[8:11], s29 offen offset:3072 nt lds
    v_mfma_f32_16x16x32_bf16 v[24:27], v[200:203], a[28:31], v[24:27]
    v_mfma_f32_16x16x32_bf16 v[28:31], v[204:207], a[28:31], v[28:31]
    s_waitcnt lgkmcnt(5)
    v_mfma_f32_16x16x32_bf16 v[32:35], v[192:195], a[32:35], v[32:35]
    ds_read_b128 a[56:59], v233 offset:6144
    v_mfma_f32_16x16x32_bf16 v[36:39], v[196:199], a[32:35], v[36:39]
    v_mfma_f32_16x16x32_bf16 v[40:43], v[200:203], a[32:35], v[40:43]
    v_mfma_f32_16x16x32_bf16 v[44:47], v[204:207], a[32:35], v[44:47]
    s_waitcnt lgkmcnt(5)
    v_mfma_f32_16x16x32_bf16 v[48:51], v[192:195], a[36:39], v[48:51]
    ds_read_b128 a[60:63], v233 offset:8192
    v_mfma_f32_16x16x32_bf16 v[52:55], v[196:199], a[36:39], v[52:55]
    v_mfma_f32_16x16x32_bf16 v[56:59], v[200:203], a[36:39], v[56:59]
    v_mfma_f32_16x16x32_bf16 v[60:63], v[204:207], a[36:39], v[60:63]
    s_waitcnt lgkmcnt(5)
    v_mfma_f32_16x16x32_bf16 v[64:67], v[192:195], a[40:43], v[64:67]
    v_mfma_f32_16x16x32_bf16 v[68:71], v[196:199], a[40:43], v[68:71]
    v_mfma_f32_16x16x32_bf16 v[72:75], v[200:203], a[40:43], v[72:75]
    v_mfma_f32_16x16x32_bf16 v[76:79], v[204:207], a[40:43], v[76:79]
    s_waitcnt lgkmcnt(4)
    v_mfma_f32_16x16x32_bf16 v[0:3], v[208:211], a[44:47], v[0:3]
    v_mfma_f32_16x16x32_bf16 v[4:7], v[212:215], a[44:47], v[4:7]
    v_mfma_f32_16x16x32_bf16 v[8:11], v[216:219], a[44:47], v[8:11]
    s_waitcnt vmcnt(6)
    s_waitcnt lgkmcnt(0)
    s_barrier
    ds_read_b128 a[0:3], v232 offset:20480
    ds_read_b64_tr_b16 v[192:193], v236 offset:0
    ds_read_b64_tr_b16 v[194:195], v236 offset:1024
    v_mfma_f32_16x16x32_bf16 v[12:15], v[220:223], a[44:47], v[12:15]
    ds_read_b128 a[4:7], v232 offset:22528
    ds_read_b64_tr_b16 v[196:197], v236 offset:8
    ds_read_b64_tr_b16 v[198:199], v236 offset:1032
    v_mfma_f32_16x16x32_bf16 v[16:19], v[208:211], a[48:51], v[16:19]
    s_add_u32 m0, s52, 8192
    ds_read_b128 a[8:11], v232 offset:24576
    ds_read_b64_tr_b16 v[200:201], v237 offset:0
    ds_read_b64_tr_b16 v[202:203], v237 offset:1024
    v_mfma_f32_16x16x32_bf16 v[20:23], v[212:215], a[48:51], v[20:23]
    buffer_load_dwordx4 v164, s[4:7], s30 offen nt lds
    ds_read_b64_tr_b16 v[204:205], v237 offset:8
    ds_read_b64_tr_b16 v[206:207], v237 offset:1032
    v_mfma_f32_16x16x32_bf16 v[24:27], v[216:219], a[48:51], v[24:27]
    v_mfma_f32_16x16x32_bf16 v[28:31], v[220:223], a[48:51], v[28:31]
    s_add_u32 m0, s52, 8192
    s_nop 0
    buffer_load_dwordx4 v165, s[4:7], s30 offen offset:1024 nt lds
    v_mfma_f32_16x16x32_bf16 v[32:35], v[208:211], a[52:55], v[32:35]
    ds_read_b128 a[12:15], v232 offset:26624
    v_mfma_f32_16x16x32_bf16 v[36:39], v[212:215], a[52:55], v[36:39]
    s_add_u32 m0, s52, 8192
    s_nop 0
    buffer_load_dwordx4 v166, s[4:7], s30 offen offset:2048 nt lds
    v_mfma_f32_16x16x32_bf16 v[40:43], v[216:219], a[52:55], v[40:43]
    v_mfma_f32_16x16x32_bf16 v[44:47], v[220:223], a[52:55], v[44:47]
    s_add_u32 m0, s52, 8192
    s_nop 0
    buffer_load_dwordx4 v167, s[4:7], s30 offen offset:3072 nt lds
    v_mfma_f32_16x16x32_bf16 v[48:51], v[208:211], a[56:59], v[48:51]
    ds_read_b128 a[16:19], v232 offset:28672
    v_mfma_f32_16x16x32_bf16 v[52:55], v[212:215], a[56:59], v[52:55]
    s_add_u32 m0, s53, 8192
    s_nop 0
    buffer_load_dwordx4 v168, s[8:11], s30 offen nt lds
    v_mfma_f32_16x16x32_bf16 v[56:59], v[216:219], a[56:59], v[56:59]
    v_mfma_f32_16x16x32_bf16 v[60:63], v[220:223], a[56:59], v[60:63]
    s_add_u32 m0, s53, 8192
    s_nop 0
    buffer_load_dwordx4 v169, s[8:11], s30 offen offset:1024 nt lds
    v_mfma_f32_16x16x32_bf16 v[64:67], v[208:211], a[60:63], v[64:67]
    ds_read_b128 a[20:23], v233 offset:20480
    ds_read_b64_tr_b16 v[208:209], v238 offset:0
    ds_read_b64_tr_b16 v[210:211], v238 offset:1024
    v_mfma_f32_16x16x32_bf16 v[68:71], v[212:215], a[60:63], v[68:71]
    s_add_u32 m0, s53, 8192
    s_nop 0
    buffer_load_dwordx4 v168, s[8:11], s30 offen offset:2048 nt lds
    ds_read_b64_tr_b16 v[212:213], v238 offset:8
    ds_read_b64_tr_b16 v[214:215], v238 offset:1032
    v_mfma_f32_16x16x32_bf16 v[72:75], v[216:219], a[60:63], v[72:75]
    ds_read_b64_tr_b16 v[216:217], v239 offset:0
    ds_read_b64_tr_b16 v[218:219], v239 offset:1024
    v_mfma_f32_16x16x32_bf16 v[76:79], v[220:223], a[60:63], v[76:79]
    s_waitcnt lgkmcnt(15)
    ds_read_b64_tr_b16 v[220:221], v239 offset:8
    ds_read_b64_tr_b16 v[222:223], v239 offset:1032
    v_mfma_f32_16x16x32_bf16 v[80:83], v[192:195], a[0:3], v[80:83]
    s_waitcnt lgkmcnt(15)
    ds_read_b128 a[24:27], v233 offset:22528
    v_mfma_f32_16x16x32_bf16 v[84:87], v[196:199], a[0:3], v[84:87]
    s_waitcnt lgkmcnt(14)
    v_mfma_f32_16x16x32_bf16 v[88:91], v[200:203], a[0:3], v[88:91]
    s_waitcnt lgkmcnt(12)
    v_mfma_f32_16x16x32_bf16 v[92:95], v[204:207], a[0:3], v[92:95]
    s_add_u32 m0, s53, 8192
    s_nop 0
    buffer_load_dwordx4 v169, s[8:11], s30 offen offset:3072 nt lds
    v_mfma_f32_16x16x32_bf16 v[96:99], v[192:195], a[4:7], v[96:99]
    ds_read_b128 a[28:31], v233 offset:24576
    v_mfma_f32_16x16x32_bf16 v[100:103], v[196:199], a[4:7], v[100:103]
    v_mfma_f32_16x16x32_bf16 v[104:107], v[200:203], a[4:7], v[104:107]
    v_mfma_f32_16x16x32_bf16 v[108:111], v[204:207], a[4:7], v[108:111]
    v_mfma_f32_16x16x32_bf16 v[112:115], v[192:195], a[8:11], v[112:115]
    ds_read_b128 a[32:35], v233 offset:26624
    v_mfma_f32_16x16x32_bf16 v[116:119], v[196:199], a[8:11], v[116:119]
    v_mfma_f32_16x16x32_bf16 v[120:123], v[200:203], a[8:11], v[120:123]
    v_mfma_f32_16x16x32_bf16 v[124:127], v[204:207], a[8:11], v[124:127]
    s_waitcnt lgkmcnt(13)
    v_mfma_f32_16x16x32_bf16 v[128:131], v[192:195], a[12:15], v[128:131]
    ds_read_b128 a[36:39], v233 offset:28672
    v_mfma_f32_16x16x32_bf16 v[132:135], v[196:199], a[12:15], v[132:135]
    v_mfma_f32_16x16x32_bf16 v[136:139], v[200:203], a[12:15], v[136:139]
    v_mfma_f32_16x16x32_bf16 v[140:143], v[204:207], a[12:15], v[140:143]
    s_waitcnt lgkmcnt(13)
    v_mfma_f32_16x16x32_bf16 v[144:147], v[192:195], a[16:19], v[144:147]
    v_mfma_f32_16x16x32_bf16 v[148:151], v[196:199], a[16:19], v[148:151]
    v_mfma_f32_16x16x32_bf16 v[152:155], v[200:203], a[16:19], v[152:155]
    v_mfma_f32_16x16x32_bf16 v[156:159], v[204:207], a[16:19], v[156:159]
    s_waitcnt lgkmcnt(10)
    v_mfma_f32_16x16x32_bf16 v[80:83], v[208:211], a[20:23], v[80:83]
    s_waitcnt lgkmcnt(8)
    v_mfma_f32_16x16x32_bf16 v[84:87], v[212:215], a[20:23], v[84:87]
    s_waitcnt lgkmcnt(6)
    v_mfma_f32_16x16x32_bf16 v[88:91], v[216:219], a[20:23], v[88:91]
    s_waitcnt vmcnt(9)
    s_waitcnt lgkmcnt(0)
    s_barrier
    ds_read_b128 a[40:43], v232 offset:40960
    v_mfma_f32_16x16x32_bf16 v[92:95], v[220:223], a[20:23], v[92:95]
    ds_read_b128 a[44:47], v232 offset:43008
    v_mfma_f32_16x16x32_bf16 v[96:99], v[208:211], a[24:27], v[96:99]
    ds_read_b128 a[48:51], v232 offset:45056
    v_mfma_f32_16x16x32_bf16 v[100:103], v[212:215], a[24:27], v[100:103]
    v_mfma_f32_16x16x32_bf16 v[104:107], v[216:219], a[24:27], v[104:107]
    v_mfma_f32_16x16x32_bf16 v[108:111], v[220:223], a[24:27], v[108:111]
    v_mfma_f32_16x16x32_bf16 v[112:115], v[208:211], a[28:31], v[112:115]
    ds_read_b128 a[52:55], v232 offset:47104
    v_mfma_f32_16x16x32_bf16 v[116:119], v[212:215], a[28:31], v[116:119]
    v_mfma_f32_16x16x32_bf16 v[120:123], v[216:219], a[28:31], v[120:123]
    v_mfma_f32_16x16x32_bf16 v[124:127], v[220:223], a[28:31], v[124:127]
    v_mfma_f32_16x16x32_bf16 v[128:131], v[208:211], a[32:35], v[128:131]
    ds_read_b128 a[56:59], v232 offset:49152
    v_mfma_f32_16x16x32_bf16 v[132:135], v[212:215], a[32:35], v[132:135]
    v_mfma_f32_16x16x32_bf16 v[136:139], v[216:219], a[32:35], v[136:139]
    v_mfma_f32_16x16x32_bf16 v[140:143], v[220:223], a[32:35], v[140:143]
    v_mfma_f32_16x16x32_bf16 v[144:147], v[208:211], a[36:39], v[144:147]
    ds_read_b128 a[60:63], v233 offset:40960
    v_mfma_f32_16x16x32_bf16 v[148:151], v[212:215], a[36:39], v[148:151]
    v_mfma_f32_16x16x32_bf16 v[152:155], v[216:219], a[36:39], v[152:155]
    v_mfma_f32_16x16x32_bf16 v[156:159], v[220:223], a[36:39], v[156:159]
    s_waitcnt lgkmcnt(5)
    v_mfma_f32_16x16x32_bf16 v[0:3], v[192:195], a[40:43], v[0:3]
    ds_read_b128 a[0:3], v233 offset:43008
    v_mfma_f32_16x16x32_bf16 v[4:7], v[196:199], a[40:43], v[4:7]
    v_mfma_f32_16x16x32_bf16 v[8:11], v[200:203], a[40:43], v[8:11]
    v_mfma_f32_16x16x32_bf16 v[12:15], v[204:207], a[40:43], v[12:15]
    s_waitcnt lgkmcnt(5)
    v_mfma_f32_16x16x32_bf16 v[16:19], v[192:195], a[44:47], v[16:19]
    ds_read_b128 a[4:7], v233 offset:45056
    v_mfma_f32_16x16x32_bf16 v[20:23], v[196:199], a[44:47], v[20:23]
    v_mfma_f32_16x16x32_bf16 v[24:27], v[200:203], a[44:47], v[24:27]
    v_mfma_f32_16x16x32_bf16 v[28:31], v[204:207], a[44:47], v[28:31]
    s_waitcnt lgkmcnt(5)
    v_mfma_f32_16x16x32_bf16 v[32:35], v[192:195], a[48:51], v[32:35]
    ds_read_b128 a[8:11], v233 offset:47104
    v_mfma_f32_16x16x32_bf16 v[36:39], v[196:199], a[48:51], v[36:39]
    v_mfma_f32_16x16x32_bf16 v[40:43], v[200:203], a[48:51], v[40:43]
    v_mfma_f32_16x16x32_bf16 v[44:47], v[204:207], a[48:51], v[44:47]
    s_waitcnt lgkmcnt(5)
    v_mfma_f32_16x16x32_bf16 v[48:51], v[192:195], a[52:55], v[48:51]
    ds_read_b128 a[12:15], v233 offset:49152
    v_mfma_f32_16x16x32_bf16 v[52:55], v[196:199], a[52:55], v[52:55]
    v_mfma_f32_16x16x32_bf16 v[56:59], v[200:203], a[52:55], v[56:59]
    v_mfma_f32_16x16x32_bf16 v[60:63], v[204:207], a[52:55], v[60:63]
    s_waitcnt lgkmcnt(5)
    v_mfma_f32_16x16x32_bf16 v[64:67], v[192:195], a[56:59], v[64:67]
    v_mfma_f32_16x16x32_bf16 v[68:71], v[196:199], a[56:59], v[68:71]
    v_mfma_f32_16x16x32_bf16 v[72:75], v[200:203], a[56:59], v[72:75]
    v_mfma_f32_16x16x32_bf16 v[76:79], v[204:207], a[56:59], v[76:79]
    s_waitcnt lgkmcnt(4)
    v_mfma_f32_16x16x32_bf16 v[0:3], v[208:211], a[60:63], v[0:3]
    v_mfma_f32_16x16x32_bf16 v[4:7], v[212:215], a[60:63], v[4:7]
    v_mfma_f32_16x16x32_bf16 v[8:11], v[216:219], a[60:63], v[8:11]
    v_mfma_f32_16x16x32_bf16 v[12:15], v[220:223], a[60:63], v[12:15]
    s_waitcnt lgkmcnt(3)
    v_mfma_f32_16x16x32_bf16 v[16:19], v[208:211], a[0:3], v[16:19]
    v_mfma_f32_16x16x32_bf16 v[20:23], v[212:215], a[0:3], v[20:23]
    v_mfma_f32_16x16x32_bf16 v[24:27], v[216:219], a[0:3], v[24:27]
    v_mfma_f32_16x16x32_bf16 v[28:31], v[220:223], a[0:3], v[28:31]
    s_waitcnt lgkmcnt(2)
    v_mfma_f32_16x16x32_bf16 v[32:35], v[208:211], a[4:7], v[32:35]
    v_mfma_f32_16x16x32_bf16 v[36:39], v[212:215], a[4:7], v[36:39]
    v_mfma_f32_16x16x32_bf16 v[40:43], v[216:219], a[4:7], v[40:43]
    v_mfma_f32_16x16x32_bf16 v[44:47], v[220:223], a[4:7], v[44:47]
    s_waitcnt lgkmcnt(1)
    v_mfma_f32_16x16x32_bf16 v[48:51], v[208:211], a[8:11], v[48:51]
    v_mfma_f32_16x16x32_bf16 v[52:55], v[212:215], a[8:11], v[52:55]
    v_mfma_f32_16x16x32_bf16 v[56:59], v[216:219], a[8:11], v[56:59]
    v_mfma_f32_16x16x32_bf16 v[60:63], v[220:223], a[8:11], v[60:63]
    s_waitcnt lgkmcnt(0)
    v_mfma_f32_16x16x32_bf16 v[64:67], v[208:211], a[12:15], v[64:67]
    v_mfma_f32_16x16x32_bf16 v[68:71], v[212:215], a[12:15], v[68:71]
    v_mfma_f32_16x16x32_bf16 v[72:75], v[216:219], a[12:15], v[72:75]
    v_mfma_f32_16x16x32_bf16 v[76:79], v[220:223], a[12:15], v[76:79]
    s_waitcnt lgkmcnt(0)
    s_barrier
    s_add_u32 s38, s85, 2
    s_add_u32 s36, s38, s86
    s_and_b32 s36, s36, 15
    s_lshl_b32 s36, s36, 14
    s_add_u32 s36, s36, s42
    s_lshr_b32 s37, s38, 4
    s_lshl_b32 s37, s37, 25
    s_add_u32 s36, s36, s37
    s_cmp_lt_u32 s38, 32
    s_cselect_b32 s29, s36, 0x70000000
    s_add_u32 m0, s52, 16384
    s_nop 0
    buffer_load_dwordx4 v164, s[4:7], s29 offen nt lds
    buffer_load_dwordx4 v165, s[4:7], s29 offen offset:1024 nt lds
    buffer_load_dwordx4 v166, s[4:7], s29 offen offset:2048 nt lds
    buffer_load_dwordx4 v167, s[4:7], s29 offen offset:3072 nt lds
    v_mov_b32 v182, s54
    v_mov_b32 v183, s54
    s_mul_i32 s36, s84, 20
    s_lshl_b32 s37, s83, 1
    s_add_u32 s36, s36, s37
    s_lshl_b32 s36, s36, 10
    v_add_u32 v184, s36, v162
    v_pk_mul_f32 v[80:81], v[80:81], v[182:183]
    v_pk_mul_f32 v[82:83], v[82:83], v[182:183]
    v_pk_mul_f32 v[84:85], v[84:85], v[182:183]
    v_pk_mul_f32 v[86:87], v[86:87], v[182:183]
    v_cvt_pk_bf16_f32 v80, v80, v81
    v_cvt_pk_bf16_f32 v81, v82, v83
    v_cvt_pk_bf16_f32 v82, v84, v85
    v_cvt_pk_bf16_f32 v83, v86, v87
    ds_write_b128 v184, v[80:83] offset:0
    v_pk_mul_f32 v[88:89], v[88:89], v[182:183]
    v_pk_mul_f32 v[90:91], v[90:91], v[182:183]
    v_pk_mul_f32 v[92:93], v[92:93], v[182:183]
    v_pk_mul_f32 v[94:95], v[94:95], v[182:183]
    v_cvt_pk_bf16_f32 v88, v88, v89
    v_cvt_pk_bf16_f32 v89, v90, v91
    v_cvt_pk_bf16_f32 v90, v92, v93
    v_cvt_pk_bf16_f32 v91, v94, v95
    ds_write_b128 v184, v[88:91] offset:1024
    v_pk_mul_f32 v[96:97], v[96:97], v[182:183]
    v_pk_mul_f32 v[98:99], v[98:99], v[182:183]
    v_pk_mul_f32 v[100:101], v[100:101], v[182:183]
    v_pk_mul_f32 v[102:103], v[102:103], v[182:183]
    v_cvt_pk_bf16_f32 v96, v96, v97
    v_cvt_pk_bf16_f32 v97, v98, v99
    v_cvt_pk_bf16_f32 v98, v100, v101
    v_cvt_pk_bf16_f32 v99, v102, v103
    ds_write_b128 v184, v[96:99] offset:4096
    v_pk_mul_f32 v[104:105], v[104:105], v[182:183]
    v_pk_mul_f32 v[106:107], v[106:107], v[182:183]
    v_pk_mul_f32 v[108:109], v[108:109], v[182:183]
    v_pk_mul_f32 v[110:111], v[110:111], v[182:183]
    v_cvt_pk_bf16_f32 v104, v104, v105
    v_cvt_pk_bf16_f32 v105, v106, v107
    v_cvt_pk_bf16_f32 v106, v108, v109
    v_cvt_pk_bf16_f32 v107, v110, v111
    ds_write_b128 v184, v[104:107] offset:5120
    v_pk_mul_f32 v[112:113], v[112:113], v[182:183]
    v_pk_mul_f32 v[114:115], v[114:115], v[182:183]
    v_pk_mul_f32 v[116:117], v[116:117], v[182:183]
    v_pk_mul_f32 v[118:119], v[118:119], v[182:183]
    v_cvt_pk_bf16_f32 v112, v112, v113
    v_cvt_pk_bf16_f32 v113, v114, v115
    v_cvt_pk_bf16_f32 v114, v116, v117
    v_cvt_pk_bf16_f32 v115, v118, v119
    ds_write_b128 v184, v[112:115] offset:8192
    v_pk_mul_f32 v[120:121], v[120:121], v[182:183]
    v_pk_mul_f32 v[122:123], v[122:123], v[182:183]
    v_pk_mul_f32 v[124:125], v[124:125], v[182:183]
    v_pk_mul_f32 v[126:127], v[126:127], v[182:183]
    v_cvt_pk_bf16_f32 v120, v120, v121
    v_cvt_pk_bf16_f32 v121, v122, v123
    v_cvt_pk_bf16_f32 v122, v124, v125
    v_cvt_pk_bf16_f32 v123, v126, v127
    ds_write_b128 v184, v[120:123] offset:9216
    v_pk_mul_f32 v[128:129], v[128:129], v[182:183]
    v_pk_mul_f32 v[130:131], v[130:131], v[182:183]
    v_pk_mul_f32 v[132:133], v[132:133], v[182:183]
    v_pk_mul_f32 v[134:135], v[134:135], v[182:183]
    v_cvt_pk_bf16_f32 v128, v128, v129
    v_cvt_pk_bf16_f32 v129, v130, v131
    v_cvt_pk_bf16_f32 v130, v132, v133
    v_cvt_pk_bf16_f32 v131, v134, v135
    ds_write_b128 v184, v[128:131] offset:12288
    v_pk_mul_f32 v[136:137], v[136:137], v[182:183]
    v_pk_mul_f32 v[138:139], v[138:139], v[182:183]
    v_pk_mul_f32 v[140:141], v[140:141], v[182:183]
    v_pk_mul_f32 v[142:143], v[142:143], v[182:183]
    v_cvt_pk_bf16_f32 v136, v136, v137
    v_cvt_pk_bf16_f32 v137, v138, v139
    v_cvt_pk_bf16_f32 v138, v140, v141
    v_cvt_pk_bf16_f32 v139, v142, v143
    ds_write_b128 v184, v[136:139] offset:13312
    v_pk_mul_f32 v[144:145], v[144:145], v[182:183]
    v_pk_mul_f32 v[146:147], v[146:147], v[182:183]
    v_pk_mul_f32 v[148:149], v[148:149], v[182:183]
    v_pk_mul_f32 v[150:151], v[150:151], v[182:183]
    v_cvt_pk_bf16_f32 v144, v144, v145
    v_cvt_pk_bf16_f32 v145, v146, v147
    v_cvt_pk_bf16_f32 v146, v148, v149
    v_cvt_pk_bf16_f32 v147, v150, v151
    ds_write_b128 v184, v[144:147] offset:16384
    v_pk_mul_f32 v[152:153], v[152:153], v[182:183]
    v_pk_mul_f32 v[154:155], v[154:155], v[182:183]
    v_pk_mul_f32 v[156:157], v[156:157], v[182:183]
    v_pk_mul_f32 v[158:159], v[158:159], v[182:183]
    v_cvt_pk_bf16_f32 v152, v152, v153
    v_cvt_pk_bf16_f32 v153, v154, v155
    v_cvt_pk_bf16_f32 v154, v156, v157
    v_cvt_pk_bf16_f32 v155, v158, v159
    ds_write_b128 v184, v[152:155] offset:17408
    v_pk_mul_f32 v[0:1], v[0:1], v[182:183]
    v_pk_mul_f32 v[2:3], v[2:3], v[182:183]
    v_pk_mul_f32 v[4:5], v[4:5], v[182:183]
    v_pk_mul_f32 v[6:7], v[6:7], v[182:183]
    v_pk_mul_f32 v[8:9], v[8:9], v[182:183]
    v_pk_mul_f32 v[10:11], v[10:11], v[182:183]
    v_pk_mul_f32 v[12:13], v[12:13], v[182:183]
    v_pk_mul_f32 v[14:15], v[14:15], v[182:183]
    v_pk_mul_f32 v[16:17], v[16:17], v[182:183]
    v_pk_mul_f32 v[18:19], v[18:19], v[182:183]
    v_pk_mul_f32 v[20:21], v[20:21], v[182:183]
    v_pk_mul_f32 v[22:23], v[22:23], v[182:183]
    v_pk_mul_f32 v[24:25], v[24:25], v[182:183]
    v_pk_mul_f32 v[26:27], v[26:27], v[182:183]
    v_pk_mul_f32 v[28:29], v[28:29], v[182:183]
    v_pk_mul_f32 v[30:31], v[30:31], v[182:183]
    v_pk_mul_f32 v[32:33], v[32:33], v[182:183]
    v_pk_mul_f32 v[34:35], v[34:35], v[182:183]
    v_pk_mul_f32 v[36:37], v[36:37], v[182:183]
    v_pk_mul_f32 v[38:39], v[38:39], v[182:183]
    v_pk_mul_f32 v[40:41], v[40:41], v[182:183]
    v_pk_mul_f32 v[42:43], v[42:43], v[182:183]
    v_pk_mul_f32 v[44:45], v[44:45], v[182:183]
    v_pk_mul_f32 v[46:47], v[46:47], v[182:183]
    v_pk_mul_f32 v[48:49], v[48:49], v[182:183]
    v_pk_mul_f32 v[50:51], v[50:51], v[182:183]
    v_pk_mul_f32 v[52:53], v[52:53], v[182:183]
    v_pk_mul_f32 v[54:55], v[54:55], v[182:183]
    v_pk_mul_f32 v[56:57], v[56:57], v[182:183]
    v_pk_mul_f32 v[58:59], v[58:59], v[182:183]
    v_pk_mul_f32 v[60:61], v[60:61], v[182:183]
    v_pk_mul_f32 v[62:63], v[62:63], v[182:183]
    v_pk_mul_f32 v[64:65], v[64:65], v[182:183]
    v_pk_mul_f32 v[66:67], v[66:67], v[182:183]
    v_pk_mul_f32 v[68:69], v[68:69], v[182:183]
    v_pk_mul_f32 v[70:71], v[70:71], v[182:183]
    v_pk_mul_f32 v[72:73], v[72:73], v[182:183]
    v_pk_mul_f32 v[74:75], v[74:75], v[182:183]
    v_pk_mul_f32 v[76:77], v[76:77], v[182:183]
    v_pk_mul_f32 v[78:79], v[78:79], v[182:183]
    s_waitcnt lgkmcnt(0)
    v_cvt_pk_bf16_f32 v88, v0, v1
    v_cvt_pk_bf16_f32 v89, v2, v3
    v_cvt_pk_bf16_f32 v90, v4, v5
    v_cvt_pk_bf16_f32 v91, v6, v7
    v_cvt_pk_bf16_f32 v92, v8, v9
    v_cvt_pk_bf16_f32 v93, v10, v11
    v_cvt_pk_bf16_f32 v94, v12, v13
    v_cvt_pk_bf16_f32 v95, v14, v15
    v_cvt_pk_bf16_f32 v96, v16, v17
    v_cvt_pk_bf16_f32 v97, v18, v19
    v_cvt_pk_bf16_f32 v98, v20, v21
    v_cvt_pk_bf16_f32 v99, v22, v23
    v_cvt_pk_bf16_f32 v100, v24, v25
    v_cvt_pk_bf16_f32 v101, v26, v27
    v_cvt_pk_bf16_f32 v102, v28, v29
    v_cvt_pk_bf16_f32 v103, v30, v31
    v_cvt_pk_bf16_f32 v104, v32, v33
    v_cvt_pk_bf16_f32 v105, v34, v35
    v_cvt_pk_bf16_f32 v106, v36, v37
    v_cvt_pk_bf16_f32 v107, v38, v39
    v_cvt_pk_bf16_f32 v108, v40, v41
    v_cvt_pk_bf16_f32 v109, v42, v43
    v_cvt_pk_bf16_f32 v110, v44, v45
    v_cvt_pk_bf16_f32 v111, v46, v47
    v_cvt_pk_bf16_f32 v112, v48, v49
    v_cvt_pk_bf16_f32 v113, v50, v51
    v_cvt_pk_bf16_f32 v114, v52, v53
    v_cvt_pk_bf16_f32 v115, v54, v55
    v_cvt_pk_bf16_f32 v116, v56, v57
    v_cvt_pk_bf16_f32 v117, v58, v59
    v_cvt_pk_bf16_f32 v118, v60, v61
    v_cvt_pk_bf16_f32 v119, v62, v63
    v_cvt_pk_bf16_f32 v120, v64, v65
    v_cvt_pk_bf16_f32 v121, v66, v67
    v_cvt_pk_bf16_f32 v122, v68, v69
    v_cvt_pk_bf16_f32 v123, v70, v71
    v_cvt_pk_bf16_f32 v124, v72, v73
    v_cvt_pk_bf16_f32 v125, v74, v75
    v_cvt_pk_bf16_f32 v126, v76, v77
    v_cvt_pk_bf16_f32 v127, v78, v79
    v_mov_b32 v148, 0x3f803f80
    v_mov_b32 v149, 0x3f803f80
    v_mov_b32 v150, 0x3f803f80
    v_mov_b32 v151, 0x3f803f80
    s_waitcnt vmcnt(4)
    s_barrier
    s_mov_b32 s26, 0
    s_mov_b32 s27, 8192
    s_mov_b32 s28, 16384
    s_mov_b32 s30, s29
    s_add_u32 s38, s85, 3
    s_add_u32 s36, s38, s86
    s_and_b32 s36, s36, 15
    s_lshl_b32 s36, s36, 14
    s_add_u32 s36, s36, s42
    s_lshr_b32 s37, s38, 4
    s_lshl_b32 s37, s37, 25
    s_add_u32 s36, s36, s37
    s_cmp_lt_u32 s38, 32
    s_cselect_b32 s29, s36, 0x70000000
    s_add_u32 s39, s25, s26
    v_add_u32 v172, s39, v160
    v_xor_b32 v173, 64, v172
    v_xor_b32 v174, 128, v172
    v_xor_b32 v175, 192, v172
    ds_read_b128 v[24:27], v172 offset:0
    ds_read_b128 v[28:31], v173 offset:0
    ds_read_b128 v[32:35], v174 offset:0
    ds_read_b128 v[36:39], v175 offset:0
    ds_read_b128 v[40:43], v172 offset:4096
    ds_read_b128 v[44:47], v173 offset:4096
    ds_read_b128 v[48:51], v174 offset:4096
    ds_read_b128 v[52:55], v175 offset:4096
    s_waitcnt lgkmcnt(0)
    s_barrier
    s_add_u32 m0, s53, s28
    s_nop 0
    buffer_load_dwordx4 v168, s[8:11], s30 offen nt lds
    buffer_load_dwordx4 v169, s[8:11], s30 offen offset:1024 nt lds
    buffer_load_dwordx4 v168, s[8:11], s30 offen offset:2048 nt lds
    buffer_load_dwordx4 v169, s[8:11], s30 offen offset:3072 nt lds
    s_add_u32 m0, s52, s26
    s_nop 0
    buffer_load_dwordx4 v164, s[4:7], s29 offen nt lds
    buffer_load_dwordx4 v165, s[4:7], s29 offen offset:1024 nt lds
    buffer_load_dwordx4 v166, s[4:7], s29 offen offset:2048 nt lds
    buffer_load_dwordx4 v167, s[4:7], s29 offen offset:3072 nt lds
    s_mov_b32 s40, 0
L_attn_item:
    s_mul_i32 s36, s84, 20480
    v_add_u32 v184, s36, v162
    ds_read_b128 a[160:163], v184 offset:0
    ds_read_b128 a[164:167], v184 offset:1024
    ds_read_b128 a[168:171], v184 offset:2048
    ds_read_b128 a[172:175], v184 offset:3072
    ds_read_b128 a[176:179], v184 offset:4096
    ds_read_b128 a[180:183], v184 offset:5120
    ds_read_b128 a[184:187], v184 offset:6144
    ds_read_b128 a[188:191], v184 offset:7168
    ds_read_b128 a[192:195], v184 offset:8192
    ds_read_b128 a[196:199], v184 offset:9216
    ds_read_b128 a[200:203], v184 offset:10240
    ds_read_b128 a[204:207], v184 offset:11264
    ds_read_b128 a[208:211], v184 offset:12288
    ds_read_b128 a[212:215], v184 offset:13312
    ds_read_b128 a[216:219], v184 offset:14336
    ds_read_b128 a[220:223], v184 offset:15360
    ds_read_b128 a[224:227], v184 offset:16384
    ds_read_b128 a[228:231], v184 offset:17408
    ds_read_b128 a[232:235], v184 offset:18432
    ds_read_b128 a[236:239], v184 offset:19456
    s_waitcnt lgkmcnt(0)
    s_add_u32 s39, s82, s26
    v_add_u32 v232, s39, v161
    v_xor_b32 v233, 32, v232
    v_xor_b32 v234, 64, v232
    v_xor_b32 v235, 96, v232
    v_xor_b32 v236, 128, v232
    v_xor_b32 v237, 160, v232
    v_xor_b32 v238, 192, v232
    v_xor_b32 v239, 224, v232
    v_mfma_f32_16x16x32_bf16 v[0:3], v[24:27], a[160:163], 0
    v_mfma_f32_16x16x32_bf16 v[0:3], v[28:31], a[164:167], v[0:3]
    v_mfma_f32_16x16x32_bf16 v[0:3], v[32:35], a[168:171], v[0:3]
    v_mfma_f32_16x16x32_bf16 v[0:3], v[36:39], a[172:175], v[0:3]
    v_mfma_f32_16x16x32_bf16 v[4:7], v[40:43], a[160:163], 0
    v_mfma_f32_16x16x32_bf16 v[4:7], v[44:47], a[164:167], v[4:7]
    v_mfma_f32_16x16x32_bf16 v[4:7], v[48:51], a[168:171], v[4:7]
    v_mfma_f32_16x16x32_bf16 v[4:7], v[52:55], a[172:175], v[4:7]
    v_mfma_f32_16x16x32_bf16 v[8:11], v[24:27], a[176:179], 0
    ds_read_b64_tr_b16 v[56:57], v232 offset:0
    ds_read_b64_tr_b16 v[58:59], v232 offset:4096
    v_mfma_f32_16x16x32_bf16 v[8:11], v[28:31], a[180:183], v[8:11]
    v_exp_f32 v0, v0
    ds_read_b64_tr_b16 v[60:61], v233 offset:0
    ds_read_b64_tr_b16 v[62:63], v233 offset:4096
    v_mfma_f32_16x16x32_bf16 v[8:11], v[32:35], a[184:187], v[8:11]
    v_exp_f32 v1, v1
    ds_read_b64_tr_b16 v[64:65], v234 offset:0
    ds_read_b64_tr_b16 v[66:67], v234 offset:4096
    v_mfma_f32_16x16x32_bf16 v[8:11], v[36:39], a[188:191], v[8:11]
    v_exp_f32 v2, v2
    ds_read_b64_tr_b16 v[68:69], v235 offset:0
    ds_read_b64_tr_b16 v[70:71], v235 offset:4096
    v_mfma_f32_16x16x32_bf16 v[12:15], v[40:43], a[176:179], 0
    v_exp_f32 v3, v3
    v_exp_f32 v4, v4
    ds_read_b64_tr_b16 v[72:73], v236 offset:0
    ds_read_b64_tr_b16 v[74:75], v236 offset:4096
    v_mfma_f32_16x16x32_bf16 v[12:15], v[44:47], a[180:183], v[12:15]
    v_exp_f32 v5, v5
    ds_read_b64_tr_b16 v[76:77], v237 offset:0
    ds_read_b64_tr_b16 v[78:79], v237 offset:4096
    v_mfma_f32_16x16x32_bf16 v[12:15], v[48:51], a[184:187], v[12:15]
    v_exp_f32 v6, v6
    ds_read_b64_tr_b16 v[80:81], v238 offset:0
    ds_read_b64_tr_b16 v[82:83], v238 offset:4096
    v_mfma_f32_16x16x32_bf16 v[12:15], v[52:55], a[188:191], v[12:15]
    v_exp_f32 v7, v7
    ds_read_b64_tr_b16 v[84:85], v239 offset:0
    ds_read_b64_tr_b16 v[86:87], v239 offset:4096
    v_cvt_pk_bf16_f32 v16, v0, v1
    v_cvt_pk_bf16_f32 v17, v2, v3
    v_cvt_pk_bf16_f32 v18, v4, v5
    v_cvt_pk_bf16_f32 v19, v6, v7
    v_mfma_f32_16x16x32_bf16 v[0:3], v[24:27], a[192:195], 0
    s_waitcnt lgkmcnt(12)
    v_mfma_f32_16x16x32_bf16 a[0:3], v[56:59], v[16:19], 0
    s_add_u32 s85, s85, 1
    v_exp_f32 v8, v8
    v_mfma_f32_16x16x32_bf16 v[0:3], v[28:31], a[196:199], v[0:3]
    s_waitcnt lgkmcnt(10)
    v_exp_f32 v9, v9
    v_mfma_f32_16x16x32_bf16 a[4:7], v[60:63], v[16:19], 0
    s_mov_b32 s31, s27
    v_exp_f32 v10, v10
    v_mfma_f32_16x16x32_bf16 v[0:3], v[32:35], a[200:203], v[0:3]
    s_waitcnt lgkmcnt(8)
    v_exp_f32 v11, v11
    v_mfma_f32_16x16x32_bf16 a[8:11], v[64:67], v[16:19], 0
    s_mov_b32 s32, s28
    v_exp_f32 v12, v12
    v_mfma_f32_16x16x32_bf16 v[0:3], v[36:39], a[204:207], v[0:3]
    s_mov_b32 s33, s26
    v_exp_f32 v13, v13
    v_mfma_f32_16x16x32_bf16 a[12:15], v[68:71], v[16:19], 0
    s_waitcnt lgkmcnt(6)
    v_exp_f32 v14, v14
    v_mfma_f32_16x16x32_bf16 v[4:7], v[40:43], a[192:195], 0
    s_cmp_lt_u32 s85, 30
    s_cselect_b32 s35, s29, 0x70000000
    v_exp_f32 v15, v15
    v_mfma_f32_16x16x32_bf16 v[128:131], v[148:151], v[16:19], 0
    s_waitcnt lgkmcnt(4)
    v_cvt_pk_bf16_f32 v20, v8, v9
    v_cvt_pk_bf16_f32 v21, v10, v11
    v_mfma_f32_16x16x32_bf16 a[16:19], v[72:75], v[16:19], 0
    v_cvt_pk_bf16_f32 v22, v12, v13
    v_cvt_pk_bf16_f32 v23, v14, v15
    v_mfma_f32_16x16x32_bf16 v[4:7], v[44:47], a[196:199], v[4:7]
    s_waitcnt lgkmcnt(2)
    v_mfma_f32_16x16x32_bf16 a[20:23], v[76:79], v[16:19], 0
    v_mfma_f32_16x16x32_bf16 v[4:7], v[48:51], a[200:203], v[4:7]
    s_waitcnt lgkmcnt(0)
    v_mfma_f32_16x16x32_bf16 a[24:27], v[80:83], v[16:19], 0
    v_mfma_f32_16x16x32_bf16 v[4:7], v[52:55], a[204:207], v[4:7]
    v_mfma_f32_16x16x32_bf16 a[28:31], v[84:87], v[16:19], 0
    v_mfma_f32_16x16x32_bf16 v[8:11], v[24:27], a[208:211], 0
    v_mfma_f32_16x16x32_bf16 a[32:35], v[56:59], v[20:23], 0
    v_exp_f32 v0, v0
    v_mfma_f32_16x16x32_bf16 v[8:11], v[28:31], a[212:215], v[8:11]
    v_exp_f32 v1, v1
    v_mfma_f32_16x16x32_bf16 a[36:39], v[60:63], v[20:23], 0
    v_exp_f32 v2, v2
    v_mfma_f32_16x16x32_bf16 v[8:11], v[32:35], a[216:219], v[8:11]
    v_exp_f32 v3, v3
    v_mfma_f32_16x16x32_bf16 a[40:43], v[64:67], v[20:23], 0
    v_exp_f32 v4, v4
    v_mfma_f32_16x16x32_bf16 v[8:11], v[36:39], a[220:223], v[8:11]
    v_exp_f32 v5, v5
    v_mfma_f32_16x16x32_bf16 a[44:47], v[68:71], v[20:23], 0
    v_exp_f32 v6, v6
    v_mfma_f32_16x16x32_bf16 v[12:15], v[40:43], a[208:211], 0
    v_exp_f32 v7, v7
    v_mfma_f32_16x16x32_bf16 v[132:135], v[148:151], v[20:23], 0
    v_cvt_pk_bf16_f32 v16, v0, v1
    v_cvt_pk_bf16_f32 v17, v2, v3
    v_mfma_f32_16x16x32_bf16 a[48:51], v[72:75], v[20:23], 0
    v_cvt_pk_bf16_f32 v18, v4, v5
    v_cvt_pk_bf16_f32 v19, v6, v7
    v_mfma_f32_16x16x32_bf16 v[12:15], v[44:47], a[212:215], v[12:15]
    s_add_u32 s39, s25, s27
    v_add_u32 v172, s39, v160
    v_xor_b32 v173, 64, v172
    v_mfma_f32_16x16x32_bf16 a[52:55], v[76:79], v[20:23], 0
    v_xor_b32 v174, 128, v172
    v_xor_b32 v175, 192, v172
    v_mfma_f32_16x16x32_bf16 v[12:15], v[48:51], a[216:219], v[12:15]
    v_mfma_f32_16x16x32_bf16 a[56:59], v[80:83], v[20:23], 0
    v_mfma_f32_16x16x32_bf16 v[12:15], v[52:55], a[220:223], v[12:15]
    v_mfma_f32_16x16x32_bf16 a[60:63], v[84:87], v[20:23], 0
    v_mfma_f32_16x16x32_bf16 v[0:3], v[24:27], a[224:227], 0
    s_add_u32 s38, s85, 3
    ds_read_b128 v[24:27], v172 offset:0
    v_mfma_f32_16x16x32_bf16 a[64:67], v[56:59], v[16:19], 0
    s_add_u32 s36, s38, s86
    v_exp_f32 v8, v8
    v_mfma_f32_16x16x32_bf16 v[0:3], v[28:31], a[228:231], v[0:3]
    s_and_b32 s36, s36, 15
    ds_read_b128 v[28:31], v173 offset:0
    s_add_u32 s39, s82, s31
    v_add_u32 v232, s39, v161
    v_mfma_f32_16x16x32_bf16 a[68:71], v[60:63], v[16:19], 0
    s_lshl_b32 s36, s36, 14
    v_exp_f32 v9, v9
    v_mfma_f32_16x16x32_bf16 v[0:3], v[32:35], a[232:235], v[0:3]
    s_add_u32 s36, s36, s42
    ds_read_b128 v[32:35], v174 offset:0
    v_cvt_pk_bf16_f32 v20, v8, v9
    v_mfma_f32_16x16x32_bf16 a[72:75], v[64:67], v[16:19], 0
    s_lshr_b32 s37, s38, 4
    v_exp_f32 v10, v10
    v_mfma_f32_16x16x32_bf16 v[0:3], v[36:39], a[236:239], v[0:3]
    s_lshl_b32 s37, s37, 25
    ds_read_b128 v[36:39], v175 offset:0
    v_xor_b32 v233, 32, v232
    v_mfma_f32_16x16x32_bf16 a[76:79], v[68:71], v[16:19], 0
    s_add_u32 s36, s36, s37
    v_exp_f32 v11, v11
    v_mfma_f32_16x16x32_bf16 v[4:7], v[40:43], a[224:227], 0
    s_cmp_lt_u32 s38, 32
    s_cselect_b32 s34, s36, 0x70000000
    ds_read_b128 v[40:43], v172 offset:4096
    v_cvt_pk_bf16_f32 v21, v10, v11
    v_mfma_f32_16x16x32_bf16 v[136:139], v[148:151], v[16:19], 0
    v_exp_f32 v12, v12
    v_mfma_f32_16x16x32_bf16 a[80:83], v[72:75], v[16:19], 0
    v_exp_f32 v13, v13
    v_mfma_f32_16x16x32_bf16 v[4:7], v[44:47], a[228:231], v[4:7]
    ds_read_b128 v[44:47], v173 offset:4096
    v_cvt_pk_bf16_f32 v22, v12, v13
    v_mfma_f32_16x16x32_bf16 a[84:87], v[76:79], v[16:19], 0
    v_exp_f32 v14, v14
    v_mfma_f32_16x16x32_bf16 v[4:7], v[48:51], a[232:235], v[4:7]
    ds_read_b128 v[48:51], v174 offset:4096
    v_mfma_f32_16x16x32_bf16 a[88:91], v[80:83], v[16:19], 0
    v_exp_f32 v15, v15
    v_mfma_f32_16x16x32_bf16 v[4:7], v[52:55], a[236:239], v[4:7]
    ds_read_b128 v[52:55], v175 offset:4096
    v_cvt_pk_bf16_f32 v23, v14, v15
    v_mfma_f32_16x16x32_bf16 a[92:95], v[84:87], v[16:19], 0
    s_waitcnt lgkmcnt(7)
    v_mfma_f32_16x16x32_bf16 v[8:11], v[24:27], a[160:163], 0
    v_mfma_f32_16x16x32_bf16 a[96:99], v[56:59], v[20:23], 0
    s_waitcnt lgkmcnt(5)
    v_exp_f32 v0, v0
    v_mfma_f32_16x16x32_bf16 v[8:11], v[28:31], a[164:167], v[8:11]
    v_exp_f32 v1, v1
    v_mfma_f32_16x16x32_bf16 a[100:103], v[60:63], v[20:23], 0
    s_waitcnt lgkmcnt(4)
    v_exp_f32 v2, v2
    v_mfma_f32_16x16x32_bf16 v[8:11], v[32:35], a[168:171], v[8:11]
    v_exp_f32 v3, v3
    v_mfma_f32_16x16x32_bf16 a[104:107], v[64:67], v[20:23], 0
    s_waitcnt lgkmcnt(3)
    v_exp_f32 v4, v4
    v_mfma_f32_16x16x32_bf16 v[8:11], v[36:39], a[172:175], v[8:11]
    v_exp_f32 v5, v5
    v_mfma_f32_16x16x32_bf16 a[108:111], v[68:71], v[20:23], 0
    v_exp_f32 v6, v6
    v_mfma_f32_16x16x32_bf16 v[12:15], v[40:43], a[160:163], 0
    s_waitcnt vmcnt(8) lgkmcnt(0)
    s_barrier
    v_exp_f32 v7, v7
    v_mfma_f32_16x16x32_bf16 v[140:143], v[148:151], v[20:23], 0
    v_cvt_pk_bf16_f32 v16, v0, v1
    v_cvt_pk_bf16_f32 v17, v2, v3
    v_mfma_f32_16x16x32_bf16 a[112:115], v[72:75], v[20:23], 0
    v_cvt_pk_bf16_f32 v18, v4, v5
    v_cvt_pk_bf16_f32 v19, v6, v7
    v_mfma_f32_16x16x32_bf16 v[12:15], v[44:47], a[164:167], v[12:15]
    v_xor_b32 v234, 64, v232
    v_xor_b32 v235, 96, v232
    v_mfma_f32_16x16x32_bf16 a[116:119], v[76:79], v[20:23], 0
    v_xor_b32 v236, 128, v232
    v_xor_b32 v237, 160, v232
    v_mfma_f32_16x16x32_bf16 v[12:15], v[48:51], a[168:171], v[12:15]
    v_xor_b32 v238, 192, v232
    v_xor_b32 v239, 224, v232
    v_mfma_f32_16x16x32_bf16 a[120:123], v[80:83], v[20:23], 0
    v_mfma_f32_16x16x32_bf16 v[12:15], v[52:55], a[172:175], v[12:15]
    v_mfma_f32_16x16x32_bf16 a[124:127], v[84:87], v[20:23], 0
    v_mfma_f32_16x16x32_bf16 v[0:3], v[24:27], a[176:179], 0
    v_mfma_f32_16x16x32_bf16 a[128:131], v[56:59], v[16:19], 0
    ds_read_b64_tr_b16 v[56:57], v232 offset:0
    ds_read_b64_tr_b16 v[58:59], v232 offset:4096
    v_mfma_f32_16x16x32_bf16 v[0:3], v[28:31], a[180:183], v[0:3]
    v_exp_f32 v8, v8
    v_mfma_f32_16x16x32_bf16 a[132:135], v[60:63], v[16:19], 0
    ds_read_b64_tr_b16 v[60:61], v233 offset:0
    ds_read_b64_tr_b16 v[62:63], v233 offset:4096
    v_mfma_f32_16x16x32_bf16 v[0:3], v[32:35], a[184:187], v[0:3]
    v_exp_f32 v9, v9
    v_mfma_f32_16x16x32_bf16 a[136:139], v[64:67], v[16:19], 0
    ds_read_b64_tr_b16 v[64:65], v234 offset:0
    ds_read_b64_tr_b16 v[66:67], v234 offset:4096
    v_mfma_f32_16x16x32_bf16 v[0:3], v[36:39], a[188:191], v[0:3]
    v_exp_f32 v10, v10
    v_mfma_f32_16x16x32_bf16 a[140:143], v[68:71], v[16:19], 0
    ds_read_b64_tr_b16 v[68:69], v235 offset:0
    ds_read_b64_tr_b16 v[70:71], v235 offset:4096
    v_mfma_f32_16x16x32_bf16 v[4:7], v[40:43], a[176:179], 0
    v_exp_f32 v11, v11
    v_mfma_f32_16x16x32_bf16 v[144:147], v[148:151], v[16:19], 0
    v_exp_f32 v12, v12
    v_mfma_f32_16x16x32_bf16 a[144:147], v[72:75], v[16:19], 0
    ds_read_b64_tr_b16 v[72:73], v236 offset:0
    ds_read_b64_tr_b16 v[74:75], v236 offset:4096
    v_mfma_f32_16x16x32_bf16 v[4:7], v[44:47], a[180:183], v[4:7]
    v_exp_f32 v13, v13
    v_mfma_f32_16x16x32_bf16 a[148:151], v[76:79], v[16:19], 0
    ds_read_b64_tr_b16 v[76:77], v237 offset:0
    ds_read_b64_tr_b16 v[78:79], v237 offset:4096
    v_mfma_f32_16x16x32_bf16 v[4:7], v[48:51], a[184:187], v[4:7]
    v_exp_f32 v14, v14
    v_mfma_f32_16x16x32_bf16 a[152:155], v[80:83], v[16:19], 0
    ds_read_b64_tr_b16 v[80:81], v238 offset:0
    ds_read_b64_tr_b16 v[82:83], v238 offset:4096
    v_mfma_f32_16x16x32_bf16 v[4:7], v[52:55], a[188:191], v[4:7]
    v_exp_f32 v15, v15
    v_mfma_f32_16x16x32_bf16 a[156:159], v[84:87], v[16:19], 0
    ds_read_b64_tr_b16 v[84:85], v239 offset:0
    ds_read_b64_tr_b16 v[86:87], v239 offset:4096
    v_cvt_pk_bf16_f32 v20, v8, v9
    v_cvt_pk_bf16_f32 v21, v10, v11
    v_cvt_pk_bf16_f32 v22, v12, v13
    v_cvt_pk_bf16_f32 v23, v14, v15
    v_mfma_f32_16x16x32_bf16 v[8:11], v[24:27], a[192:195], 0
    s_waitcnt lgkmcnt(12)
    v_mfma_f32_16x16x32_bf16 a[0:3], v[56:59], v[20:23], a[0:3]
    s_add_u32 s85, s85, 1
    v_exp_f32 v0, v0
    v_mfma_f32_16x16x32_bf16 v[8:11], v[28:31], a[196:199], v[8:11]
    s_add_u32 m0, s53, s33
    v_exp_f32 v1, v1
    v_mfma_f32_16x16x32_bf16 a[4:7], v[60:63], v[20:23], a[4:7]
    s_waitcnt vmcnt(5)
    v_exp_f32 v2, v2
    v_mfma_f32_16x16x32_bf16 v[8:11], v[32:35], a[200:203], v[8:11]
    s_waitcnt lgkmcnt(8)
    buffer_load_dwordx4 v168, s[8:11], s35 offen nt lds
    v_mfma_f32_16x16x32_bf16 a[8:11], v[64:67], v[20:23], a[8:11]
    s_mov_b32 s26, s32
    v_exp_f32 v3, v3
    v_mfma_f32_16x16x32_bf16 v[8:11], v[36:39], a[204:207], v[8:11]
    s_mov_b32 s27, s33
    v_exp_f32 v4, v4
    v_mfma_f32_16x16x32_bf16 a[12:15], v[68:71], v[20:23], a[12:15]
    s_waitcnt lgkmcnt(6)
    v_exp_f32 v5, v5
    v_mfma_f32_16x16x32_bf16 v[12:15], v[40:43], a[192:195], 0
    s_mov_b32 s28, s31
    v_exp_f32 v6, v6
    v_mfma_f32_16x16x32_bf16 v[128:131], v[148:151], v[20:23], v[128:131]
    s_waitcnt lgkmcnt(4)
    v_exp_f32 v7, v7
    v_mfma_f32_16x16x32_bf16 a[16:19], v[72:75], v[20:23], a[16:19]
    s_cmp_lt_u32 s85, 30
    s_cselect_b32 s30, s34, 0x70000000
    v_cvt_pk_bf16_f32 v16, v0, v1
    v_cvt_pk_bf16_f32 v17, v2, v3
    v_mfma_f32_16x16x32_bf16 v[12:15], v[44:47], a[196:199], v[12:15]
    s_waitcnt vmcnt(5)
    v_cvt_pk_bf16_f32 v18, v4, v5
    v_cvt_pk_bf16_f32 v19, v6, v7
    v_mfma_f32_16x16x32_bf16 a[20:23], v[76:79], v[20:23], a[20:23]
    buffer_load_dwordx4 v169, s[8:11], s35 offen offset:1024 nt lds
    v_mfma_f32_16x16x32_bf16 v[12:15], v[48:51], a[200:203], v[12:15]
    s_waitcnt lgkmcnt(0)
    v_mfma_f32_16x16x32_bf16 a[24:27], v[80:83], v[20:23], a[24:27]
    v_mfma_f32_16x16x32_bf16 v[12:15], v[52:55], a[204:207], v[12:15]
    v_mfma_f32_16x16x32_bf16 a[28:31], v[84:87], v[20:23], a[28:31]
    v_mfma_f32_16x16x32_bf16 v[0:3], v[24:27], a[208:211], 0
    v_mfma_f32_16x16x32_bf16 a[32:35], v[56:59], v[16:19], a[32:35]
    v_exp_f32 v8, v8
    v_mfma_f32_16x16x32_bf16 v[0:3], v[28:31], a[212:215], v[0:3]
    s_add_u32 m0, s53, s33
    v_exp_f32 v9, v9
    v_mfma_f32_16x16x32_bf16 a[36:39], v[60:63], v[16:19], a[36:39]
    s_waitcnt vmcnt(5)
    v_exp_f32 v10, v10
    v_mfma_f32_16x16x32_bf16 v[0:3], v[32:35], a[216:219], v[0:3]
    buffer_load_dwordx4 v168, s[8:11], s35 offen offset:2048 nt lds
    v_mfma_f32_16x16x32_bf16 a[40:43], v[64:67], v[16:19], a[40:43]
    v_exp_f32 v11, v11
    v_mfma_f32_16x16x32_bf16 v[0:3], v[36:39], a[220:223], v[0:3]
    v_exp_f32 v12, v12
    v_mfma_f32_16x16x32_bf16 a[44:47], v[68:71], v[16:19], a[44:47]
    v_exp_f32 v13, v13
    v_mfma_f32_16x16x32_bf16 v[4:7], v[40:43], a[208:211], 0
    v_exp_f32 v14, v14
    v_mfma_f32_16x16x32_bf16 v[132:135], v[148:151], v[16:19], v[132:135]
    v_exp_f32 v15, v15
    v_mfma_f32_16x16x32_bf16 a[48:51], v[72:75], v[16:19], a[48:51]
    v_cvt_pk_bf16_f32 v20, v8, v9
    v_cvt_pk_bf16_f32 v21, v10, v11
    v_mfma_f32_16x16x32_bf16 v[4:7], v[44:47], a[212:215], v[4:7]
    s_waitcnt vmcnt(5)
    v_cvt_pk_bf16_f32 v22, v12, v13
    v_cvt_pk_bf16_f32 v23, v14, v15
    v_mfma_f32_16x16x32_bf16 a[52:55], v[76:79], v[16:19], a[52:55]
    buffer_load_dwordx4 v169, s[8:11], s35 offen offset:3072 nt lds
    v_mfma_f32_16x16x32_bf16 v[4:7], v[48:51], a[216:219], v[4:7]
    s_add_u32 s39, s25, s32
    v_add_u32 v172, s39, v160
    v_xor_b32 v173, 64, v172
    v_mfma_f32_16x16x32_bf16 a[56:59], v[80:83], v[16:19], a[56:59]
    v_xor_b32 v174, 128, v172
    v_xor_b32 v175, 192, v172
    v_mfma_f32_16x16x32_bf16 v[4:7], v[52:55], a[220:223], v[4:7]
    v_mfma_f32_16x16x32_bf16 a[60:63], v[84:87], v[16:19], a[60:63]
    v_mfma_f32_16x16x32_bf16 v[8:11], v[24:27], a[224:227], 0
    s_add_u32 s38, s85, 3
    ds_read_b128 v[24:27], v172 offset:0
    v_mfma_f32_16x16x32_bf16 a[64:67], v[56:59], v[20:23], a[64:67]
    s_add_u32 s36, s38, s86
    v_exp_f32 v0, v0
    v_mfma_f32_16x16x32_bf16 v[8:11], v[28:31], a[228:231], v[8:11]
    s_and_b32 s36, s36, 15
    ds_read_b128 v[28:31], v173 offset:0
    v_exp_f32 v1, v1
    v_mfma_f32_16x16x32_bf16 a[68:71], v[60:63], v[20:23], a[68:71]
    s_add_u32 m0, s52, s31
    v_exp_f32 v2, v2
    v_mfma_f32_16x16x32_bf16 v[8:11], v[32:35], a[232:235], v[8:11]
    s_waitcnt vmcnt(5)
    ds_read_b128 v[32:35], v174 offset:0
    v_cvt_pk_bf16_f32 v16, v0, v1
    v_mfma_f32_16x16x32_bf16 a[72:75], v[64:67], v[20:23], a[72:75]
    s_lshl_b32 s36, s36, 14
    buffer_load_dwordx4 v164, s[4:7], s34 offen nt lds
    v_mfma_f32_16x16x32_bf16 v[8:11], v[36:39], a[236:239], v[8:11]
    s_add_u32 s36, s36, s42
    ds_read_b128 v[36:39], v175 offset:0
    s_add_u32 s39, s82, s26
    v_add_u32 v232, s39, v161
    v_mfma_f32_16x16x32_bf16 a[76:79], v[68:71], v[20:23], a[76:79]
    s_lshr_b32 s37, s38, 4
    v_exp_f32 v3, v3
    v_mfma_f32_16x16x32_bf16 v[12:15], v[40:43], a[224:227], 0
    s_lshl_b32 s37, s37, 25
    ds_read_b128 v[40:43], v172 offset:4096
    v_cvt_pk_bf16_f32 v17, v2, v3
    v_mfma_f32_16x16x32_bf16 v[136:139], v[148:151], v[20:23], v[136:139]
    s_add_u32 s36, s36, s37
    v_exp_f32 v4, v4
    v_mfma_f32_16x16x32_bf16 a[80:83], v[72:75], v[20:23], a[80:83]
    s_cmp_lt_u32 s38, 32
    s_cselect_b32 s29, s36, 0x70000000
    v_exp_f32 v5, v5
    v_mfma_f32_16x16x32_bf16 v[12:15], v[44:47], a[228:231], v[12:15]
    s_waitcnt vmcnt(5)
    ds_read_b128 v[44:47], v173 offset:4096
    v_cvt_pk_bf16_f32 v18, v4, v5
    v_mfma_f32_16x16x32_bf16 a[84:87], v[76:79], v[20:23], a[84:87]
    buffer_load_dwordx4 v165, s[4:7], s34 offen offset:1024 nt lds
    v_mfma_f32_16x16x32_bf16 v[12:15], v[48:51], a[232:235], v[12:15]
    ds_read_b128 v[48:51], v174 offset:4096
    v_xor_b32 v233, 32, v232
    v_mfma_f32_16x16x32_bf16 a[88:91], v[80:83], v[20:23], a[88:91]
    v_exp_f32 v6, v6
    v_mfma_f32_16x16x32_bf16 v[12:15], v[52:55], a[236:239], v[12:15]
    ds_read_b128 v[52:55], v175 offset:4096
    v_mfma_f32_16x16x32_bf16 a[92:95], v[84:87], v[20:23], a[92:95]
    v_exp_f32 v7, v7
    s_nop 0
    v_cvt_pk_bf16_f32 v19, v6, v7
    s_waitcnt lgkmcnt(7)
    v_mfma_f32_16x16x32_bf16 v[0:3], v[24:27], a[160:163], 0
    v_mfma_f32_16x16x32_bf16 a[96:99], v[56:59], v[16:19], a[96:99]
    s_waitcnt lgkmcnt(5)
    v_exp_f32 v8, v8
    v_mfma_f32_16x16x32_bf16 v[0:3], v[28:31], a[164:167], v[0:3]
    s_add_u32 m0, s52, s31
    v_exp_f32 v9, v9
    v_mfma_f32_16x16x32_bf16 a[100:103], v[60:63], v[16:19], a[100:103]
    s_waitcnt vmcnt(5)
    v_exp_f32 v10, v10
    v_mfma_f32_16x16x32_bf16 v[0:3], v[32:35], a[168:171], v[0:3]
    buffer_load_dwordx4 v166, s[4:7], s34 offen offset:2048 nt lds
    v_mfma_f32_16x16x32_bf16 a[104:107], v[64:67], v[16:19], a[104:107]
    s_waitcnt lgkmcnt(3)
    v_exp_f32 v11, v11
    v_mfma_f32_16x16x32_bf16 v[0:3], v[36:39], a[172:175], v[0:3]
    v_exp_f32 v12, v12
    v_mfma_f32_16x16x32_bf16 a[108:111], v[68:71], v[16:19], a[108:111]
    v_exp_f32 v13, v13
    v_mfma_f32_16x16x32_bf16 v[4:7], v[40:43], a[160:163], 0
    s_waitcnt lgkmcnt(0)
    s_barrier
    v_exp_f32 v14, v14
    v_mfma_f32_16x16x32_bf16 v[140:143], v[148:151], v[16:19], v[140:143]
    v_exp_f32 v15, v15
    v_mfma_f32_16x16x32_bf16 a[112:115], v[72:75], v[16:19], a[112:115]
    v_cvt_pk_bf16_f32 v20, v8, v9
    v_cvt_pk_bf16_f32 v21, v10, v11
    v_mfma_f32_16x16x32_bf16 v[4:7], v[44:47], a[164:167], v[4:7]
    s_waitcnt vmcnt(5)
    v_cvt_pk_bf16_f32 v22, v12, v13
    v_cvt_pk_bf16_f32 v23, v14, v15
    v_mfma_f32_16x16x32_bf16 a[116:119], v[76:79], v[16:19], a[116:119]
    buffer_load_dwordx4 v167, s[4:7], s34 offen offset:3072 nt lds
    v_mfma_f32_16x16x32_bf16 v[4:7], v[48:51], a[168:171], v[4:7]
    v_xor_b32 v234, 64, v232
    v_xor_b32 v235, 96, v232
    v_mfma_f32_16x16x32_bf16 a[120:123], v[80:83], v[16:19], a[120:123]
    v_xor_b32 v236, 128, v232
    v_xor_b32 v237, 160, v232
    v_mfma_f32_16x16x32_bf16 v[4:7], v[52:55], a[172:175], v[4:7]
    v_xor_b32 v238, 192, v232
    v_xor_b32 v239, 224, v232
    v_mfma_f32_16x16x32_bf16 a[124:127], v[84:87], v[16:19], a[124:127]
    s_cmp_eq_u32 s40, 1
    s_cbranch_scc0 L_attn_nopub
    s_add_u32 s96, s80, 0x5000000
    s_addc_u32 s97, s81, 0
    s_mov_b32 s98, 32768
    s_mov_b32 s99, 0x20000
    s_cmp_lg_u32 s24, 0
    s_cbranch_scc1 L_attn_f1
    v_mov_b32 v180, 1
    v_mov_b32 v181, 0
    s_mov_b64 exec, 1
    buffer_store_dword v180, v181, s[96:99], s90 offen sc0 sc1
    s_mov_b64 exec, -1
L_attn_f1:
L_attn_nopub:
    s_mov_b32 s41, 7
L_attn_loop:
    s_nop 2
    v_mfma_f32_16x16x32_bf16 v[8:11], v[24:27], a[176:179], 0
    v_mfma_f32_16x16x32_bf16 a[128:131], v[56:59], v[20:23], a[128:131]
    ds_read_b64_tr_b16 v[56:57], v232 offset:0
    ds_read_b64_tr_b16 v[58:59], v232 offset:4096
    v_mfma_f32_16x16x32_bf16 v[8:11], v[28:31], a[180:183], v[8:11]
    v_exp_f32 v0, v0
    v_mfma_f32_16x16x32_bf16 a[132:135], v[60:63], v[20:23], a[132:135]
    ds_read_b64_tr_b16 v[60:61], v233 offset:0
    ds_read_b64_tr_b16 v[62:63], v233 offset:4096
    v_mfma_f32_16x16x32_bf16 v[8:11], v[32:35], a[184:187], v[8:11]
    v_exp_f32 v1, v1
    v_mfma_f32_16x16x32_bf16 a[136:139], v[64:67], v[20:23], a[136:139]
    ds_read_b64_tr_b16 v[64:65], v234 offset:0
    ds_read_b64_tr_b16 v[66:67], v234 offset:4096
    v_mfma_f32_16x16x32_bf16 v[8:11], v[36:39], a[188:191], v[8:11]
    v_exp_f32 v2, v2
    v_mfma_f32_16x16x32_bf16 a[140:143], v[68:71], v[20:23], a[140:143]
    ds_read_b64_tr_b16 v[68:69], v235 offset:0
    ds_read_b64_tr_b16 v[70:71], v235 offset:4096
    v_mfma_f32_16x16x32_bf16 v[12:15], v[40:43], a[176:179], 0
    v_exp_f32 v3, v3
    v_mfma_f32_16x16x32_bf16 v[144:147], v[148:151], v[20:23], v[144:147]
    v_exp_f32 v4, v4
    v_mfma_f32_16x16x32_bf16 a[144:147], v[72:75], v[20:23], a[144:147]
    ds_read_b64_tr_b16 v[72:73], v236 offset:0
    ds_read_b64_tr_b16 v[74:75], v236 offset:4096
    v_mfma_f32_16x16x32_bf16 v[12:15], v[44:47], a[180:183], v[12:15]
    v_exp_f32 v5, v5
    v_mfma_f32_16x16x32_bf16 a[148:151], v[76:79], v[20:23], a[148:151]
    ds_read_b64_tr_b16 v[76:77], v237 offset:0
    ds_read_b64_tr_b16 v[78:79], v237 offset:4096
    v_mfma_f32_16x16x32_bf16 v[12:15], v[48:51], a[184:187], v[12:15]
    v_exp_f32 v6, v6
    v_mfma_f32_16x16x32_bf16 a[152:155], v[80:83], v[20:23], a[152:155]
    ds_read_b64_tr_b16 v[80:81], v238 offset:0
    ds_read_b64_tr_b16 v[82:83], v238 offset:4096
    v_mfma_f32_16x16x32_bf16 v[12:15], v[52:55], a[188:191], v[12:15]
    v_exp_f32 v7, v7
    v_mfma_f32_16x16x32_bf16 a[156:159], v[84:87], v[20:23], a[156:159]
    ds_read_b64_tr_b16 v[84:85], v239 offset:0
    ds_read_b64_tr_b16 v[86:87], v239 offset:4096
    v_cvt_pk_bf16_f32 v16, v0, v1
    v_cvt_pk_bf16_f32 v17, v2, v3
    v_cvt_pk_bf16_f32 v18, v4, v5
    v_cvt_pk_bf16_f32 v19, v6, v7
    v_mfma_f32_16x16x32_bf16 v[0:3], v[24:27], a[192:195], 0
    s_waitcnt lgkmcnt(12)
    v_mfma_f32_16x16x32_bf16 a[0:3], v[56:59], v[16:19], a[0:3]
    s_add_u32 s85, s85, 1
    v_exp_f32 v8, v8
    v_mfma_f32_16x16x32_bf16 v[0:3], v[28:31], a[196:199], v[0:3]
    s_add_u32 m0, s53, s28
    v_exp_f32 v9, v9
    v_mfma_f32_16x16x32_bf16 a[4:7], v[60:63], v[16:19], a[4:7]
    s_waitcnt vmcnt(5)
    v_exp_f32 v10, v10
    v_mfma_f32_16x16x32_bf16 v[0:3], v[32:35], a[200:203], v[0:3]
    s_waitcnt lgkmcnt(8)
    buffer_load_dwordx4 v168, s[8:11], s30 offen nt lds
    v_mfma_f32_16x16x32_bf16 a[8:11], v[64:67], v[16:19], a[8:11]
    s_mov_b32 s31, s27
    v_exp_f32 v11, v11
    v_mfma_f32_16x16x32_bf16 v[0:3], v[36:39], a[204:207], v[0:3]
    s_mov_b32 s32, s28
    v_exp_f32 v12, v12
    v_mfma_f32_16x16x32_bf16 a[12:15], v[68:71], v[16:19], a[12:15]
    s_waitcnt lgkmcnt(6)
    v_exp_f32 v13, v13
    v_mfma_f32_16x16x32_bf16 v[4:7], v[40:43], a[192:195], 0
    s_mov_b32 s33, s26
    v_exp_f32 v14, v14
    v_mfma_f32_16x16x32_bf16 v[128:131], v[148:151], v[16:19], v[128:131]
    s_waitcnt lgkmcnt(4)
    v_exp_f32 v15, v15
    v_mfma_f32_16x16x32_bf16 a[16:19], v[72:75], v[16:19], a[16:19]
    s_cmp_lt_u32 s85, 30
    s_cselect_b32 s35, s29, 0x70000000
    v_cvt_pk_bf16_f32 v20, v8, v9
    v_cvt_pk_bf16_f32 v21, v10, v11
    v_mfma_f32_16x16x32_bf16 v[4:7], v[44:47], a[196:199], v[4:7]
    s_waitcnt vmcnt(5)
    v_cvt_pk_bf16_f32 v22, v12, v13
    v_cvt_pk_bf16_f32 v23, v14, v15
    v_mfma_f32_16x16x32_bf16 a[20:23], v[76:79], v[16:19], a[20:23]
    buffer_load_dwordx4 v169, s[8:11], s30 offen offset:1024 nt lds
    v_mfma_f32_16x16x32_bf16 v[4:7], v[48:51], a[200:203], v[4:7]
    s_waitcnt lgkmcnt(0)
    v_mfma_f32_16x16x32_bf16 a[24:27], v[80:83], v[16:19], a[24:27]
    v_mfma_f32_16x16x32_bf16 v[4:7], v[52:55], a[204:207], v[4:7]
    v_mfma_f32_16x16x32_bf16 a[28:31], v[84:87], v[16:19], a[28:31]
    v_mfma_f32_16x16x32_bf16 v[8:11], v[24:27], a[208:211], 0
    v_mfma_f32_16x16x32_bf16 a[32:35], v[56:59], v[20:23], a[32:35]
    v_exp_f32 v0, v0
    v_mfma_f32_16x16x32_bf16 v[8:11], v[28:31], a[212:215], v[8:11]
    s_add_u32 m0, s53, s28
    v_exp_f32 v1, v1
    v_mfma_f32_16x16x32_bf16 a[36:39], v[60:63], v[20:23], a[36:39]
    s_waitcnt vmcnt(5)
    v_exp_f32 v2, v2
    v_mfma_f32_16x16x32_bf16 v[8:11], v[32:35], a[216:219], v[8:11]
    buffer_load_dwordx4 v168, s[8:11], s30 offen offset:2048 nt lds
    v_mfma_f32_16x16x32_bf16 a[40:43], v[64:67], v[20:23], a[40:43]
    v_exp_f32 v3, v3
    v_mfma_f32_16x16x32_bf16 v[8:11], v[36:39], a[220:223], v[8:11]
    v_exp_f32 v4, v4
    v_mfma_f32_16x16x32_bf16 a[44:47], v[68:71], v[20:23], a[44:47]
    v_exp_f32 v5, v5
    v_mfma_f32_16x16x32_bf16 v[12:15], v[40:43], a[208:211], 0
    v_exp_f32 v6, v6
    v_mfma_f32_16x16x32_bf16 v[132:135], v[148:151], v[20:23], v[132:135]
    v_exp_f32 v7, v7
    v_mfma_f32_16x16x32_bf16 a[48:51], v[72:75], v[20:23], a[48:51]
    v_cvt_pk_bf16_f32 v16, v0, v1
    v_cvt_pk_bf16_f32 v17, v2, v3
    v_mfma_f32_16x16x32_bf16 v[12:15], v[44:47], a[212:215], v[12:15]
    s_waitcnt vmcnt(5)
    v_cvt_pk_bf16_f32 v18, v4, v5
    v_cvt_pk_bf16_f32 v19, v6, v7
    v_mfma_f32_16x16x32_bf16 a[52:55], v[76:79], v[20:23], a[52:55]
    buffer_load_dwordx4 v169, s[8:11], s30 offen offset:3072 nt lds
    v_mfma_f32_16x16x32_bf16 v[12:15], v[48:51], a[216:219], v[12:15]
    s_add_u32 s39, s25, s27
    v_add_u32 v172, s39, v160
    v_xor_b32 v173, 64, v172
    v_mfma_f32_16x16x32_bf16 a[56:59], v[80:83], v[20:23], a[56:59]
    v_xor_b32 v174, 128, v172
    v_xor_b32 v175, 192, v172
    v_mfma_f32_16x16x32_bf16 v[12:15], v[52:55], a[220:223], v[12:15]
    v_mfma_f32_16x16x32_bf16 a[60:63], v[84:87], v[20:23], a[60:63]
    v_mfma_f32_16x16x32_bf16 v[0:3], v[24:27], a[224:227], 0
    s_add_u32 s38, s85, 3
    ds_read_b128 v[24:27], v172 offset:0
    v_mfma_f32_16x16x32_bf16 a[64:67], v[56:59], v[16:19], a[64:67]
    s_add_u32 s36, s38, s86
    v_exp_f32 v8, v8
    v_mfma_f32_16x16x32_bf16 v[0:3], v[28:31], a[228:231], v[0:3]
    s_and_b32 s36, s36, 15
    ds_read_b128 v[28:31], v173 offset:0
    v_exp_f32 v9, v9
    v_mfma_f32_16x16x32_bf16 a[68:71], v[60:63], v[16:19], a[68:71]
    s_add_u32 m0, s52, s26
    v_exp_f32 v10, v10
    v_mfma_f32_16x16x32_bf16 v[0:3], v[32:35], a[232:235], v[0:3]
    s_waitcnt vmcnt(5)
    ds_read_b128 v[32:35], v174 offset:0
    v_cvt_pk_bf16_f32 v20, v8, v9
    v_mfma_f32_16x16x32_bf16 a[72:75], v[64:67], v[16:19], a[72:75]
    s_lshl_b32 s36, s36, 14
    buffer_load_dwordx4 v164, s[4:7], s29 offen nt lds
    v_mfma_f32_16x16x32_bf16 v[0:3], v[36:39], a[236:239], v[0:3]
    s_add_u32 s36, s36, s42
    ds_read_b128 v[36:39], v175 offset:0
    s_add_u32 s39, s82, s31
    v_add_u32 v232, s39, v161
    v_mfma_f32_16x16x32_bf16 a[76:79], v[68:71], v[16:19], a[76:79]
    s_lshr_b32 s37, s38, 4
    v_exp_f32 v11, v11
    v_mfma_f32_16x16x32_bf16 v[4:7], v[40:43], a[224:227], 0
    s_lshl_b32 s37, s37, 25
    ds_read_b128 v[40:43], v172 offset:4096
    v_cvt_pk_bf16_f32 v21, v10, v11
    v_mfma_f32_16x16x32_bf16 v[136:139], v[148:151], v[16:19], v[136:139]
    s_add_u32 s36, s36, s37
    v_exp_f32 v12, v12
    v_mfma_f32_16x16x32_bf16 a[80:83], v[72:75], v[16:19], a[80:83]
    s_cmp_lt_u32 s38, 32
    s_cselect_b32 s34, s36, 0x70000000
    v_exp_f32 v13, v13
    v_mfma_f32_16x16x32_bf16 v[4:7], v[44:47], a[228:231], v[4:7]
    s_waitcnt vmcnt(5)
    ds_read_b128 v[44:47], v173 offset:4096
    v_cvt_pk_bf16_f32 v22, v12, v13
    v_mfma_f32_16x16x32_bf16 a[84:87], v[76:79], v[16:19], a[84:87]
    buffer_load_dwordx4 v165, s[4:7], s29 offen offset:1024 nt lds
    v_mfma_f32_16x16x32_bf16 v[4:7], v[48:51], a[232:235], v[4:7]
    ds_read_b128 v[48:51], v174 offset:4096
    v_xor_b32 v233, 32, v232
    v_mfma_f32_16x16x32_bf16 a[88:91], v[80:83], v[16:19], a[88:91]
    v_exp_f32 v14, v14
    v_mfma_f32_16x16x32_bf16 v[4:7], v[52:55], a[236:239], v[4:7]
    ds_read_b128 v[52:55], v175 offset:4096
    v_mfma_f32_16x16x32_bf16 a[92:95], v[84:87], v[16:19], a[92:95]
    v_exp_f32 v15, v15
    s_nop 0
    v_cvt_pk_bf16_f32 v23, v14, v15
    s_waitcnt lgkmcnt(7)
    v_mfma_f32_16x16x32_bf16 v[8:11], v[24:27], a[160:163], 0
    v_mfma_f32_16x16x32_bf16 a[96:99], v[56:59], v[20:23], a[96:99]
    s_waitcnt lgkmcnt(5)
    v_exp_f32 v0, v0
    v_mfma_f32_16x16x32_bf16 v[8:11], v[28:31], a[164:167], v[8:11]
    s_add_u32 m0, s52, s26
    v_exp_f32 v1, v1
    v_mfma_f32_16x16x32_bf16 a[100:103], v[60:63], v[20:23], a[100:103]
    s_waitcnt vmcnt(5)
    v_exp_f32 v2, v2
    v_mfma_f32_16x16x32_bf16 v[8:11], v[32:35], a[168:171], v[8:11]
    buffer_load_dwordx4 v166, s[4:7], s29 offen offset:2048 nt lds
    v_mfma_f32_16x16x32_bf16 a[104:107], v[64:67], v[20:23], a[104:107]
    s_waitcnt lgkmcnt(3)
    v_exp_f32 v3, v3
    v_mfma_f32_16x16x32_bf16 v[8:11], v[36:39], a[172:175], v[8:11]
    v_exp_f32 v4, v4
    v_mfma_f32_16x16x32_bf16 a[108:111], v[68:71], v[20:23], a[108:111]
    v_exp_f32 v5, v5
    v_mfma_f32_16x16x32_bf16 v[12:15], v[40:43], a[160:163], 0
    s_waitcnt lgkmcnt(0)
    s_barrier
    v_exp_f32 v6, v6
    v_mfma_f32_16x16x32_bf16 v[140:143], v[148:151], v[20:23], v[140:143]
    v_exp_f32 v7, v7
    v_mfma_f32_16x16x32_bf16 a[112:115], v[72:75], v[20:23], a[112:115]
    v_cvt_pk_bf16_f32 v16, v0, v1
    v_cvt_pk_bf16_f32 v17, v2, v3
    v_mfma_f32_16x16x32_bf16 v[12:15], v[44:47], a[164:167], v[12:15]
    s_waitcnt vmcnt(5)
    v_cvt_pk_bf16_f32 v18, v4, v5
    v_cvt_pk_bf16_f32 v19, v6, v7
    v_mfma_f32_16x16x32_bf16 a[116:119], v[76:79], v[20:23], a[116:119]
    buffer_load_dwordx4 v167, s[4:7], s29 offen offset:3072 nt lds
    v_mfma_f32_16x16x32_bf16 v[12:15], v[48:51], a[168:171], v[12:15]
    v_xor_b32 v234, 64, v232
    v_xor_b32 v235, 96, v232
    v_mfma_f32_16x16x32_bf16 a[120:123], v[80:83], v[20:23], a[120:123]
    v_xor_b32 v236, 128, v232
    v_xor_b32 v237, 160, v232
    v_mfma_f32_16x16x32_bf16 v[12:15], v[52:55], a[172:175], v[12:15]
    v_xor_b32 v238, 192, v232
    v_xor_b32 v239, 224, v232
    v_mfma_f32_16x16x32_bf16 a[124:127], v[84:87], v[20:23], a[124:127]
    v_mfma_f32_16x16x32_bf16 v[0:3], v[24:27], a[176:179], 0
    v_mfma_f32_16x16x32_bf16 a[128:131], v[56:59], v[16:19], a[128:131]
    ds_read_b64_tr_b16 v[56:57], v232 offset:0
    ds_read_b64_tr_b16 v[58:59], v232 offset:4096
    v_mfma_f32_16x16x32_bf16 v[0:3], v[28:31], a[180:183], v[0:3]
    v_exp_f32 v8, v8
    v_mfma_f32_16x16x32_bf16 a[132:135], v[60:63], v[16:19], a[132:135]
    ds_read_b64_tr_b16 v[60:61], v233 offset:0
    ds_read_b64_tr_b16 v[62:63], v233 offset:4096
    v_mfma_f32_16x16x32_bf16 v[0:3], v[32:35], a[184:187], v[0:3]
    v_exp_f32 v9, v9
    v_mfma_f32_16x16x32_bf16 a[136:139], v[64:67], v[16:19], a[136:139]
    ds_read_b64_tr_b16 v[64:65], v234 offset:0
    ds_read_b64_tr_b16 v[66:67], v234 offset:4096
    v_mfma_f32_16x16x32_bf16 v[0:3], v[36:39], a[188:191], v[0:3]
    v_exp_f32 v10, v10
    v_mfma_f32_16x16x32_bf16 a[140:143], v[68:71], v[16:19], a[140:143]
    ds_read_b64_tr_b16 v[68:69], v235 offset:0
    ds_read_b64_tr_b16 v[70:71], v235 offset:4096
    v_mfma_f32_16x16x32_bf16 v[4:7], v[40:43], a[176:179], 0
    v_exp_f32 v11, v11
    v_mfma_f32_16x16x32_bf16 v[144:147], v[148:151], v[16:19], v[144:147]
    v_exp_f32 v12, v12
    v_mfma_f32_16x16x32_bf16 a[144:147], v[72:75], v[16:19], a[144:147]
    ds_read_b64_tr_b16 v[72:73], v236 offset:0
    ds_read_b64_tr_b16 v[74:75], v236 offset:4096
    v_mfma_f32_16x16x32_bf16 v[4:7], v[44:47], a[180:183], v[4:7]
    v_exp_f32 v13, v13
    v_mfma_f32_16x16x32_bf16 a[148:151], v[76:79], v[16:19], a[148:151]
    ds_read_b64_tr_b16 v[76:77], v237 offset:0
    ds_read_b64_tr_b16 v[78:79], v237 offset:4096
    v_mfma_f32_16x16x32_bf16 v[4:7], v[48:51], a[184:187], v[4:7]
    v_exp_f32 v14, v14
    v_mfma_f32_16x16x32_bf16 a[152:155], v[80:83], v[16:19], a[152:155]
    ds_read_b64_tr_b16 v[80:81], v238 offset:0
    ds_read_b64_tr_b16 v[82:83], v238 offset:4096
    v_mfma_f32_16x16x32_bf16 v[4:7], v[52:55], a[188:191], v[4:7]
    v_exp_f32 v15, v15
    v_mfma_f32_16x16x32_bf16 a[156:159], v[84:87], v[16:19], a[156:159]
    ds_read_b64_tr_b16 v[84:85], v239 offset:0
    ds_read_b64_tr_b16 v[86:87], v239 offset:4096
    v_cvt_pk_bf16_f32 v20, v8, v9
    v_cvt_pk_bf16_f32 v21, v10, v11
    v_cvt_pk_bf16_f32 v22, v12, v13
    v_cvt_pk_bf16_f32 v23, v14, v15
    v_mfma_f32_16x16x32_bf16 v[8:11], v[24:27], a[192:195], 0
    s_waitcnt lgkmcnt(12)
    v_mfma_f32_16x16x32_bf16 a[0:3], v[56:59], v[20:23], a[0:3]
    s_add_u32 s85, s85, 1
    v_exp_f32 v0, v0
    v_mfma_f32_16x16x32_bf16 v[8:11], v[28:31], a[196:199], v[8:11]
    s_add_u32 m0, s53, s33
    v_exp_f32 v1, v1
    v_mfma_f32_16x16x32_bf16 a[4:7], v[60:63], v[20:23], a[4:7]
    s_waitcnt vmcnt(5)
    v_exp_f32 v2, v2
    v_mfma_f32_16x16x32_bf16 v[8:11], v[32:35], a[200:203], v[8:11]
    s_waitcnt lgkmcnt(8)
    buffer_load_dwordx4 v168, s[8:11], s35 offen nt lds
    v_mfma_f32_16x16x32_bf16 a[8:11], v[64:67], v[20:23], a[8:11]
    s_mov_b32 s26, s32
    v_exp_f32 v3, v3
    v_mfma_f32_16x16x32_bf16 v[8:11], v[36:39], a[204:207], v[8:11]
    s_mov_b32 s27, s33
    v_exp_f32 v4, v4
    v_mfma_f32_16x16x32_bf16 a[12:15], v[68:71], v[20:23], a[12:15]
    s_waitcnt lgkmcnt(6)
    v_exp_f32 v5, v5
    v_mfma_f32_16x16x32_bf16 v[12:15], v[40:43], a[192:195], 0
    s_mov_b32 s28, s31
    v_exp_f32 v6, v6
    v_mfma_f32_16x16x32_bf16 v[128:131], v[148:151], v[20:23], v[128:131]
    s_waitcnt lgkmcnt(4)
    v_exp_f32 v7, v7
    v_mfma_f32_16x16x32_bf16 a[16:19], v[72:75], v[20:23], a[16:19]
    s_cmp_lt_u32 s85, 30
    s_cselect_b32 s30, s34, 0x70000000
    v_cvt_pk_bf16_f32 v16, v0, v1
    v_cvt_pk_bf16_f32 v17, v2, v3
    v_mfma_f32_16x16x32_bf16 v[12:15], v[44:47], a[196:199], v[12:15]
    s_waitcnt vmcnt(5)
    v_cvt_pk_bf16_f32 v18, v4, v5
    v_cvt_pk_bf16_f32 v19, v6, v7
    v_mfma_f32_16x16x32_bf16 a[20:23], v[76:79], v[20:23], a[20:23]
    buffer_load_dwordx4 v169, s[8:11], s35 offen offset:1024 nt lds
    v_mfma_f32_16x16x32_bf16 v[12:15], v[48:51], a[200:203], v[12:15]
    s_waitcnt lgkmcnt(0)
    v_mfma_f32_16x16x32_bf16 a[24:27], v[80:83], v[20:23], a[24:27]
    v_mfma_f32_16x16x32_bf16 v[12:15], v[52:55], a[204:207], v[12:15]
    v_mfma_f32_16x16x32_bf16 a[28:31], v[84:87], v[20:23], a[28:31]
    v_mfma_f32_16x16x32_bf16 v[0:3], v[24:27], a[208:211], 0
    v_mfma_f32_16x16x32_bf16 a[32:35], v[56:59], v[16:19], a[32:35]
    v_exp_f32 v8, v8
    v_mfma_f32_16x16x32_bf16 v[0:3], v[28:31], a[212:215], v[0:3]
    s_add_u32 m0, s53, s33
    v_exp_f32 v9, v9
    v_mfma_f32_16x16x32_bf16 a[36:39], v[60:63], v[16:19], a[36:39]
    s_waitcnt vmcnt(5)
    v_exp_f32 v10, v10
    v_mfma_f32_16x16x32_bf16 v[0:3], v[32:35], a[216:219], v[0:3]
    buffer_load_dwordx4 v168, s[8:11], s35 offen offset:2048 nt lds
    v_mfma_f32_16x16x32_bf16 a[40:43], v[64:67], v[16:19], a[40:43]
    v_exp_f32 v11, v11
    v_mfma_f32_16x16x32_bf16 v[0:3], v[36:39], a[220:223], v[0:3]
    v_exp_f32 v12, v12
    v_mfma_f32_16x16x32_bf16 a[44:47], v[68:71], v[16:19], a[44:47]
    v_exp_f32 v13, v13
    v_mfma_f32_16x16x32_bf16 v[4:7], v[40:43], a[208:211], 0
    v_exp_f32 v14, v14
    v_mfma_f32_16x16x32_bf16 v[132:135], v[148:151], v[16:19], v[132:135]
    v_exp_f32 v15, v15
    v_mfma_f32_16x16x32_bf16 a[48:51], v[72:75], v[16:19], a[48:51]
    v_cvt_pk_bf16_f32 v20, v8, v9
    v_cvt_pk_bf16_f32 v21, v10, v11
    v_mfma_f32_16x16x32_bf16 v[4:7], v[44:47], a[212:215], v[4:7]
    s_waitcnt vmcnt(5)
    v_cvt_pk_bf16_f32 v22, v12, v13
    v_cvt_pk_bf16_f32 v23, v14, v15
    v_mfma_f32_16x16x32_bf16 a[52:55], v[76:79], v[16:19], a[52:55]
    buffer_load_dwordx4 v169, s[8:11], s35 offen offset:3072 nt lds
    v_mfma_f32_16x16x32_bf16 v[4:7], v[48:51], a[216:219], v[4:7]
    s_add_u32 s39, s25, s32
    v_add_u32 v172, s39, v160
    v_xor_b32 v173, 64, v172
    v_mfma_f32_16x16x32_bf16 a[56:59], v[80:83], v[16:19], a[56:59]
    v_xor_b32 v174, 128, v172
    v_xor_b32 v175, 192, v172
    v_mfma_f32_16x16x32_bf16 v[4:7], v[52:55], a[220:223], v[4:7]
    v_mfma_f32_16x16x32_bf16 a[60:63], v[84:87], v[16:19], a[60:63]
    v_mfma_f32_16x16x32_bf16 v[8:11], v[24:27], a[224:227], 0
    s_add_u32 s38, s85, 3
    ds_read_b128 v[24:27], v172 offset:0
    v_mfma_f32_16x16x32_bf16 a[64:67], v[56:59], v[20:23], a[64:67]
    s_add_u32 s36, s38, s86
    v_exp_f32 v0, v0
    v_mfma_f32_16x16x32_bf16 v[8:11], v[28:31], a[228:231], v[8:11]
    s_and_b32 s36, s36, 15
    ds_read_b128 v[28:31], v173 offset:0
    v_exp_f32 v1, v1
    v_mfma_f32_16x16x32_bf16 a[68:71], v[60:63], v[20:23], a[68:71]
    s_add_u32 m0, s52, s31
    v_exp_f32 v2, v2
    v_mfma_f32_16x16x32_bf16 v[8:11], v[32:35], a[232:235], v[8:11]
    s_waitcnt vmcnt(5)
    ds_read_b128 v[32:35], v174 offset:0
    v_cvt_pk_bf16_f32 v16, v0, v1
    v_mfma_f32_16x16x32_bf16 a[72:75], v[64:67], v[20:23], a[72:75]
    s_lshl_b32 s36, s36, 14
    buffer_load_dwordx4 v164, s[4:7], s34 offen nt lds
    v_mfma_f32_16x16x32_bf16 v[8:11], v[36:39], a[236:239], v[8:11]
    s_add_u32 s36, s36, s42
    ds_read_b128 v[36:39], v175 offset:0
    s_add_u32 s39, s82, s26
    v_add_u32 v232, s39, v161
    v_mfma_f32_16x16x32_bf16 a[76:79], v[68:71], v[20:23], a[76:79]
    s_lshr_b32 s37, s38, 4
    v_exp_f32 v3, v3
    v_mfma_f32_16x16x32_bf16 v[12:15], v[40:43], a[224:227], 0
    s_lshl_b32 s37, s37, 25
    ds_read_b128 v[40:43], v172 offset:4096
    v_cvt_pk_bf16_f32 v17, v2, v3
    v_mfma_f32_16x16x32_bf16 v[136:139], v[148:151], v[20:23], v[136:139]
    s_add_u32 s36, s36, s37
    v_exp_f32 v4, v4
    v_mfma_f32_16x16x32_bf16 a[80:83], v[72:75], v[20:23], a[80:83]
    s_cmp_lt_u32 s38, 32
    s_cselect_b32 s29, s36, 0x70000000
    v_exp_f32 v5, v5
    v_mfma_f32_16x16x32_bf16 v[12:15], v[44:47], a[228:231], v[12:15]
    s_waitcnt vmcnt(5)
    ds_read_b128 v[44:47], v173 offset:4096
    v_cvt_pk_bf16_f32 v18, v4, v5
    v_mfma_f32_16x16x32_bf16 a[84:87], v[76:79], v[20:23], a[84:87]
    buffer_load_dwordx4 v165, s[4:7], s34 offen offset:1024 nt lds
    v_mfma_f32_16x16x32_bf16 v[12:15], v[48:51], a[232:235], v[12:15]
    ds_read_b128 v[48:51], v174 offset:4096
    v_xor_b32 v233, 32, v232
    v_mfma_f32_16x16x32_bf16 a[88:91], v[80:83], v[20:23], a[88:91]
    v_exp_f32 v6, v6
    v_mfma_f32_16x16x32_bf16 v[12:15], v[52:55], a[236:239], v[12:15]
    ds_read_b128 v[52:55], v175 offset:4096
    v_mfma_f32_16x16x32_bf16 a[92:95], v[84:87], v[20:23], a[92:95]
    v_exp_f32 v7, v7
    s_nop 0
    v_cvt_pk_bf16_f32 v19, v6, v7
    s_waitcnt lgkmcnt(7)
    v_mfma_f32_16x16x32_bf16 v[0:3], v[24:27], a[160:163], 0
    v_mfma_f32_16x16x32_bf16 a[96:99], v[56:59], v[16:19], a[96:99]
    s_waitcnt lgkmcnt(5)
    v_exp_f32 v8, v8
    v_mfma_f32_16x16x32_bf16 v[0:3], v[28:31], a[164:167], v[0:3]
    s_add_u32 m0, s52, s31
    v_exp_f32 v9, v9
    v_mfma_f32_16x16x32_bf16 a[100:103], v[60:63], v[16:19], a[100:103]
    s_waitcnt vmcnt(5)
    v_exp_f32 v10, v10
    v_mfma_f32_16x16x32_bf16 v[0:3], v[32:35], a[168:171], v[0:3]
    buffer_load_dwordx4 v166, s[4:7], s34 offen offset:2048 nt lds
    v_mfma_f32_16x16x32_bf16 a[104:107], v[64:67], v[16:19], a[104:107]
    s_waitcnt lgkmcnt(3)
    v_exp_f32 v11, v11
    v_mfma_f32_16x16x32_bf16 v[0:3], v[36:39], a[172:175], v[0:3]
    v_exp_f32 v12, v12
    v_mfma_f32_16x16x32_bf16 a[108:111], v[68:71], v[16:19], a[108:111]
    v_exp_f32 v13, v13
    v_mfma_f32_16x16x32_bf16 v[4:7], v[40:43], a[160:163], 0
    s_waitcnt lgkmcnt(0)
    s_barrier
    v_exp_f32 v14, v14
    v_mfma_f32_16x16x32_bf16 v[140:143], v[148:151], v[16:19], v[140:143]
    v_exp_f32 v15, v15
    v_mfma_f32_16x16x32_bf16 a[112:115], v[72:75], v[16:19], a[112:115]
    v_cvt_pk_bf16_f32 v20, v8, v9
    v_cvt_pk_bf16_f32 v21, v10, v11
    v_mfma_f32_16x16x32_bf16 v[4:7], v[44:47], a[164:167], v[4:7]
    s_waitcnt vmcnt(5)
    v_cvt_pk_bf16_f32 v22, v12, v13
    v_cvt_pk_bf16_f32 v23, v14, v15
    v_mfma_f32_16x16x32_bf16 a[116:119], v[76:79], v[16:19], a[116:119]
    buffer_load_dwordx4 v167, s[4:7], s34 offen offset:3072 nt lds
    v_mfma_f32_16x16x32_bf16 v[4:7], v[48:51], a[168:171], v[4:7]
    v_xor_b32 v234, 64, v232
    v_xor_b32 v235, 96, v232
    v_mfma_f32_16x16x32_bf16 a[120:123], v[80:83], v[16:19], a[120:123]
    v_xor_b32 v236, 128, v232
    v_xor_b32 v237, 160, v232
    v_mfma_f32_16x16x32_bf16 v[4:7], v[52:55], a[172:175], v[4:7]
    v_xor_b32 v238, 192, v232
    v_xor_b32 v239, 224, v232
    v_mfma_f32_16x16x32_bf16 a[124:127], v[84:87], v[16:19], a[124:127]
    s_sub_u32 s41, s41, 1
    s_cmp_lg_u32 s41, 0
    s_cbranch_scc1 L_attn_loop
    s_nop 1
    v_mfma_f32_16x16x32_bf16 v[144:147], v[148:151], v[20:23], v[144:147]
    v_mfma_f32_16x16x32_bf16 a[128:131], v[56:59], v[20:23], a[128:131]
    v_mfma_f32_16x16x32_bf16 a[132:135], v[60:63], v[20:23], a[132:135]
    v_mfma_f32_16x16x32_bf16 a[136:139], v[64:67], v[20:23], a[136:139]
    v_mfma_f32_16x16x32_bf16 a[140:143], v[68:71], v[20:23], a[140:143]
    v_mfma_f32_16x16x32_bf16 a[144:147], v[72:75], v[20:23], a[144:147]
    v_mfma_f32_16x16x32_bf16 a[148:151], v[76:79], v[20:23], a[148:151]
    v_mfma_f32_16x16x32_bf16 a[152:155], v[80:83], v[20:23], a[152:155]
    v_mfma_f32_16x16x32_bf16 a[156:159], v[84:87], v[20:23], a[156:159]
    s_waitcnt lgkmcnt(0)
    s_nop 7
    s_cmp_eq_u32 s40, 1
    s_cbranch_scc0 L_attn_nodrain
    s_waitcnt vmcnt(0)
L_attn_nodrain:
    v_subrev_u32 v180, 98304, v162
    v_lshrrev_b32 v181, 2, v180
    v_add_u32 v181, 139264, v181
    s_mul_i32 s36, s24, 1280
    v_add_u32 v182, s36, v181
    ds_write_b32 v182, v128 offset:0
    ds_write_b32 v182, v132 offset:256
    ds_write_b32 v182, v136 offset:512
    ds_write_b32 v182, v140 offset:768
    ds_write_b32 v182, v144 offset:1024
    s_waitcnt lgkmcnt(0)
    s_barrier
    ds_read_b32 v192, v181 offset:0
    ds_read_b32 v193, v181 offset:256
    ds_read_b32 v194, v181 offset:512
    ds_read_b32 v195, v181 offset:768
    ds_read_b32 v196, v181 offset:1024
    ds_read_b32 v197, v181 offset:1280
    ds_read_b32 v198, v181 offset:1536
    ds_read_b32 v199, v181 offset:1792
    ds_read_b32 v200, v181 offset:2048
    ds_read_b32 v201, v181 offset:2304
    ds_read_b32 v202, v181 offset:2560
    ds_read_b32 v203, v181 offset:2816
    ds_read_b32 v204, v181 offset:3072
    ds_read_b32 v205, v181 offset:3328
    ds_read_b32 v206, v181 offset:3584
    ds_read_b32 v207, v181 offset:3840
    ds_read_b32 v208, v181 offset:4096
    ds_read_b32 v209, v181 offset:4352
    ds_read_b32 v210, v181 offset:4608
    ds_read_b32 v211, v181 offset:4864
    s_waitcnt lgkmcnt(0)
    v_add_f32 v192, v192, v202
    v_add_f32 v197, v197, v207
    v_add_f32 v193, v193, v203
    v_add_f32 v198, v198, v208
    v_add_f32 v194, v194, v204
    v_add_f32 v199, v199, v209
    v_add_f32 v195, v195, v205
    v_add_f32 v200, v200, v210
    v_add_f32 v196, v196, v206
    v_add_f32 v201, v201, v211
    v_add_f32 v0, v192, v193
    v_min3_f32 v1, v192, v193, v194
    v_add_f32 v0, v0, v194
    v_add_f32 v0, v0, v195
    v_add_f32 v0, v0, v196
    v_add_f32 v0, v0, v197
    v_add_f32 v0, v0, v198
    v_add_f32 v0, v0, v199
    v_add_f32 v0, v0, v200
    v_add_f32 v0, v0, v201
    v_min3_f32 v1, v1, v195, v196
    v_min3_f32 v1, v1, v197, v198
    v_min3_f32 v1, v1, v199, v200
    v_min_f32 v1, v1, v201
    v_mov_b32 v2, 0x49800000
    v_mov_b32 v3, 0x35800000
    v_cmp_nle_f32 s[36:37], v0, v2
    v_cmp_nge_f32 s[38:39], v1, v3
    s_cmp_eq_u32 s84, 0
    s_cselect_b64 vcc, -1, 0
    s_nop 1
    v_cndmask_b32 v128, v197, v192, vcc
    v_cndmask_b32 v132, v198, v193, vcc
    v_cndmask_b32 v136, v199, v194, vcc
    v_cndmask_b32 v140, v200, v195, vcc
    v_cndmask_b32 v144, v201, v196, vcc
    v_rcp_f32 v128, v128
    v_rcp_f32 v132, v132
    v_rcp_f32 v136, v136
    v_rcp_f32 v140, v140
    v_rcp_f32 v144, v144
    s_or_b64 s[36:37], s[36:37], s[38:39]
    s_cmp_lg_u64 s[36:37], 0
    s_cbranch_scc1 L_attn_slow
L_attn_oex:
    s_cmp_eq_u32 s40, 1
    s_cbranch_scc0 L_attn_nowo
    s_cmp_ge_u32 s2, 240
    s_cbranch_scc1 L_attn_nowo
    s_and_b32 s25, s2, 3
    s_lshr_b32 s43, s2, 3
    s_mul_i32 s26, s43, 43
    s_lshr_b32 s26, s26, 7
    s_mul_i32 s37, s26, 3
    s_sub_u32 s27, s43, s37
    s_mul_i32 s28, s26, 3
    s_mul_i32 s37, s27, 5
    s_add_u32 s28, s28, s37
    s_and_b32 s28, s28, 15
    s_sub_u32 s4, s92, 4096
    s_subb_u32 s5, s93, 0
    s_mov_b32 s6, 4722688
    s_mov_b32 s7, 0x20000
    s_mov_b32 s8, s80
    s_mov_b32 s9, s81
    s_mov_b32 s10, 20971520
    s_mov_b32 s11, 0x20000
    s_add_u32 s12, s80, 33554432
    s_addc_u32 s13, s81, 0
    s_mov_b32 s14, 12582912
    s_mov_b32 s15, 0x20000
    s_add_u32 s16, s80, 0x5000000
    s_addc_u32 s17, s81, 0
    s_mov_b32 s18, 32768
    s_mov_b32 s19, 0x20000
    s_lshl_b32 s36, s25, 10
    s_lshl_b32 s37, s24, 4
    s_add_u32 s36, s36, s37
    s_mul_i32 s36, s36, 1152
    s_mul_i32 s37, s27, 384
    s_add_u32 s29, s36, s37
    s_add_u32 s29, s29, 4096
    s_mul_i32 s36, s51, 80
    s_lshl_b32 s37, s26, 3
    s_add_u32 s36, s36, s37
    s_lshl_b32 s37, s24, 1
    s_add_u32 s36, s36, s37
    s_lshl_b32 s36, s36, 17
    s_lshl_b32 s37, s25, 15
    s_add_u32 s30, s36, s37
    s_mul_i32 s31, s24, 6144
    s_mul_i32 s35, s2, 49152
    s_mul_i32 s36, s24, 12288
    s_add_u32 s35, s35, s36
    s_add_u32 s34, s28, 0
    s_and_b32 s34, s34, 15
    s_mul_i32 s34, s34, 73728
    s_add_u32 s34, s34, s29
    s_add_u32 m0, s31, 0
    s_add_u32 s32, s34, 0
    buffer_load_dwordx4 v253, s[4:7], s32 offen offset:0 lds
    s_add_u32 s32, s34, 4294966272
    buffer_load_dwordx4 v254, s[4:7], s32 offen offset:1024 lds
    s_add_u32 s32, s34, 4294965248
    buffer_load_dwordx4 v255, s[4:7], s32 offen offset:2048 lds
    s_add_u32 m0, s31, 3072
    s_add_u32 s32, s34, 9216
    buffer_load_dwordx4 v253, s[4:7], s32 offen offset:0 lds
    s_add_u32 s32, s34, 8192
    buffer_load_dwordx4 v254, s[4:7], s32 offen offset:1024 lds
    s_add_u32 s32, s34, 7168
    buffer_load_dwordx4 v255, s[4:7], s32 offen offset:2048 lds
L_attn_nowo:
    s_lshl_b32 s36, s24, 12
    v_add_u32 v172, s36, v162
    s_xor_b32 s37, s24, 2
    s_lshl_b32 s36, s37, 12
    v_add_u32 v173, s36, v162
    s_mul_i32 s37, s40, 5242880
    s_add_u32 s55, s48, s37
    ds_write_b128 v172, a[16:19] offset:0
    ds_write_b128 v172, a[20:23] offset:1024
    ds_write_b128 v172, a[24:27] offset:2048
    ds_write_b128 v172, a[28:31] offset:3072
    s_waitcnt lgkmcnt(0)
    s_barrier
    ds_read_b128 v[192:195], v173 offset:0
    ds_read_b128 v[196:199], v173 offset:1024
    ds_read_b128 v[200:203], v173 offset:2048
    ds_read_b128 v[204:207], v173 offset:3072
    ds_write_b128 v172, a[48:51] offset:16384
    ds_write_b128 v172, a[52:55] offset:17408
    ds_write_b128 v172, a[56:59] offset:18432
    ds_write_b128 v172, a[60:63] offset:19456
    s_cmp_eq_u32 s40, 0
    s_cbranch_scc0 L_attn_nh0
    s_add_u32 m0, s53, s28
    s_nop 0
    buffer_load_dwordx4 v168, s[8:11], s30 offen nt lds
    buffer_load_dwordx4 v169, s[8:11], s30 offen offset:1024 nt lds
L_attn_nh0:
    v_accvgpr_read_b32 v208, a0
    v_accvgpr_read_b32 v209, a1
    v_accvgpr_read_b32 v210, a2
    v_accvgpr_read_b32 v211, a3
    v_accvgpr_read_b32 v212, a4
    v_accvgpr_read_b32 v213, a5
    v_accvgpr_read_b32 v214, a6
    v_accvgpr_read_b32 v215, a7
    v_accvgpr_read_b32 v216, a8
    v_accvgpr_read_b32 v217, a9
    v_accvgpr_read_b32 v218, a10
    v_accvgpr_read_b32 v219, a11
    v_accvgpr_read_b32 v220, a12
    v_accvgpr_read_b32 v221, a13
    v_accvgpr_read_b32 v222, a14
    v_accvgpr_read_b32 v223, a15
    s_waitcnt lgkmcnt(4)
    v_pk_add_f32 v[192:193], v[192:193], v[208:209]
    v_pk_add_f32 v[194:195], v[194:195], v[210:211]
    v_pk_add_f32 v[196:197], v[196:197], v[212:213]
    v_pk_add_f32 v[198:199], v[198:199], v[214:215]
    v_pk_add_f32 v[200:201], v[200:201], v[216:217]
    v_pk_add_f32 v[202:203], v[202:203], v[218:219]
    v_pk_add_f32 v[204:205], v[204:205], v[220:221]
    v_pk_add_f32 v[206:207], v[206:207], v[222:223]
    v_pk_mul_f32 v[192:193], v[192:193], v[128:129] op_sel_hi:[1,0]
    v_pk_mul_f32 v[194:195], v[194:195], v[128:129] op_sel_hi:[1,0]
    v_pk_mul_f32 v[196:197], v[196:197], v[128:129] op_sel_hi:[1,0]
    v_pk_mul_f32 v[198:199], v[198:199], v[128:129] op_sel_hi:[1,0]
    v_pk_mul_f32 v[200:201], v[200:201], v[128:129] op_sel_hi:[1,0]
    v_pk_mul_f32 v[202:203], v[202:203], v[128:129] op_sel_hi:[1,0]
    v_pk_mul_f32 v[204:205], v[204:205], v[128:129] op_sel_hi:[1,0]
    v_pk_mul_f32 v[206:207], v[206:207], v[128:129] op_sel_hi:[1,0]
    v_cvt_pk_bf16_f32 v224, v192, v193
    v_cvt_pk_bf16_f32 v225, v194, v195
    v_cvt_pk_bf16_f32 v226, v196, v197
    v_cvt_pk_bf16_f32 v227, v198, v199
    v_cvt_pk_bf16_f32 v228, v200, v201
    v_cvt_pk_bf16_f32 v229, v202, v203
    v_cvt_pk_bf16_f32 v230, v204, v205
    v_cvt_pk_bf16_f32 v231, v206, v207
    s_add_u32 s47, s55, 0
    buffer_store_dwordx4 v[224:227], v180, s[20:23], s47 offen offset:0 sc0 sc1
    buffer_store_dwordx4 v[228:231], v180, s[20:23], s47 offen offset:1024 sc0 sc1
    s_waitcnt lgkmcnt(0)
    s_barrier
    ds_read_b128 v[192:195], v173 offset:16384
    ds_read_b128 v[196:199], v173 offset:17408
    ds_read_b128 v[200:203], v173 offset:18432
    ds_read_b128 v[204:207], v173 offset:19456
    ds_write_b128 v172, a[80:83] offset:0
    ds_write_b128 v172, a[84:87] offset:1024
    ds_write_b128 v172, a[88:91] offset:2048
    ds_write_b128 v172, a[92:95] offset:3072
    s_cmp_eq_u32 s40, 0
    s_cbranch_scc0 L_attn_nh1
    s_add_u32 m0, s53, s28
    s_nop 0
    buffer_load_dwordx4 v168, s[8:11], s30 offen offset:2048 nt lds
    buffer_load_dwordx4 v169, s[8:11], s30 offen offset:3072 nt lds
L_attn_nh1:
    v_accvgpr_read_b32 v208, a32
    v_accvgpr_read_b32 v209, a33
    v_accvgpr_read_b32 v210, a34
    v_accvgpr_read_b32 v211, a35
    v_accvgpr_read_b32 v212, a36
    v_accvgpr_read_b32 v213, a37
    v_accvgpr_read_b32 v214, a38
    v_accvgpr_read_b32 v215, a39
    v_accvgpr_read_b32 v216, a40
    v_accvgpr_read_b32 v217, a41
    v_accvgpr_read_b32 v218, a42
    v_accvgpr_read_b32 v219, a43
    v_accvgpr_read_b32 v220, a44
    v_accvgpr_read_b32 v221, a45
    v_accvgpr_read_b32 v222, a46
    v_accvgpr_read_b32 v223, a47
    s_waitcnt lgkmcnt(4)
    v_pk_add_f32 v[192:193], v[192:193], v[208:209]
    v_pk_add_f32 v[194:195], v[194:195], v[210:211]
    v_pk_add_f32 v[196:197], v[196:197], v[212:213]
    v_pk_add_f32 v[198:199], v[198:199], v[214:215]
    v_pk_add_f32 v[200:201], v[200:201], v[216:217]
    v_pk_add_f32 v[202:203], v[202:203], v[218:219]
    v_pk_add_f32 v[204:205], v[204:205], v[220:221]
    v_pk_add_f32 v[206:207], v[206:207], v[222:223]
    v_pk_mul_f32 v[192:193], v[192:193], v[132:133] op_sel_hi:[1,0]
    v_pk_mul_f32 v[194:195], v[194:195], v[132:133] op_sel_hi:[1,0]
    v_pk_mul_f32 v[196:197], v[196:197], v[132:133] op_sel_hi:[1,0]
    v_pk_mul_f32 v[198:199], v[198:199], v[132:133] op_sel_hi:[1,0]
    v_pk_mul_f32 v[200:201], v[200:201], v[132:133] op_sel_hi:[1,0]
    v_pk_mul_f32 v[202:203], v[202:203], v[132:133] op_sel_hi:[1,0]
    v_pk_mul_f32 v[204:205], v[204:205], v[132:133] op_sel_hi:[1,0]
    v_pk_mul_f32 v[206:207], v[206:207], v[132:133] op_sel_hi:[1,0]
    v_cvt_pk_bf16_f32 v232, v192, v193
    v_cvt_pk_bf16_f32 v233, v194, v195
    v_cvt_pk_bf16_f32 v234, v196, v197
    v_cvt_pk_bf16_f32 v235, v198, v199
    v_cvt_pk_bf16_f32 v236, v200, v201
    v_cvt_pk_bf16_f32 v237, v202, v203
    v_cvt_pk_bf16_f32 v238, v204, v205
    v_cvt_pk_bf16_f32 v239, v206, v207
    s_add_u32 s47, s55, 131072
    buffer_store_dwordx4 v[232:235], v180, s[20:23], s47 offen offset:0 sc0 sc1
    buffer_store_dwordx4 v[236:239], v180, s[20:23], s47 offen offset:1024 sc0 sc1
    s_waitcnt lgkmcnt(0)
    s_barrier
    ds_read_b128 v[192:195], v173 offset:0
    ds_read_b128 v[196:199], v173 offset:1024
    ds_read_b128 v[200:203], v173 offset:2048
    ds_read_b128 v[204:207], v173 offset:3072
    ds_write_b128 v172, a[112:115] offset:16384
    ds_write_b128 v172, a[116:119] offset:17408
    ds_write_b128 v172, a[120:123] offset:18432
    ds_write_b128 v172, a[124:127] offset:19456
    s_cmp_eq_u32 s40, 0
    s_cbranch_scc0 L_attn_nh2
    s_add_u32 m0, s52, s26
    s_nop 0
    buffer_load_dwordx4 v164, s[4:7], s29 offen nt lds
    buffer_load_dwordx4 v165, s[4:7], s29 offen offset:1024 nt lds
L_attn_nh2:
    v_accvgpr_read_b32 v208, a64
    v_accvgpr_read_b32 v209, a65
    v_accvgpr_read_b32 v210, a66
    v_accvgpr_read_b32 v211, a67
    v_accvgpr_read_b32 v212, a68
    v_accvgpr_read_b32 v213, a69
    v_accvgpr_read_b32 v214, a70
    v_accvgpr_read_b32 v215, a71
    v_accvgpr_read_b32 v216, a72
    v_accvgpr_read_b32 v217, a73
    v_accvgpr_read_b32 v218, a74
    v_accvgpr_read_b32 v219, a75
    v_accvgpr_read_b32 v220, a76
    v_accvgpr_read_b32 v221, a77
    v_accvgpr_read_b32 v222, a78
    v_accvgpr_read_b32 v223, a79
    s_waitcnt lgkmcnt(4)
    v_pk_add_f32 v[192:193], v[192:193], v[208:209]
    v_pk_add_f32 v[194:195], v[194:195], v[210:211]
    v_pk_add_f32 v[196:197], v[196:197], v[212:213]
    v_pk_add_f32 v[198:199], v[198:199], v[214:215]
    v_pk_add_f32 v[200:201], v[200:201], v[216:217]
    v_pk_add_f32 v[202:203], v[202:203], v[218:219]
    v_pk_add_f32 v[204:205], v[204:205], v[220:221]
    v_pk_add_f32 v[206:207], v[206:207], v[222:223]
    v_pk_mul_f32 v[192:193], v[192:193], v[136:137] op_sel_hi:[1,0]
    v_pk_mul_f32 v[194:195], v[194:195], v[136:137] op_sel_hi:[1,0]
    v_pk_mul_f32 v[196:197], v[196:197], v[136:137] op_sel_hi:[1,0]
    v_pk_mul_f32 v[198:199], v[198:199], v[136:137] op_sel_hi:[1,0]
    v_pk_mul_f32 v[200:201], v[200:201], v[136:137] op_sel_hi:[1,0]
    v_pk_mul_f32 v[202:203], v[202:203], v[136:137] op_sel_hi:[1,0]
    v_pk_mul_f32 v[204:205], v[204:205], v[136:137] op_sel_hi:[1,0]
    v_pk_mul_f32 v[206:207], v[206:207], v[136:137] op_sel_hi:[1,0]
    v_cvt_pk_bf16_f32 v224, v192, v193
    v_cvt_pk_bf16_f32 v225, v194, v195
    v_cvt_pk_bf16_f32 v226, v196, v197
    v_cvt_pk_bf16_f32 v227, v198, v199
    v_cvt_pk_bf16_f32 v228, v200, v201
    v_cvt_pk_bf16_f32 v229, v202, v203
    v_cvt_pk_bf16_f32 v230, v204, v205
    v_cvt_pk_bf16_f32 v231, v206, v207
    s_add_u32 s47, s55, 262144
    buffer_store_dwordx4 v[224:227], v180, s[20:23], s47 offen offset:0 sc0 sc1
    buffer_store_dwordx4 v[228:231], v180, s[20:23], s47 offen offset:1024 sc0 sc1
    s_waitcnt lgkmcnt(0)
    s_barrier
    ds_read_b128 v[192:195], v173 offset:16384
    ds_read_b128 v[196:199], v173 offset:17408
    ds_read_b128 v[200:203], v173 offset:18432
    ds_read_b128 v[204:207], v173 offset:19456
    ds_write_b128 v172, a[144:147] offset:0
    ds_write_b128 v172, a[148:151] offset:1024
    ds_write_b128 v172, a[152:155] offset:2048
    ds_write_b128 v172, a[156:159] offset:3072
    s_cmp_eq_u32 s40, 0
    s_cbranch_scc0 L_attn_nh3
    s_add_u32 m0, s52, s26
    s_nop 0
    buffer_load_dwordx4 v166, s[4:7], s29 offen offset:2048 nt lds
    buffer_load_dwordx4 v167, s[4:7], s29 offen offset:3072 nt lds
L_attn_nh3:
    v_accvgpr_read_b32 v208, a96
    v_accvgpr_read_b32 v209, a97
    v_accvgpr_read_b32 v210, a98
    v_accvgpr_read_b32 v211, a99
    v_accvgpr_read_b32 v212, a100
    v_accvgpr_read_b32 v213, a101
    v_accvgpr_read_b32 v214, a102
    v_accvgpr_read_b32 v215, a103
    v_accvgpr_read_b32 v216, a104
    v_accvgpr_read_b32 v217, a105
    v_accvgpr_read_b32 v218, a106
    v_accvgpr_read_b32 v219, a107
    v_accvgpr_read_b32 v220, a108
    v_accvgpr_read_b32 v221, a109
    v_accvgpr_read_b32 v222, a110
    v_accvgpr_read_b32 v223, a111
    s_waitcnt lgkmcnt(4)
    v_pk_add_f32 v[192:193], v[192:193], v[208:209]
    v_pk_add_f32 v[194:195], v[194:195], v[210:211]
    v_pk_add_f32 v[196:197], v[196:197], v[212:213]
    v_pk_add_f32 v[198:199], v[198:199], v[214:215]
    v_pk_add_f32 v[200:201], v[200:201], v[216:217]
    v_pk_add_f32 v[202:203], v[202:203], v[218:219]
    v_pk_add_f32 v[204:205], v[204:205], v[220:221]
    v_pk_add_f32 v[206:207], v[206:207], v[222:223]
    v_pk_mul_f32 v[192:193], v[192:193], v[140:141] op_sel_hi:[1,0]
    v_pk_mul_f32 v[194:195], v[194:195], v[140:141] op_sel_hi:[1,0]
    v_pk_mul_f32 v[196:197], v[196:197], v[140:141] op_sel_hi:[1,0]
    v_pk_mul_f32 v[198:199], v[198:199], v[140:141] op_sel_hi:[1,0]
    v_pk_mul_f32 v[200:201], v[200:201], v[140:141] op_sel_hi:[1,0]
    v_pk_mul_f32 v[202:203], v[202:203], v[140:141] op_sel_hi:[1,0]
    v_pk_mul_f32 v[204:205], v[204:205], v[140:141] op_sel_hi:[1,0]
    v_pk_mul_f32 v[206:207], v[206:207], v[140:141] op_sel_hi:[1,0]
    v_cvt_pk_bf16_f32 v232, v192, v193
    v_cvt_pk_bf16_f32 v233, v194, v195
    v_cvt_pk_bf16_f32 v234, v196, v197
    v_cvt_pk_bf16_f32 v235, v198, v199
    v_cvt_pk_bf16_f32 v236, v200, v201
    v_cvt_pk_bf16_f32 v237, v202, v203
    v_cvt_pk_bf16_f32 v238, v204, v205
    v_cvt_pk_bf16_f32 v239, v206, v207
    s_add_u32 s47, s55, 393216
    buffer_store_dwordx4 v[232:235], v180, s[20:23], s47 offen offset:0 sc0 sc1
    buffer_store_dwordx4 v[236:239], v180, s[20:23], s47 offen offset:1024 sc0 sc1
    s_waitcnt lgkmcnt(0)
    s_barrier
    ds_read_b128 v[192:195], v173 offset:0
    ds_read_b128 v[196:199], v173 offset:1024
    ds_read_b128 v[200:203], v173 offset:2048
    ds_read_b128 v[204:207], v173 offset:3072
    v_accvgpr_read_b32 v208, a128
    v_accvgpr_read_b32 v209, a129
    v_accvgpr_read_b32 v210, a130
    v_accvgpr_read_b32 v211, a131
    v_accvgpr_read_b32 v212, a132
    v_accvgpr_read_b32 v213, a133
    v_accvgpr_read_b32 v214, a134
    v_accvgpr_read_b32 v215, a135
    v_accvgpr_read_b32 v216, a136
    v_accvgpr_read_b32 v217, a137
    v_accvgpr_read_b32 v218, a138
    v_accvgpr_read_b32 v219, a139
    v_accvgpr_read_b32 v220, a140
    v_accvgpr_read_b32 v221, a141
    v_accvgpr_read_b32 v222, a142
    v_accvgpr_read_b32 v223, a143
    s_waitcnt lgkmcnt(0)
    v_pk_add_f32 v[192:193], v[192:193], v[208:209]
    v_pk_add_f32 v[194:195], v[194:195], v[210:211]
    v_pk_add_f32 v[196:197], v[196:197], v[212:213]
    v_pk_add_f32 v[198:199], v[198:199], v[214:215]
    v_pk_add_f32 v[200:201], v[200:201], v[216:217]
    v_pk_add_f32 v[202:203], v[202:203], v[218:219]
    v_pk_add_f32 v[204:205], v[204:205], v[220:221]
    v_pk_add_f32 v[206:207], v[206:207], v[222:223]
    v_pk_mul_f32 v[192:193], v[192:193], v[144:145] op_sel_hi:[1,0]
    v_pk_mul_f32 v[194:195], v[194:195], v[144:145] op_sel_hi:[1,0]
    v_pk_mul_f32 v[196:197], v[196:197], v[144:145] op_sel_hi:[1,0]
    v_pk_mul_f32 v[198:199], v[198:199], v[144:145] op_sel_hi:[1,0]
    v_pk_mul_f32 v[200:201], v[200:201], v[144:145] op_sel_hi:[1,0]
    v_pk_mul_f32 v[202:203], v[202:203], v[144:145] op_sel_hi:[1,0]
    v_pk_mul_f32 v[204:205], v[204:205], v[144:145] op_sel_hi:[1,0]
    v_pk_mul_f32 v[206:207], v[206:207], v[144:145] op_sel_hi:[1,0]
    v_cvt_pk_bf16_f32 v224, v192, v193
    v_cvt_pk_bf16_f32 v225, v194, v195
    v_cvt_pk_bf16_f32 v226, v196, v197
    v_cvt_pk_bf16_f32 v227, v198, v199
    v_cvt_pk_bf16_f32 v228, v200, v201
    v_cvt_pk_bf16_f32 v229, v202, v203
    v_cvt_pk_bf16_f32 v230, v204, v205
    v_cvt_pk_bf16_f32 v231, v206, v207
    s_add_u32 s47, s55, 524288
    buffer_store_dwordx4 v[224:227], v180, s[20:23], s47 offen offset:0 sc0 sc1
    buffer_store_dwordx4 v[228:231], v180, s[20:23], s47 offen offset:1024 sc0 sc1
    s_waitcnt lgkmcnt(0)
    s_barrier
    s_cmp_eq_u32 s40, 1
    s_cbranch_scc1 L_attn_tail
    s_mov_b32 s96, s78
    s_mov_b32 s97, s79
    s_mov_b32 s98, 256
    s_mov_b32 s99, 0x20000
    v_mov_b32 v191, 0
    buffer_load_dword v190, v191, s[96:99], 0 offen sc0 sc1
    s_mul_i32 s36, s84, 20
    s_lshl_b32 s37, s83, 1
    s_add_u32 s36, s36, s37
    s_lshl_b32 s36, s36, 10
    v_add_u32 v184, s36, v162
    ds_write_b128 v184, v[88:91] offset:0
    ds_write_b128 v184, v[92:95] offset:1024
    ds_write_b128 v184, v[96:99] offset:4096
    ds_write_b128 v184, v[100:103] offset:5120
    ds_write_b128 v184, v[104:107] offset:8192
    ds_write_b128 v184, v[108:111] offset:9216
    ds_write_b128 v184, v[112:115] offset:12288
    ds_write_b128 v184, v[116:119] offset:13312
    ds_write_b128 v184, v[120:123] offset:16384
    ds_write_b128 v184, v[124:127] offset:17408
    s_waitcnt lgkmcnt(0)
    s_barrier
    s_mov_b32 s40, 1
    s_branch L_attn_item
L_attn_tail:
    s_cmp_ge_u32 s2, 240
    s_cbranch_scc0 L_attn_task
    s_waitcnt vmcnt(0)
    s_barrier
    s_add_u32 s96, s80, 0x5000000
    s_addc_u32 s97, s81, 0
    s_mov_b32 s98, 32768
    s_mov_b32 s99, 0x20000
    s_cmp_lg_u32 s24, 0
    s_cbranch_scc1 L_attn_f2x
    v_mov_b32 v180, 2
    v_mov_b32 v181, 0
    s_mov_b64 exec, 1
    buffer_store_dword v180, v181, s[96:99], s90 offen sc0 sc1
    s_mov_b64 exec, -1
L_attn_f2x:
    s_endpgm
L_attn_task:
    s_add_u32 s34, s28, 1
    s_and_b32 s34, s34, 15
    s_mul_i32 s34, s34, 73728
    s_add_u32 s34, s34, s29
    s_add_u32 m0, s31, 24576
    s_add_u32 s32, s34, 0
    buffer_load_dwordx4 v253, s[4:7], s32 offen offset:0 lds
    s_add_u32 s32, s34, 4294966272
    buffer_load_dwordx4 v254, s[4:7], s32 offen offset:1024 lds
    s_add_u32 s32, s34, 4294965248
    buffer_load_dwordx4 v255, s[4:7], s32 offen offset:2048 lds
    s_add_u32 m0, s31, 27648
    s_add_u32 s32, s34, 9216
    buffer_load_dwordx4 v253, s[4:7], s32 offen offset:0 lds
    s_add_u32 s32, s34, 8192
    buffer_load_dwordx4 v254, s[4:7], s32 offen offset:1024 lds
    s_add_u32 s32, s34, 7168
    buffer_load_dwordx4 v255, s[4:7], s32 offen offset:2048 lds
    s_add_u32 s34, s28, 2
    s_and_b32 s34, s34, 15
    s_mul_i32 s34, s34, 73728
    s_add_u32 s34, s34, s29
    s_add_u32 m0, s31, 49152
    s_add_u32 s32, s34, 0
    buffer_load_dwordx4 v253, s[4:7], s32 offen offset:0 lds
    s_add_u32 s32, s34, 4294966272
    buffer_load_dwordx4 v254, s[4:7], s32 offen offset:1024 lds
    s_add_u32 s32, s34, 4294965248
    buffer_load_dwordx4 v255, s[4:7], s32 offen offset:2048 lds
    s_add_u32 m0, s31, 52224
    s_add_u32 s32, s34, 9216
    buffer_load_dwordx4 v253, s[4:7], s32 offen offset:0 lds
    s_add_u32 s32, s34, 8192
    buffer_load_dwordx4 v254, s[4:7], s32 offen offset:1024 lds
    s_add_u32 s32, s34, 7168
    buffer_load_dwordx4 v255, s[4:7], s32 offen offset:2048 lds
    s_waitcnt vmcnt(12)
    s_barrier
    s_add_u32 s96, s80, 0x5000000
    s_addc_u32 s97, s81, 0
    s_mov_b32 s98, 32768
    s_mov_b32 s99, 0x20000
    s_cmp_lg_u32 s24, 0
    s_cbranch_scc1 L_attn_f2
    v_mov_b32 v180, 2
    v_mov_b32 v181, 0
    s_mov_b64 exec, 1
    buffer_store_dword v180, v181, s[96:99], s90 offen sc0 sc1
    s_mov_b64 exec, -1
L_attn_f2:
    v_mov_b32 v243, v190
    v_lshlrev_b32 v232, 4, v252
    v_lshrrev_b32 v1, 4, v252
    v_and_b32 v2, 15, v252
    v_lshrrev_b32 v6, 2, v2
    v_and_b32 v7, 3, v2
    v_lshl_add_u32 v8, v1, 2, v6
    v_lshrrev_b32 v9, 1, v8
    v_and_b32 v9, 3, v9
    v_mul_u32_u24 v8, 384, v8
    v_lshl_add_u32 v8, v7, 3, v8
    v_xor_b32 v10, 0, v9
    v_lshl_add_u32 v224, v10, 5, v8
    v_add_u32 v228, 49152, v224
    v_xor_b32 v10, 1, v9
    v_lshl_add_u32 v225, v10, 5, v8
    v_add_u32 v229, 49152, v225
    v_xor_b32 v10, 2, v9
    v_lshl_add_u32 v226, v10, 5, v8
    v_add_u32 v230, 49152, v226
    v_xor_b32 v10, 3, v9
    v_lshl_add_u32 v227, v10, 5, v8
    v_add_u32 v231, 49152, v227
    s_lshl_b32 s36, s26, 7
    s_mul_i32 s37, s36, 52429
    s_lshr_b32 s37, s37, 23
    s_add_u32 s36, s36, 127
    s_mul_i32 s38, s36, 52429
    s_lshr_b32 s38, s38, 23
    v_mov_b32 v11, s37
    v_mov_b32 v12, s38
    v_cmp_gt_u32 vcc, 8, v252
    s_nop 1
    v_cndmask_b32 v11, v12, v11, vcc
    v_and_b32 v12, 3, v11
    v_and_b32 v13, 7, v252
    v_lshl_add_u32 v12, v12, 3, v13
    s_and_b32 s36, s2, 7
    v_lshlrev_b32 v12, 3, v12
    v_add_u32 v12, s36, v12
    v_lshlrev_b32 v12, 7, v12
    v_lshrrev_b32 v13, 2, v11
    v_add_u32 v13, 1, v13
    s_cmp_lg_u32 s24, 0
    s_cbranch_scc1 L_attn_p1_done
    s_mov_b32 s44, 0
    s_mov_b64 exec, 0xffff
    s_mov_b32 s96, s78
    s_mov_b32 s97, s79
    s_mov_b32 s98, 256
    s_mov_b32 s99, 0x20000
    v_mov_b32 v15, 0
    v_cmp_gt_u32 vcc, 256, v243
    s_nop 4
    s_cbranch_vccz L_attn_p1_loop
L_attn_p1_gate:
    buffer_load_dword v14, v15, s[96:99], 0 offen sc0 sc1
    s_waitcnt vmcnt(0)
    v_cmp_gt_u32 vcc, 256, v14
    s_nop 4
    s_cbranch_vccz L_attn_p1_loop
    s_add_u32 s44, s44, 1
    s_cmp_lt_u32 s44, 65536
    s_cbranch_scc0 L_attn_p1_restore
    s_sleep 2
    s_branch L_attn_p1_gate
L_attn_p1_loop:
    buffer_load_dword v14, v12, s[16:19], 0 offen sc0 sc1
    s_waitcnt vmcnt(0)
    v_cmp_lt_u32 vcc, v14, v13
    s_nop 4
    s_cbranch_vccz L_attn_p1_restore
    s_add_u32 s44, s44, 1
    s_cmp_lt_u32 s44, 65536
    s_cbranch_scc0 L_attn_p1_restore
    s_sleep 1
    s_branch L_attn_p1_loop
L_attn_p1_restore:
    s_mov_b64 exec, -1
L_attn_p1_done:
    s_barrier
    s_add_u32 s33, s28, 0
    s_and_b32 s33, s33, 15
    s_mul_i32 s33, s33, 2048
    s_add_u32 s33, s33, s30
    buffer_load_dwordx4 v[160:163], v232, s[8:11], s33 offen sc0 sc1
    s_add_u32 s33, s33, 131072
    buffer_load_dwordx4 v[164:167], v232, s[8:11], s33 offen sc0 sc1
    s_add_u32 s33, s28, 0
    s_and_b32 s33, s33, 15
    s_mul_i32 s33, s33, 2048
    s_add_u32 s33, s33, s30
    s_add_u32 s33, s33, 1024
    buffer_load_dwordx4 v[168:171], v232, s[8:11], s33 offen sc0 sc1
    s_add_u32 s33, s33, 131072
    buffer_load_dwordx4 v[172:175], v232, s[8:11], s33 offen sc0 sc1
    s_add_u32 s33, s28, 1
    s_and_b32 s33, s33, 15
    s_mul_i32 s33, s33, 2048
    s_add_u32 s33, s33, s30
    buffer_load_dwordx4 v[176:179], v232, s[8:11], s33 offen sc0 sc1
    s_add_u32 s33, s33, 131072
    buffer_load_dwordx4 v[180:183], v232, s[8:11], s33 offen sc0 sc1
    s_add_u32 s33, s28, 1
    s_and_b32 s33, s33, 15
    s_mul_i32 s33, s33, 2048
    s_add_u32 s33, s33, s30
    s_add_u32 s33, s33, 1024
    buffer_load_dwordx4 v[184:187], v232, s[8:11], s33 offen sc0 sc1
    s_add_u32 s33, s33, 131072
    buffer_load_dwordx4 v[188:191], v232, s[8:11], s33 offen sc0 sc1
    s_waitcnt lgkmcnt(0)
    ds_read_b64_tr_b16 v[96:97], v224 offset:0
    ds_read_b64_tr_b16 v[98:99], v224 offset:6144
    ds_read_b64_tr_b16 v[100:101], v225 offset:0
    ds_read_b64_tr_b16 v[102:103], v225 offset:6144
    ds_read_b64_tr_b16 v[104:105], v226 offset:0
    ds_read_b64_tr_b16 v[106:107], v226 offset:6144
    ds_read_b64_tr_b16 v[108:109], v227 offset:0
    ds_read_b64_tr_b16 v[110:111], v227 offset:6144
    ds_read_b64_tr_b16 v[112:113], v224 offset:128
    ds_read_b64_tr_b16 v[114:115], v224 offset:6272
    ds_read_b64_tr_b16 v[116:117], v225 offset:128
    ds_read_b64_tr_b16 v[118:119], v225 offset:6272
    ds_read_b64_tr_b16 v[120:121], v226 offset:128
    ds_read_b64_tr_b16 v[122:123], v226 offset:6272
    ds_read_b64_tr_b16 v[124:125], v227 offset:128
    ds_read_b64_tr_b16 v[126:127], v227 offset:6272
    ds_read_b64_tr_b16 v[128:129], v224 offset:256
    ds_read_b64_tr_b16 v[130:131], v224 offset:6400
    ds_read_b64_tr_b16 v[132:133], v225 offset:256
    ds_read_b64_tr_b16 v[134:135], v225 offset:6400
    ds_read_b64_tr_b16 v[136:137], v226 offset:256
    ds_read_b64_tr_b16 v[138:139], v226 offset:6400
    ds_read_b64_tr_b16 v[140:141], v227 offset:256
    ds_read_b64_tr_b16 v[142:143], v227 offset:6400
    s_waitcnt vmcnt(6) lgkmcnt(15)
    v_mfma_f32_16x16x32_bf16 v[0:3], v[96:99], v[160:163], 0
    ds_read_b64_tr_b16 v[144:145], v224 offset:12288
    ds_read_b64_tr_b16 v[146:147], v224 offset:18432
    v_mfma_f32_16x16x32_bf16 v[48:51], v[96:99], v[164:167], 0
    s_add_u32 s33, s28, 2
    v_mfma_f32_16x16x32_bf16 v[4:7], v[100:103], v[160:163], 0
    s_and_b32 s33, s33, 15
    ds_read_b64_tr_b16 v[148:149], v225 offset:12288
    ds_read_b64_tr_b16 v[150:151], v225 offset:18432
    v_mfma_f32_16x16x32_bf16 v[52:55], v[100:103], v[164:167], 0
    s_mul_i32 s33, s33, 2048
    v_mfma_f32_16x16x32_bf16 v[8:11], v[104:107], v[160:163], 0
    s_add_u32 s33, s33, s30
    buffer_load_dwordx4 v[192:195], v232, s[8:11], s33 offen sc0 sc1
    ds_read_b64_tr_b16 v[152:153], v226 offset:12288
    ds_read_b64_tr_b16 v[154:155], v226 offset:18432
    v_mfma_f32_16x16x32_bf16 v[56:59], v[104:107], v[164:167], 0
    v_mfma_f32_16x16x32_bf16 v[12:15], v[108:111], v[160:163], 0
    s_add_u32 s33, s33, 131072
    buffer_load_dwordx4 v[196:199], v232, s[8:11], s33 offen sc0 sc1
    ds_read_b64_tr_b16 v[156:157], v227 offset:12288
    ds_read_b64_tr_b16 v[158:159], v227 offset:18432
    v_mfma_f32_16x16x32_bf16 v[60:63], v[108:111], v[164:167], 0
    s_waitcnt lgkmcnt(15)
    v_mfma_f32_16x16x32_bf16 v[16:19], v[112:115], v[160:163], 0
    s_add_u32 s33, s28, 2
    ds_read_b64_tr_b16 v[96:97], v224 offset:12416
    ds_read_b64_tr_b16 v[98:99], v224 offset:18560
    v_mfma_f32_16x16x32_bf16 v[64:67], v[112:115], v[164:167], 0
    s_and_b32 s33, s33, 15
    v_mfma_f32_16x16x32_bf16 v[20:23], v[116:119], v[160:163], 0
    s_mul_i32 s33, s33, 2048
    ds_read_b64_tr_b16 v[100:101], v225 offset:12416
    ds_read_b64_tr_b16 v[102:103], v225 offset:18560
    v_mfma_f32_16x16x32_bf16 v[68:71], v[116:119], v[164:167], 0
    s_add_u32 s33, s33, s30
    v_mfma_f32_16x16x32_bf16 v[24:27], v[120:123], v[160:163], 0
    s_add_u32 s33, s33, 1024
    buffer_load_dwordx4 v[200:203], v232, s[8:11], s33 offen sc0 sc1
    ds_read_b64_tr_b16 v[104:105], v226 offset:12416
    ds_read_b64_tr_b16 v[106:107], v226 offset:18560
    v_mfma_f32_16x16x32_bf16 v[72:75], v[120:123], v[164:167], 0
    v_mfma_f32_16x16x32_bf16 v[28:31], v[124:127], v[160:163], 0
    s_add_u32 s33, s33, 131072
    buffer_load_dwordx4 v[204:207], v232, s[8:11], s33 offen sc0 sc1
    ds_read_b64_tr_b16 v[108:109], v227 offset:12416
    ds_read_b64_tr_b16 v[110:111], v227 offset:18560
    v_mfma_f32_16x16x32_bf16 v[76:79], v[124:127], v[164:167], 0
    s_waitcnt lgkmcnt(15)
    v_mfma_f32_16x16x32_bf16 v[32:35], v[128:131], v[160:163], 0
    s_add_u32 s34, s28, 3
    ds_read_b64_tr_b16 v[112:113], v224 offset:12544
    ds_read_b64_tr_b16 v[114:115], v224 offset:18688
    v_mfma_f32_16x16x32_bf16 v[80:83], v[128:131], v[164:167], 0
    s_and_b32 s34, s34, 15
    v_mfma_f32_16x16x32_bf16 v[36:39], v[132:135], v[160:163], 0
    s_mul_i32 s34, s34, 73728
    ds_read_b64_tr_b16 v[116:117], v225 offset:12544
    ds_read_b64_tr_b16 v[118:119], v225 offset:18688
    v_mfma_f32_16x16x32_bf16 v[84:87], v[132:135], v[164:167], 0
    s_add_u32 s34, s34, s29
    v_mfma_f32_16x16x32_bf16 v[40:43], v[136:139], v[160:163], 0
    s_add_u32 m0, s31, 73728
    ds_read_b64_tr_b16 v[120:121], v226 offset:12544
    ds_read_b64_tr_b16 v[122:123], v226 offset:18688
    v_mfma_f32_16x16x32_bf16 v[88:91], v[136:139], v[164:167], 0
    s_add_u32 s32, s34, 0
    buffer_load_dwordx4 v253, s[4:7], s32 offen offset:0 lds
    v_mfma_f32_16x16x32_bf16 v[44:47], v[140:143], v[160:163], 0
    ds_read_b64_tr_b16 v[124:125], v227 offset:12544
    ds_read_b64_tr_b16 v[126:127], v227 offset:18688
    v_mfma_f32_16x16x32_bf16 v[92:95], v[140:143], v[164:167], 0
    s_waitcnt vmcnt(9) lgkmcnt(15)
    v_mfma_f32_16x16x32_bf16 v[0:3], v[144:147], v[168:171], v[0:3]
    s_add_u32 s32, s34, 4294966272
    buffer_load_dwordx4 v254, s[4:7], s32 offen offset:1024 lds
    v_mfma_f32_16x16x32_bf16 v[48:51], v[144:147], v[172:175], v[48:51]
    v_mfma_f32_16x16x32_bf16 v[4:7], v[148:151], v[168:171], v[4:7]
    s_add_u32 s32, s34, 4294965248
    buffer_load_dwordx4 v255, s[4:7], s32 offen offset:2048 lds
    v_mfma_f32_16x16x32_bf16 v[52:55], v[148:151], v[172:175], v[52:55]
    v_mfma_f32_16x16x32_bf16 v[8:11], v[152:155], v[168:171], v[8:11]
    s_add_u32 m0, s31, 76800
    v_mfma_f32_16x16x32_bf16 v[56:59], v[152:155], v[172:175], v[56:59]
    s_add_u32 s32, s34, 9216
    buffer_load_dwordx4 v253, s[4:7], s32 offen offset:0 lds
    v_mfma_f32_16x16x32_bf16 v[12:15], v[156:159], v[168:171], v[12:15]
    s_waitcnt lgkmcnt(0)
    s_barrier
    ds_read_b64_tr_b16 v[128:129], v224 offset:24576
    ds_read_b64_tr_b16 v[130:131], v224 offset:30720
    v_mfma_f32_16x16x32_bf16 v[60:63], v[156:159], v[172:175], v[60:63]
    ds_read_b64_tr_b16 v[132:133], v225 offset:24576
    ds_read_b64_tr_b16 v[134:135], v225 offset:30720
    v_mfma_f32_16x16x32_bf16 v[16:19], v[96:99], v[168:171], v[16:19]
    s_add_u32 s32, s34, 8192
    buffer_load_dwordx4 v254, s[4:7], s32 offen offset:1024 lds
    ds_read_b64_tr_b16 v[136:137], v226 offset:24576
    ds_read_b64_tr_b16 v[138:139], v226 offset:30720
    v_mfma_f32_16x16x32_bf16 v[64:67], v[96:99], v[172:175], v[64:67]
    ds_read_b64_tr_b16 v[140:141], v227 offset:24576
    ds_read_b64_tr_b16 v[142:143], v227 offset:30720
    v_mfma_f32_16x16x32_bf16 v[20:23], v[100:103], v[168:171], v[20:23]
    s_add_u32 s32, s34, 7168
    buffer_load_dwordx4 v255, s[4:7], s32 offen offset:2048 lds
    ds_read_b64_tr_b16 v[144:145], v224 offset:24704
    ds_read_b64_tr_b16 v[146:147], v224 offset:30848
    v_mfma_f32_16x16x32_bf16 v[68:71], v[100:103], v[172:175], v[68:71]
    ds_read_b64_tr_b16 v[148:149], v225 offset:24704
    ds_read_b64_tr_b16 v[150:151], v225 offset:30848
    v_mfma_f32_16x16x32_bf16 v[24:27], v[104:107], v[168:171], v[24:27]
    s_add_u32 s33, s28, 3
    ds_read_b64_tr_b16 v[152:153], v226 offset:24704
    ds_read_b64_tr_b16 v[154:155], v226 offset:30848
    v_mfma_f32_16x16x32_bf16 v[72:75], v[104:107], v[172:175], v[72:75]
    s_and_b32 s33, s33, 15
    v_mfma_f32_16x16x32_bf16 v[28:31], v[108:111], v[168:171], v[28:31]
    s_mul_i32 s33, s33, 2048
    ds_read_b64_tr_b16 v[156:157], v227 offset:24704
    ds_read_b64_tr_b16 v[158:159], v227 offset:30848
    v_mfma_f32_16x16x32_bf16 v[76:79], v[108:111], v[172:175], v[76:79]
    s_add_u32 s33, s33, s30
    buffer_load_dwordx4 v[208:211], v232, s[8:11], s33 offen sc0 sc1
    v_mfma_f32_16x16x32_bf16 v[32:35], v[112:115], v[168:171], v[32:35]
    ds_read_b64_tr_b16 v[96:97], v224 offset:24832
    ds_read_b64_tr_b16 v[98:99], v224 offset:30976
    v_mfma_f32_16x16x32_bf16 v[80:83], v[112:115], v[172:175], v[80:83]
    s_add_u32 s33, s33, 131072
    buffer_load_dwordx4 v[212:215], v232, s[8:11], s33 offen sc0 sc1
    v_mfma_f32_16x16x32_bf16 v[36:39], v[116:119], v[168:171], v[36:39]
    ds_read_b64_tr_b16 v[100:101], v225 offset:24832
    ds_read_b64_tr_b16 v[102:103], v225 offset:30976
    v_mfma_f32_16x16x32_bf16 v[84:87], v[116:119], v[172:175], v[84:87]
    s_add_u32 s34, s28, 4
    v_mfma_f32_16x16x32_bf16 v[40:43], v[120:123], v[168:171], v[40:43]
    s_and_b32 s34, s34, 15
    ds_read_b64_tr_b16 v[104:105], v226 offset:24832
    ds_read_b64_tr_b16 v[106:107], v226 offset:30976
    v_mfma_f32_16x16x32_bf16 v[88:91], v[120:123], v[172:175], v[88:91]
    s_mul_i32 s34, s34, 73728
    v_mfma_f32_16x16x32_bf16 v[44:47], v[124:127], v[168:171], v[44:47]
    s_add_u32 s34, s34, s29
    ds_read_b64_tr_b16 v[108:109], v227 offset:24832
    ds_read_b64_tr_b16 v[110:111], v227 offset:30976
    v_mfma_f32_16x16x32_bf16 v[92:95], v[124:127], v[172:175], v[92:95]
    s_waitcnt vmcnt(14) lgkmcnt(15)
    v_mfma_f32_16x16x32_bf16 v[0:3], v[128:131], v[176:179], v[0:3]
    s_add_u32 m0, s31, 0
    ds_read_b64_tr_b16 v[112:113], v224 offset:36864
    ds_read_b64_tr_b16 v[114:115], v224 offset:43008
    v_mfma_f32_16x16x32_bf16 v[48:51], v[128:131], v[180:183], v[48:51]
    s_add_u32 s32, s34, 0
    buffer_load_dwordx4 v253, s[4:7], s32 offen offset:0 lds
    v_mfma_f32_16x16x32_bf16 v[4:7], v[132:135], v[176:179], v[4:7]
    ds_read_b64_tr_b16 v[116:117], v225 offset:36864
    ds_read_b64_tr_b16 v[118:119], v225 offset:43008
    v_mfma_f32_16x16x32_bf16 v[52:55], v[132:135], v[180:183], v[52:55]
    s_add_u32 s32, s34, 4294966272
    buffer_load_dwordx4 v254, s[4:7], s32 offen offset:1024 lds
    v_mfma_f32_16x16x32_bf16 v[8:11], v[136:139], v[176:179], v[8:11]
    ds_read_b64_tr_b16 v[120:121], v226 offset:36864
    ds_read_b64_tr_b16 v[122:123], v226 offset:43008
    v_mfma_f32_16x16x32_bf16 v[56:59], v[136:139], v[180:183], v[56:59]
    s_add_u32 s32, s34, 4294965248
    buffer_load_dwordx4 v255, s[4:7], s32 offen offset:2048 lds
    v_mfma_f32_16x16x32_bf16 v[12:15], v[140:143], v[176:179], v[12:15]
    ds_read_b64_tr_b16 v[124:125], v227 offset:36864
    ds_read_b64_tr_b16 v[126:127], v227 offset:43008
    v_mfma_f32_16x16x32_bf16 v[60:63], v[140:143], v[180:183], v[60:63]
    s_waitcnt lgkmcnt(15)
    v_mfma_f32_16x16x32_bf16 v[16:19], v[144:147], v[176:179], v[16:19]
    s_add_u32 m0, s31, 3072
    ds_read_b64_tr_b16 v[128:129], v224 offset:36992
    ds_read_b64_tr_b16 v[130:131], v224 offset:43136
    v_mfma_f32_16x16x32_bf16 v[64:67], v[144:147], v[180:183], v[64:67]
    s_add_u32 s32, s34, 9216
    buffer_load_dwordx4 v253, s[4:7], s32 offen offset:0 lds
    v_mfma_f32_16x16x32_bf16 v[20:23], v[148:151], v[176:179], v[20:23]
    ds_read_b64_tr_b16 v[132:133], v225 offset:36992
    ds_read_b64_tr_b16 v[134:135], v225 offset:43136
    v_mfma_f32_16x16x32_bf16 v[68:71], v[148:151], v[180:183], v[68:71]
    s_add_u32 s32, s34, 8192
    buffer_load_dwordx4 v254, s[4:7], s32 offen offset:1024 lds
    v_mfma_f32_16x16x32_bf16 v[24:27], v[152:155], v[176:179], v[24:27]
    ds_read_b64_tr_b16 v[136:137], v226 offset:36992
    ds_read_b64_tr_b16 v[138:139], v226 offset:43136
    v_mfma_f32_16x16x32_bf16 v[72:75], v[152:155], v[180:183], v[72:75]
    s_add_u32 s32, s34, 7168
    buffer_load_dwordx4 v255, s[4:7], s32 offen offset:2048 lds
    v_mfma_f32_16x16x32_bf16 v[28:31], v[156:159], v[176:179], v[28:31]
    ds_read_b64_tr_b16 v[140:141], v227 offset:36992
    ds_read_b64_tr_b16 v[142:143], v227 offset:43136
    v_mfma_f32_16x16x32_bf16 v[76:79], v[156:159], v[180:183], v[76:79]
    s_waitcnt lgkmcnt(15)
    v_mfma_f32_16x16x32_bf16 v[32:35], v[96:99], v[176:179], v[32:35]
    s_add_u32 s33, s28, 3
    ds_read_b64_tr_b16 v[144:145], v224 offset:37120
    ds_read_b64_tr_b16 v[146:147], v224 offset:43264
    v_mfma_f32_16x16x32_bf16 v[80:83], v[96:99], v[180:183], v[80:83]
    s_and_b32 s33, s33, 15
    v_mfma_f32_16x16x32_bf16 v[36:39], v[100:103], v[176:179], v[36:39]
    s_mul_i32 s33, s33, 2048
    ds_read_b64_tr_b16 v[148:149], v225 offset:37120
    ds_read_b64_tr_b16 v[150:151], v225 offset:43264
    v_mfma_f32_16x16x32_bf16 v[84:87], v[100:103], v[180:183], v[84:87]
    s_add_u32 s33, s33, s30
    v_mfma_f32_16x16x32_bf16 v[40:43], v[104:107], v[176:179], v[40:43]
    s_add_u32 s33, s33, 1024
    buffer_load_dwordx4 v[216:219], v232, s[8:11], s33 offen sc0 sc1
    ds_read_b64_tr_b16 v[152:153], v226 offset:37120
    ds_read_b64_tr_b16 v[154:155], v226 offset:43264
    v_mfma_f32_16x16x32_bf16 v[88:91], v[104:107], v[180:183], v[88:91]
    v_mfma_f32_16x16x32_bf16 v[44:47], v[108:111], v[176:179], v[44:47]
    s_add_u32 s33, s33, 131072
    buffer_load_dwordx4 v[220:223], v232, s[8:11], s33 offen sc0 sc1
    ds_read_b64_tr_b16 v[156:157], v227 offset:37120
    ds_read_b64_tr_b16 v[158:159], v227 offset:43264
    v_mfma_f32_16x16x32_bf16 v[92:95], v[108:111], v[180:183], v[92:95]
    s_waitcnt vmcnt(20) lgkmcnt(15)
    v_mfma_f32_16x16x32_bf16 v[0:3], v[112:115], v[184:187], v[0:3]
    s_add_u32 s33, s28, 4
    v_mfma_f32_16x16x32_bf16 v[48:51], v[112:115], v[188:191], v[48:51]
    s_and_b32 s33, s33, 15
    v_mfma_f32_16x16x32_bf16 v[4:7], v[116:119], v[184:187], v[4:7]
    s_mul_i32 s33, s33, 2048
    v_mfma_f32_16x16x32_bf16 v[52:55], v[116:119], v[188:191], v[52:55]
    s_add_u32 s33, s33, s30
    buffer_load_dwordx4 v[160:163], v232, s[8:11], s33 offen sc0 sc1
    v_mfma_f32_16x16x32_bf16 v[8:11], v[120:123], v[184:187], v[8:11]
    v_mfma_f32_16x16x32_bf16 v[56:59], v[120:123], v[188:191], v[56:59]
    s_add_u32 s33, s33, 131072
    buffer_load_dwordx4 v[164:167], v232, s[8:11], s33 offen sc0 sc1
    v_mfma_f32_16x16x32_bf16 v[12:15], v[124:127], v[184:187], v[12:15]
    s_waitcnt lgkmcnt(0)
    s_barrier
    ds_read_b64_tr_b16 v[96:97], v228 offset:0
    ds_read_b64_tr_b16 v[98:99], v228 offset:6144
    v_mfma_f32_16x16x32_bf16 v[60:63], v[124:127], v[188:191], v[60:63]
    ds_read_b64_tr_b16 v[100:101], v229 offset:0
    ds_read_b64_tr_b16 v[102:103], v229 offset:6144
    v_mfma_f32_16x16x32_bf16 v[16:19], v[128:131], v[184:187], v[16:19]
    s_add_u32 s34, s28, 5
    ds_read_b64_tr_b16 v[104:105], v230 offset:0
    ds_read_b64_tr_b16 v[106:107], v230 offset:6144
    v_mfma_f32_16x16x32_bf16 v[64:67], v[128:131], v[188:191], v[64:67]
    s_and_b32 s34, s34, 15
    ds_read_b64_tr_b16 v[108:109], v231 offset:0
    ds_read_b64_tr_b16 v[110:111], v231 offset:6144
    v_mfma_f32_16x16x32_bf16 v[20:23], v[132:135], v[184:187], v[20:23]
    s_mul_i32 s34, s34, 73728
    ds_read_b64_tr_b16 v[112:113], v228 offset:128
    ds_read_b64_tr_b16 v[114:115], v228 offset:6272
    v_mfma_f32_16x16x32_bf16 v[68:71], v[132:135], v[188:191], v[68:71]
    s_add_u32 s34, s34, s29
    ds_read_b64_tr_b16 v[116:117], v229 offset:128
    ds_read_b64_tr_b16 v[118:119], v229 offset:6272
    v_mfma_f32_16x16x32_bf16 v[24:27], v[136:139], v[184:187], v[24:27]
    s_add_u32 m0, s31, 24576
    ds_read_b64_tr_b16 v[120:121], v230 offset:128
    ds_read_b64_tr_b16 v[122:123], v230 offset:6272
    v_mfma_f32_16x16x32_bf16 v[72:75], v[136:139], v[188:191], v[72:75]
    s_add_u32 s32, s34, 0
    buffer_load_dwordx4 v253, s[4:7], s32 offen offset:0 lds
    v_mfma_f32_16x16x32_bf16 v[28:31], v[140:143], v[184:187], v[28:31]
    ds_read_b64_tr_b16 v[124:125], v231 offset:128
    ds_read_b64_tr_b16 v[126:127], v231 offset:6272
    v_mfma_f32_16x16x32_bf16 v[76:79], v[140:143], v[188:191], v[76:79]
    s_add_u32 s32, s34, 4294966272
    buffer_load_dwordx4 v254, s[4:7], s32 offen offset:1024 lds
    v_mfma_f32_16x16x32_bf16 v[32:35], v[144:147], v[184:187], v[32:35]
    ds_read_b64_tr_b16 v[128:129], v228 offset:256
    ds_read_b64_tr_b16 v[130:131], v228 offset:6400
    v_mfma_f32_16x16x32_bf16 v[80:83], v[144:147], v[188:191], v[80:83]
    s_add_u32 s32, s34, 4294965248
    buffer_load_dwordx4 v255, s[4:7], s32 offen offset:2048 lds
    v_mfma_f32_16x16x32_bf16 v[36:39], v[148:151], v[184:187], v[36:39]
    ds_read_b64_tr_b16 v[132:133], v229 offset:256
    ds_read_b64_tr_b16 v[134:135], v229 offset:6400
    v_mfma_f32_16x16x32_bf16 v[84:87], v[148:151], v[188:191], v[84:87]
    s_add_u32 m0, s31, 27648
    v_mfma_f32_16x16x32_bf16 v[40:43], v[152:155], v[184:187], v[40:43]
    s_add_u32 s32, s34, 9216
    buffer_load_dwordx4 v253, s[4:7], s32 offen offset:0 lds
    ds_read_b64_tr_b16 v[136:137], v230 offset:256
    ds_read_b64_tr_b16 v[138:139], v230 offset:6400
    v_mfma_f32_16x16x32_bf16 v[88:91], v[152:155], v[188:191], v[88:91]
    v_mfma_f32_16x16x32_bf16 v[44:47], v[156:159], v[184:187], v[44:47]
    s_add_u32 s32, s34, 8192
    buffer_load_dwordx4 v254, s[4:7], s32 offen offset:1024 lds
    ds_read_b64_tr_b16 v[140:141], v231 offset:256
    ds_read_b64_tr_b16 v[142:143], v231 offset:6400
    v_mfma_f32_16x16x32_bf16 v[92:95], v[156:159], v[188:191], v[92:95]
    s_waitcnt vmcnt(25) lgkmcnt(15)
    v_mfma_f32_16x16x32_bf16 v[0:3], v[96:99], v[192:195], v[0:3]
    s_add_u32 s32, s34, 7168
    buffer_load_dwordx4 v255, s[4:7], s32 offen offset:2048 lds
    ds_read_b64_tr_b16 v[144:145], v228 offset:12288
    ds_read_b64_tr_b16 v[146:147], v228 offset:18432
    v_mfma_f32_16x16x32_bf16 v[48:51], v[96:99], v[196:199], v[48:51]
    v_mfma_f32_16x16x32_bf16 v[4:7], v[100:103], v[192:195], v[4:7]
    s_add_u32 s33, s28, 4
    ds_read_b64_tr_b16 v[148:149], v229 offset:12288
    ds_read_b64_tr_b16 v[150:151], v229 offset:18432
    v_mfma_f32_16x16x32_bf16 v[52:55], v[100:103], v[196:199], v[52:55]
    s_and_b32 s33, s33, 15
    v_mfma_f32_16x16x32_bf16 v[8:11], v[104:107], v[192:195], v[8:11]
    s_mul_i32 s33, s33, 2048
    ds_read_b64_tr_b16 v[152:153], v230 offset:12288
    ds_read_b64_tr_b16 v[154:155], v230 offset:18432
    v_mfma_f32_16x16x32_bf16 v[56:59], v[104:107], v[196:199], v[56:59]
    s_add_u32 s33, s33, s30
    v_mfma_f32_16x16x32_bf16 v[12:15], v[108:111], v[192:195], v[12:15]
    s_add_u32 s33, s33, 1024
    buffer_load_dwordx4 v[168:171], v232, s[8:11], s33 offen sc0 sc1
    ds_read_b64_tr_b16 v[156:157], v231 offset:12288
    ds_read_b64_tr_b16 v[158:159], v231 offset:18432
    v_mfma_f32_16x16x32_bf16 v[60:63], v[108:111], v[196:199], v[60:63]
    s_waitcnt lgkmcnt(15)
    v_mfma_f32_16x16x32_bf16 v[16:19], v[112:115], v[192:195], v[16:19]
    s_add_u32 s33, s33, 131072
    buffer_load_dwordx4 v[172:175], v232, s[8:11], s33 offen sc0 sc1
    ds_read_b64_tr_b16 v[96:97], v228 offset:12416
    ds_read_b64_tr_b16 v[98:99], v228 offset:18560
    v_mfma_f32_16x16x32_bf16 v[64:67], v[112:115], v[196:199], v[64:67]
    v_mfma_f32_16x16x32_bf16 v[20:23], v[116:119], v[192:195], v[20:23]
    ds_read_b64_tr_b16 v[100:101], v229 offset:12416
    ds_read_b64_tr_b16 v[102:103], v229 offset:18560
    v_mfma_f32_16x16x32_bf16 v[68:71], v[116:119], v[196:199], v[68:71]
    v_mfma_f32_16x16x32_bf16 v[24:27], v[120:123], v[192:195], v[24:27]
    ds_read_b64_tr_b16 v[104:105], v230 offset:12416
    ds_read_b64_tr_b16 v[106:107], v230 offset:18560
    v_mfma_f32_16x16x32_bf16 v[72:75], v[120:123], v[196:199], v[72:75]
    v_mfma_f32_16x16x32_bf16 v[28:31], v[124:127], v[192:195], v[28:31]
    ds_read_b64_tr_b16 v[108:109], v231 offset:12416
    ds_read_b64_tr_b16 v[110:111], v231 offset:18560
    v_mfma_f32_16x16x32_bf16 v[76:79], v[124:127], v[196:199], v[76:79]
    s_waitcnt lgkmcnt(15)
    v_mfma_f32_16x16x32_bf16 v[32:35], v[128:131], v[192:195], v[32:35]
    ds_read_b64_tr_b16 v[112:113], v228 offset:12544
    ds_read_b64_tr_b16 v[114:115], v228 offset:18688
    v_mfma_f32_16x16x32_bf16 v[80:83], v[128:131], v[196:199], v[80:83]
    v_mfma_f32_16x16x32_bf16 v[36:39], v[132:135], v[192:195], v[36:39]
    ds_read_b64_tr_b16 v[116:117], v229 offset:12544
    ds_read_b64_tr_b16 v[118:119], v229 offset:18688
    v_mfma_f32_16x16x32_bf16 v[84:87], v[132:135], v[196:199], v[84:87]
    v_mfma_f32_16x16x32_bf16 v[40:43], v[136:139], v[192:195], v[40:43]
    ds_read_b64_tr_b16 v[120:121], v230 offset:12544
    ds_read_b64_tr_b16 v[122:123], v230 offset:18688
    v_mfma_f32_16x16x32_bf16 v[88:91], v[136:139], v[196:199], v[88:91]
    v_mfma_f32_16x16x32_bf16 v[44:47], v[140:143], v[192:195], v[44:47]
    ds_read_b64_tr_b16 v[124:125], v231 offset:12544
    ds_read_b64_tr_b16 v[126:127], v231 offset:18688
    v_mfma_f32_16x16x32_bf16 v[92:95], v[140:143], v[196:199], v[92:95]
    s_waitcnt vmcnt(26) lgkmcnt(15)
    v_mfma_f32_16x16x32_bf16 v[0:3], v[144:147], v[200:203], v[0:3]
    s_add_u32 s33, s28, 5
    v_mfma_f32_16x16x32_bf16 v[48:51], v[144:147], v[204:207], v[48:51]
    s_and_b32 s33, s33, 15
    v_mfma_f32_16x16x32_bf16 v[4:7], v[148:151], v[200:203], v[4:7]
    s_mul_i32 s33, s33, 2048
    v_mfma_f32_16x16x32_bf16 v[52:55], v[148:151], v[204:207], v[52:55]
    s_add_u32 s33, s33, s30
    buffer_load_dwordx4 v[176:179], v232, s[8:11], s33 offen sc0 sc1
    v_mfma_f32_16x16x32_bf16 v[8:11], v[152:155], v[200:203], v[8:11]
    v_mfma_f32_16x16x32_bf16 v[56:59], v[152:155], v[204:207], v[56:59]
    s_add_u32 s33, s33, 131072
    buffer_load_dwordx4 v[180:183], v232, s[8:11], s33 offen sc0 sc1
    v_mfma_f32_16x16x32_bf16 v[12:15], v[156:159], v[200:203], v[12:15]
    s_waitcnt vmcnt(22)
    s_waitcnt lgkmcnt(0)
    s_barrier
    ds_read_b64_tr_b16 v[128:129], v228 offset:24576
    ds_read_b64_tr_b16 v[130:131], v228 offset:30720
    v_mfma_f32_16x16x32_bf16 v[60:63], v[156:159], v[204:207], v[60:63]
    ds_read_b64_tr_b16 v[132:133], v229 offset:24576
    ds_read_b64_tr_b16 v[134:135], v229 offset:30720
    v_mfma_f32_16x16x32_bf16 v[16:19], v[96:99], v[200:203], v[16:19]
    s_add_u32 s34, s28, 6
    ds_read_b64_tr_b16 v[136:137], v230 offset:24576
    ds_read_b64_tr_b16 v[138:139], v230 offset:30720
    v_mfma_f32_16x16x32_bf16 v[64:67], v[96:99], v[204:207], v[64:67]
    s_and_b32 s34, s34, 15
    ds_read_b64_tr_b16 v[140:141], v231 offset:24576
    ds_read_b64_tr_b16 v[142:143], v231 offset:30720
    v_mfma_f32_16x16x32_bf16 v[20:23], v[100:103], v[200:203], v[20:23]
    s_mul_i32 s34, s34, 73728
    ds_read_b64_tr_b16 v[144:145], v228 offset:24704
    ds_read_b64_tr_b16 v[146:147], v228 offset:30848
    v_mfma_f32_16x16x32_bf16 v[68:71], v[100:103], v[204:207], v[68:71]
    s_add_u32 s34, s34, s29
    ds_read_b64_tr_b16 v[148:149], v229 offset:24704
    ds_read_b64_tr_b16 v[150:151], v229 offset:30848
    v_mfma_f32_16x16x32_bf16 v[24:27], v[104:107], v[200:203], v[24:27]
    s_add_u32 m0, s31, 49152
    ds_read_b64_tr_b16 v[152:153], v230 offset:24704
    ds_read_b64_tr_b16 v[154:155], v230 offset:30848
    v_mfma_f32_16x16x32_bf16 v[72:75], v[104:107], v[204:207], v[72:75]
    s_add_u32 s32, s34, 0
    buffer_load_dwordx4 v253, s[4:7], s32 offen offset:0 lds
    v_mfma_f32_16x16x32_bf16 v[28:31], v[108:111], v[200:203], v[28:31]
    ds_read_b64_tr_b16 v[156:157], v231 offset:24704
    ds_read_b64_tr_b16 v[158:159], v231 offset:30848
    v_mfma_f32_16x16x32_bf16 v[76:79], v[108:111], v[204:207], v[76:79]
    s_add_u32 s32, s34, 4294966272
    buffer_load_dwordx4 v254, s[4:7], s32 offen offset:1024 lds
    v_mfma_f32_16x16x32_bf16 v[32:35], v[112:115], v[200:203], v[32:35]
    ds_read_b64_tr_b16 v[96:97], v228 offset:24832
    ds_read_b64_tr_b16 v[98:99], v228 offset:30976
    v_mfma_f32_16x16x32_bf16 v[80:83], v[112:115], v[204:207], v[80:83]
    s_add_u32 s32, s34, 4294965248
    buffer_load_dwordx4 v255, s[4:7], s32 offen offset:2048 lds
    v_mfma_f32_16x16x32_bf16 v[36:39], v[116:119], v[200:203], v[36:39]
    ds_read_b64_tr_b16 v[100:101], v229 offset:24832
    ds_read_b64_tr_b16 v[102:103], v229 offset:30976
    v_mfma_f32_16x16x32_bf16 v[84:87], v[116:119], v[204:207], v[84:87]
    s_add_u32 m0, s31, 52224
    v_mfma_f32_16x16x32_bf16 v[40:43], v[120:123], v[200:203], v[40:43]
    s_add_u32 s32, s34, 9216
    buffer_load_dwordx4 v253, s[4:7], s32 offen offset:0 lds
    ds_read_b64_tr_b16 v[104:105], v230 offset:24832
    ds_read_b64_tr_b16 v[106:107], v230 offset:30976
    v_mfma_f32_16x16x32_bf16 v[88:91], v[120:123], v[204:207], v[88:91]
    v_mfma_f32_16x16x32_bf16 v[44:47], v[124:127], v[200:203], v[44:47]
    s_add_u32 s32, s34, 8192
    buffer_load_dwordx4 v254, s[4:7], s32 offen offset:1024 lds
    ds_read_b64_tr_b16 v[108:109], v231 offset:24832
    ds_read_b64_tr_b16 v[110:111], v231 offset:30976
    v_mfma_f32_16x16x32_bf16 v[92:95], v[124:127], v[204:207], v[92:95]
    s_waitcnt vmcnt(25) lgkmcnt(15)
    v_mfma_f32_16x16x32_bf16 v[0:3], v[128:131], v[208:211], v[0:3]
    s_add_u32 s32, s34, 7168
    buffer_load_dwordx4 v255, s[4:7], s32 offen offset:2048 lds
    ds_read_b64_tr_b16 v[112:113], v228 offset:36864
    ds_read_b64_tr_b16 v[114:115], v228 offset:43008
    v_mfma_f32_16x16x32_bf16 v[48:51], v[128:131], v[212:215], v[48:51]
    v_mfma_f32_16x16x32_bf16 v[4:7], v[132:135], v[208:211], v[4:7]
    s_add_u32 s33, s28, 5
    ds_read_b64_tr_b16 v[116:117], v229 offset:36864
    ds_read_b64_tr_b16 v[118:119], v229 offset:43008
    v_mfma_f32_16x16x32_bf16 v[52:55], v[132:135], v[212:215], v[52:55]
    s_and_b32 s33, s33, 15
    v_mfma_f32_16x16x32_bf16 v[8:11], v[136:139], v[208:211], v[8:11]
    s_mul_i32 s33, s33, 2048
    ds_read_b64_tr_b16 v[120:121], v230 offset:36864
    ds_read_b64_tr_b16 v[122:123], v230 offset:43008
    v_mfma_f32_16x16x32_bf16 v[56:59], v[136:139], v[212:215], v[56:59]
    s_add_u32 s33, s33, s30
    v_mfma_f32_16x16x32_bf16 v[12:15], v[140:143], v[208:211], v[12:15]
    s_add_u32 s33, s33, 1024
    buffer_load_dwordx4 v[184:187], v232, s[8:11], s33 offen sc0 sc1
    ds_read_b64_tr_b16 v[124:125], v231 offset:36864
    ds_read_b64_tr_b16 v[126:127], v231 offset:43008
    v_mfma_f32_16x16x32_bf16 v[60:63], v[140:143], v[212:215], v[60:63]
    s_waitcnt lgkmcnt(15)
    v_mfma_f32_16x16x32_bf16 v[16:19], v[144:147], v[208:211], v[16:19]
    s_add_u32 s33, s33, 131072
    buffer_load_dwordx4 v[188:191], v232, s[8:11], s33 offen sc0 sc1
    ds_read_b64_tr_b16 v[128:129], v228 offset:36992
    ds_read_b64_tr_b16 v[130:131], v228 offset:43136
    v_mfma_f32_16x16x32_bf16 v[64:67], v[144:147], v[212:215], v[64:67]
    v_mfma_f32_16x16x32_bf16 v[20:23], v[148:151], v[208:211], v[20:23]
    ds_read_b64_tr_b16 v[132:133], v229 offset:36992
    ds_read_b64_tr_b16 v[134:135], v229 offset:43136
    v_mfma_f32_16x16x32_bf16 v[68:71], v[148:151], v[212:215], v[68:71]
    v_mfma_f32_16x16x32_bf16 v[24:27], v[152:155], v[208:211], v[24:27]
    ds_read_b64_tr_b16 v[136:137], v230 offset:36992
    ds_read_b64_tr_b16 v[138:139], v230 offset:43136
    v_mfma_f32_16x16x32_bf16 v[72:75], v[152:155], v[212:215], v[72:75]
    v_mfma_f32_16x16x32_bf16 v[28:31], v[156:159], v[208:211], v[28:31]
    ds_read_b64_tr_b16 v[140:141], v231 offset:36992
    ds_read_b64_tr_b16 v[142:143], v231 offset:43136
    v_mfma_f32_16x16x32_bf16 v[76:79], v[156:159], v[212:215], v[76:79]
    s_waitcnt lgkmcnt(15)
    v_mfma_f32_16x16x32_bf16 v[32:35], v[96:99], v[208:211], v[32:35]
    ds_read_b64_tr_b16 v[144:145], v228 offset:37120
    ds_read_b64_tr_b16 v[146:147], v228 offset:43264
    v_mfma_f32_16x16x32_bf16 v[80:83], v[96:99], v[212:215], v[80:83]
    v_mfma_f32_16x16x32_bf16 v[36:39], v[100:103], v[208:211], v[36:39]
    ds_read_b64_tr_b16 v[148:149], v229 offset:37120
    ds_read_b64_tr_b16 v[150:151], v229 offset:43264
    v_mfma_f32_16x16x32_bf16 v[84:87], v[100:103], v[212:215], v[84:87]
    v_mfma_f32_16x16x32_bf16 v[40:43], v[104:107], v[208:211], v[40:43]
    ds_read_b64_tr_b16 v[152:153], v230 offset:37120
    ds_read_b64_tr_b16 v[154:155], v230 offset:43264
    v_mfma_f32_16x16x32_bf16 v[88:91], v[104:107], v[212:215], v[88:91]
    v_mfma_f32_16x16x32_bf16 v[44:47], v[108:111], v[208:211], v[44:47]
    ds_read_b64_tr_b16 v[156:157], v231 offset:37120
    ds_read_b64_tr_b16 v[158:159], v231 offset:43264
    v_mfma_f32_16x16x32_bf16 v[92:95], v[108:111], v[212:215], v[92:95]
    s_waitcnt vmcnt(20) lgkmcnt(15)
    v_mfma_f32_16x16x32_bf16 v[0:3], v[112:115], v[216:219], v[0:3]
    s_add_u32 s33, s28, 6
    v_mfma_f32_16x16x32_bf16 v[48:51], v[112:115], v[220:223], v[48:51]
    s_and_b32 s33, s33, 15
    v_mfma_f32_16x16x32_bf16 v[4:7], v[116:119], v[216:219], v[4:7]
    s_mul_i32 s33, s33, 2048
    v_mfma_f32_16x16x32_bf16 v[52:55], v[116:119], v[220:223], v[52:55]
    s_add_u32 s33, s33, s30
    buffer_load_dwordx4 v[192:195], v232, s[8:11], s33 offen sc0 sc1
    v_mfma_f32_16x16x32_bf16 v[8:11], v[120:123], v[216:219], v[8:11]
    v_mfma_f32_16x16x32_bf16 v[56:59], v[120:123], v[220:223], v[56:59]
    s_add_u32 s33, s33, 131072
    buffer_load_dwordx4 v[196:199], v232, s[8:11], s33 offen sc0 sc1
    v_mfma_f32_16x16x32_bf16 v[12:15], v[124:127], v[216:219], v[12:15]
    s_waitcnt lgkmcnt(0)
    s_barrier
    ds_read_b64_tr_b16 v[96:97], v224 offset:0
    ds_read_b64_tr_b16 v[98:99], v224 offset:6144
    v_mfma_f32_16x16x32_bf16 v[60:63], v[124:127], v[220:223], v[60:63]
    ds_read_b64_tr_b16 v[100:101], v225 offset:0
    ds_read_b64_tr_b16 v[102:103], v225 offset:6144
    v_mfma_f32_16x16x32_bf16 v[16:19], v[128:131], v[216:219], v[16:19]
    s_add_u32 s34, s28, 7
    ds_read_b64_tr_b16 v[104:105], v226 offset:0
    ds_read_b64_tr_b16 v[106:107], v226 offset:6144
    v_mfma_f32_16x16x32_bf16 v[64:67], v[128:131], v[220:223], v[64:67]
    s_and_b32 s34, s34, 15
    ds_read_b64_tr_b16 v[108:109], v227 offset:0
    ds_read_b64_tr_b16 v[110:111], v227 offset:6144
    v_mfma_f32_16x16x32_bf16 v[20:23], v[132:135], v[216:219], v[20:23]
    s_mul_i32 s34, s34, 73728
    ds_read_b64_tr_b16 v[112:113], v224 offset:128
    ds_read_b64_tr_b16 v[114:115], v224 offset:6272
    v_mfma_f32_16x16x32_bf16 v[68:71], v[132:135], v[220:223], v[68:71]
    s_add_u32 s34, s34, s29
    ds_read_b64_tr_b16 v[116:117], v225 offset:128
    ds_read_b64_tr_b16 v[118:119], v225 offset:6272
    v_mfma_f32_16x16x32_bf16 v[24:27], v[136:139], v[216:219], v[24:27]
    s_add_u32 m0, s31, 73728
    ds_read_b64_tr_b16 v[120:121], v226 offset:128
    ds_read_b64_tr_b16 v[122:123], v226 offset:6272
    v_mfma_f32_16x16x32_bf16 v[72:75], v[136:139], v[220:223], v[72:75]
    s_add_u32 s32, s34, 0
    buffer_load_dwordx4 v253, s[4:7], s32 offen offset:0 lds
    v_mfma_f32_16x16x32_bf16 v[28:31], v[140:143], v[216:219], v[28:31]
    ds_read_b64_tr_b16 v[124:125], v227 offset:128
    ds_read_b64_tr_b16 v[126:127], v227 offset:6272
    v_mfma_f32_16x16x32_bf16 v[76:79], v[140:143], v[220:223], v[76:79]
    s_add_u32 s32, s34, 4294966272
    buffer_load_dwordx4 v254, s[4:7], s32 offen offset:1024 lds
    v_mfma_f32_16x16x32_bf16 v[32:35], v[144:147], v[216:219], v[32:35]
    ds_read_b64_tr_b16 v[128:129], v224 offset:256
    ds_read_b64_tr_b16 v[130:131], v224 offset:6400
    v_mfma_f32_16x16x32_bf16 v[80:83], v[144:147], v[220:223], v[80:83]
    s_add_u32 s32, s34, 4294965248
    buffer_load_dwordx4 v255, s[4:7], s32 offen offset:2048 lds
    v_mfma_f32_16x16x32_bf16 v[36:39], v[148:151], v[216:219], v[36:39]
    ds_read_b64_tr_b16 v[132:133], v225 offset:256
    ds_read_b64_tr_b16 v[134:135], v225 offset:6400
    v_mfma_f32_16x16x32_bf16 v[84:87], v[148:151], v[220:223], v[84:87]
    s_add_u32 m0, s31, 76800
    v_mfma_f32_16x16x32_bf16 v[40:43], v[152:155], v[216:219], v[40:43]
    s_add_u32 s32, s34, 9216
    buffer_load_dwordx4 v253, s[4:7], s32 offen offset:0 lds
    ds_read_b64_tr_b16 v[136:137], v226 offset:256
    ds_read_b64_tr_b16 v[138:139], v226 offset:6400
    v_mfma_f32_16x16x32_bf16 v[88:91], v[152:155], v[220:223], v[88:91]
    v_mfma_f32_16x16x32_bf16 v[44:47], v[156:159], v[216:219], v[44:47]
    s_add_u32 s32, s34, 8192
    buffer_load_dwordx4 v254, s[4:7], s32 offen offset:1024 lds
    ds_read_b64_tr_b16 v[140:141], v227 offset:256
    ds_read_b64_tr_b16 v[142:143], v227 offset:6400
    v_mfma_f32_16x16x32_bf16 v[92:95], v[156:159], v[220:223], v[92:95]
    s_waitcnt vmcnt(25) lgkmcnt(15)
    v_mfma_f32_16x16x32_bf16 v[0:3], v[96:99], v[160:163], v[0:3]
    s_add_u32 s32, s34, 7168
    buffer_load_dwordx4 v255, s[4:7], s32 offen offset:2048 lds
    ds_read_b64_tr_b16 v[144:145], v224 offset:12288
    ds_read_b64_tr_b16 v[146:147], v224 offset:18432
    v_mfma_f32_16x16x32_bf16 v[48:51], v[96:99], v[164:167], v[48:51]
    v_mfma_f32_16x16x32_bf16 v[4:7], v[100:103], v[160:163], v[4:7]
    s_add_u32 s33, s28, 6
    ds_read_b64_tr_b16 v[148:149], v225 offset:12288
    ds_read_b64_tr_b16 v[150:151], v225 offset:18432
    v_mfma_f32_16x16x32_bf16 v[52:55], v[100:103], v[164:167], v[52:55]
    s_and_b32 s33, s33, 15
    v_mfma_f32_16x16x32_bf16 v[8:11], v[104:107], v[160:163], v[8:11]
    s_mul_i32 s33, s33, 2048
    ds_read_b64_tr_b16 v[152:153], v226 offset:12288
    ds_read_b64_tr_b16 v[154:155], v226 offset:18432
    v_mfma_f32_16x16x32_bf16 v[56:59], v[104:107], v[164:167], v[56:59]
    s_add_u32 s33, s33, s30
    v_mfma_f32_16x16x32_bf16 v[12:15], v[108:111], v[160:163], v[12:15]
    s_add_u32 s33, s33, 1024
    buffer_load_dwordx4 v[200:203], v232, s[8:11], s33 offen sc0 sc1
    ds_read_b64_tr_b16 v[156:157], v227 offset:12288
    ds_read_b64_tr_b16 v[158:159], v227 offset:18432
    v_mfma_f32_16x16x32_bf16 v[60:63], v[108:111], v[164:167], v[60:63]
    s_waitcnt lgkmcnt(15)
    v_mfma_f32_16x16x32_bf16 v[16:19], v[112:115], v[160:163], v[16:19]
    s_add_u32 s33, s33, 131072
    buffer_load_dwordx4 v[204:207], v232, s[8:11], s33 offen sc0 sc1
    ds_read_b64_tr_b16 v[96:97], v224 offset:12416
    ds_read_b64_tr_b16 v[98:99], v224 offset:18560
    v_mfma_f32_16x16x32_bf16 v[64:67], v[112:115], v[164:167], v[64:67]
    v_mfma_f32_16x16x32_bf16 v[20:23], v[116:119], v[160:163], v[20:23]
    ds_read_b64_tr_b16 v[100:101], v225 offset:12416
    ds_read_b64_tr_b16 v[102:103], v225 offset:18560
    v_mfma_f32_16x16x32_bf16 v[68:71], v[116:119], v[164:167], v[68:71]
    v_mfma_f32_16x16x32_bf16 v[24:27], v[120:123], v[160:163], v[24:27]
    ds_read_b64_tr_b16 v[104:105], v226 offset:12416
    ds_read_b64_tr_b16 v[106:107], v226 offset:18560
    v_mfma_f32_16x16x32_bf16 v[72:75], v[120:123], v[164:167], v[72:75]
    v_mfma_f32_16x16x32_bf16 v[28:31], v[124:127], v[160:163], v[28:31]
    ds_read_b64_tr_b16 v[108:109], v227 offset:12416
    ds_read_b64_tr_b16 v[110:111], v227 offset:18560
    v_mfma_f32_16x16x32_bf16 v[76:79], v[124:127], v[164:167], v[76:79]
    s_waitcnt lgkmcnt(15)
    v_mfma_f32_16x16x32_bf16 v[32:35], v[128:131], v[160:163], v[32:35]
    ds_read_b64_tr_b16 v[112:113], v224 offset:12544
    ds_read_b64_tr_b16 v[114:115], v224 offset:18688
    v_mfma_f32_16x16x32_bf16 v[80:83], v[128:131], v[164:167], v[80:83]
    v_mfma_f32_16x16x32_bf16 v[36:39], v[132:135], v[160:163], v[36:39]
    ds_read_b64_tr_b16 v[116:117], v225 offset:12544
    ds_read_b64_tr_b16 v[118:119], v225 offset:18688
    v_mfma_f32_16x16x32_bf16 v[84:87], v[132:135], v[164:167], v[84:87]
    v_mfma_f32_16x16x32_bf16 v[40:43], v[136:139], v[160:163], v[40:43]
    ds_read_b64_tr_b16 v[120:121], v226 offset:12544
    ds_read_b64_tr_b16 v[122:123], v226 offset:18688
    v_mfma_f32_16x16x32_bf16 v[88:91], v[136:139], v[164:167], v[88:91]
    v_mfma_f32_16x16x32_bf16 v[44:47], v[140:143], v[160:163], v[44:47]
    ds_read_b64_tr_b16 v[124:125], v227 offset:12544
    ds_read_b64_tr_b16 v[126:127], v227 offset:18688
    v_mfma_f32_16x16x32_bf16 v[92:95], v[140:143], v[164:167], v[92:95]
    s_waitcnt vmcnt(20) lgkmcnt(15)
    v_mfma_f32_16x16x32_bf16 v[0:3], v[144:147], v[168:171], v[0:3]
    s_add_u32 s33, s28, 7
    v_mfma_f32_16x16x32_bf16 v[48:51], v[144:147], v[172:175], v[48:51]
    s_and_b32 s33, s33, 15
    v_mfma_f32_16x16x32_bf16 v[4:7], v[148:151], v[168:171], v[4:7]
    s_mul_i32 s33, s33, 2048
    v_mfma_f32_16x16x32_bf16 v[52:55], v[148:151], v[172:175], v[52:55]
    s_add_u32 s33, s33, s30
    buffer_load_dwordx4 v[208:211], v232, s[8:11], s33 offen sc0 sc1
    v_mfma_f32_16x16x32_bf16 v[8:11], v[152:155], v[168:171], v[8:11]
    v_mfma_f32_16x16x32_bf16 v[56:59], v[152:155], v[172:175], v[56:59]
    s_add_u32 s33, s33, 131072
    buffer_load_dwordx4 v[212:215], v232, s[8:11], s33 offen sc0 sc1
    v_mfma_f32_16x16x32_bf16 v[12:15], v[156:159], v[168:171], v[12:15]
    s_waitcnt lgkmcnt(0)
    s_barrier
    ds_read_b64_tr_b16 v[128:129], v224 offset:24576
    ds_read_b64_tr_b16 v[130:131], v224 offset:30720
    v_mfma_f32_16x16x32_bf16 v[60:63], v[156:159], v[172:175], v[60:63]
    ds_read_b64_tr_b16 v[132:133], v225 offset:24576
    ds_read_b64_tr_b16 v[134:135], v225 offset:30720
    v_mfma_f32_16x16x32_bf16 v[16:19], v[96:99], v[168:171], v[16:19]
    s_add_u32 s34, s28, 8
    ds_read_b64_tr_b16 v[136:137], v226 offset:24576
    ds_read_b64_tr_b16 v[138:139], v226 offset:30720
    v_mfma_f32_16x16x32_bf16 v[64:67], v[96:99], v[172:175], v[64:67]
    s_and_b32 s34, s34, 15
    ds_read_b64_tr_b16 v[140:141], v227 offset:24576
    ds_read_b64_tr_b16 v[142:143], v227 offset:30720
    v_mfma_f32_16x16x32_bf16 v[20:23], v[100:103], v[168:171], v[20:23]
    s_mul_i32 s34, s34, 73728
    ds_read_b64_tr_b16 v[144:145], v224 offset:24704
    ds_read_b64_tr_b16 v[146:147], v224 offset:30848
    v_mfma_f32_16x16x32_bf16 v[68:71], v[100:103], v[172:175], v[68:71]
    s_add_u32 s34, s34, s29
    ds_read_b64_tr_b16 v[148:149], v225 offset:24704
    ds_read_b64_tr_b16 v[150:151], v225 offset:30848
    v_mfma_f32_16x16x32_bf16 v[24:27], v[104:107], v[168:171], v[24:27]
    s_add_u32 m0, s31, 0
    ds_read_b64_tr_b16 v[152:153], v226 offset:24704
    ds_read_b64_tr_b16 v[154:155], v226 offset:30848
    v_mfma_f32_16x16x32_bf16 v[72:75], v[104:107], v[172:175], v[72:75]
    s_add_u32 s32, s34, 0
    buffer_load_dwordx4 v253, s[4:7], s32 offen offset:0 lds
    v_mfma_f32_16x16x32_bf16 v[28:31], v[108:111], v[168:171], v[28:31]
    ds_read_b64_tr_b16 v[156:157], v227 offset:24704
    ds_read_b64_tr_b16 v[158:159], v227 offset:30848
    v_mfma_f32_16x16x32_bf16 v[76:79], v[108:111], v[172:175], v[76:79]
    s_add_u32 s32, s34, 4294966272
    buffer_load_dwordx4 v254, s[4:7], s32 offen offset:1024 lds
    v_mfma_f32_16x16x32_bf16 v[32:35], v[112:115], v[168:171], v[32:35]
    ds_read_b64_tr_b16 v[96:97], v224 offset:24832
    ds_read_b64_tr_b16 v[98:99], v224 offset:30976
    v_mfma_f32_16x16x32_bf16 v[80:83], v[112:115], v[172:175], v[80:83]
    s_add_u32 s32, s34, 4294965248
    buffer_load_dwordx4 v255, s[4:7], s32 offen offset:2048 lds
    v_mfma_f32_16x16x32_bf16 v[36:39], v[116:119], v[168:171], v[36:39]
    ds_read_b64_tr_b16 v[100:101], v225 offset:24832
    ds_read_b64_tr_b16 v[102:103], v225 offset:30976
    v_mfma_f32_16x16x32_bf16 v[84:87], v[116:119], v[172:175], v[84:87]
    s_add_u32 m0, s31, 3072
    v_mfma_f32_16x16x32_bf16 v[40:43], v[120:123], v[168:171], v[40:43]
    s_add_u32 s32, s34, 9216
    buffer_load_dwordx4 v253, s[4:7], s32 offen offset:0 lds
    ds_read_b64_tr_b16 v[104:105], v226 offset:24832
    ds_read_b64_tr_b16 v[106:107], v226 offset:30976
    v_mfma_f32_16x16x32_bf16 v[88:91], v[120:123], v[172:175], v[88:91]
    v_mfma_f32_16x16x32_bf16 v[44:47], v[124:127], v[168:171], v[44:47]
    s_add_u32 s32, s34, 8192
    buffer_load_dwordx4 v254, s[4:7], s32 offen offset:1024 lds
    ds_read_b64_tr_b16 v[108:109], v227 offset:24832
    ds_read_b64_tr_b16 v[110:111], v227 offset:30976
    v_mfma_f32_16x16x32_bf16 v[92:95], v[124:127], v[172:175], v[92:95]
    s_waitcnt vmcnt(25) lgkmcnt(15)
    v_mfma_f32_16x16x32_bf16 v[0:3], v[128:131], v[176:179], v[0:3]
    s_add_u32 s32, s34, 7168
    buffer_load_dwordx4 v255, s[4:7], s32 offen offset:2048 lds
    ds_read_b64_tr_b16 v[112:113], v224 offset:36864
    ds_read_b64_tr_b16 v[114:115], v224 offset:43008
    v_mfma_f32_16x16x32_bf16 v[48:51], v[128:131], v[180:183], v[48:51]
    v_mfma_f32_16x16x32_bf16 v[4:7], v[132:135], v[176:179], v[4:7]
    s_add_u32 s33, s28, 7
    ds_read_b64_tr_b16 v[116:117], v225 offset:36864
    ds_read_b64_tr_b16 v[118:119], v225 offset:43008
    v_mfma_f32_16x16x32_bf16 v[52:55], v[132:135], v[180:183], v[52:55]
    s_and_b32 s33, s33, 15
    v_mfma_f32_16x16x32_bf16 v[8:11], v[136:139], v[176:179], v[8:11]
    s_mul_i32 s33, s33, 2048
    ds_read_b64_tr_b16 v[120:121], v226 offset:36864
    ds_read_b64_tr_b16 v[122:123], v226 offset:43008
    v_mfma_f32_16x16x32_bf16 v[56:59], v[136:139], v[180:183], v[56:59]
    s_add_u32 s33, s33, s30
    v_mfma_f32_16x16x32_bf16 v[12:15], v[140:143], v[176:179], v[12:15]
    s_add_u32 s33, s33, 1024
    buffer_load_dwordx4 v[216:219], v232, s[8:11], s33 offen sc0 sc1
    ds_read_b64_tr_b16 v[124:125], v227 offset:36864
    ds_read_b64_tr_b16 v[126:127], v227 offset:43008
    v_mfma_f32_16x16x32_bf16 v[60:63], v[140:143], v[180:183], v[60:63]
    s_waitcnt lgkmcnt(15)
    v_mfma_f32_16x16x32_bf16 v[16:19], v[144:147], v[176:179], v[16:19]
    s_add_u32 s33, s33, 131072
    buffer_load_dwordx4 v[220:223], v232, s[8:11], s33 offen sc0 sc1
    ds_read_b64_tr_b16 v[128:129], v224 offset:36992
    ds_read_b64_tr_b16 v[130:131], v224 offset:43136
    v_mfma_f32_16x16x32_bf16 v[64:67], v[144:147], v[180:183], v[64:67]
    v_mfma_f32_16x16x32_bf16 v[20:23], v[148:151], v[176:179], v[20:23]
    ds_read_b64_tr_b16 v[132:133], v225 offset:36992
    ds_read_b64_tr_b16 v[134:135], v225 offset:43136
    v_mfma_f32_16x16x32_bf16 v[68:71], v[148:151], v[180:183], v[68:71]
    v_mfma_f32_16x16x32_bf16 v[24:27], v[152:155], v[176:179], v[24:27]
    ds_read_b64_tr_b16 v[136:137], v226 offset:36992
    ds_read_b64_tr_b16 v[138:139], v226 offset:43136
    v_mfma_f32_16x16x32_bf16 v[72:75], v[152:155], v[180:183], v[72:75]
    v_mfma_f32_16x16x32_bf16 v[28:31], v[156:159], v[176:179], v[28:31]
    ds_read_b64_tr_b16 v[140:141], v227 offset:36992
    ds_read_b64_tr_b16 v[142:143], v227 offset:43136
    v_mfma_f32_16x16x32_bf16 v[76:79], v[156:159], v[180:183], v[76:79]
    s_waitcnt lgkmcnt(15)
    v_mfma_f32_16x16x32_bf16 v[32:35], v[96:99], v[176:179], v[32:35]
    ds_read_b64_tr_b16 v[144:145], v224 offset:37120
    ds_read_b64_tr_b16 v[146:147], v224 offset:43264
    v_mfma_f32_16x16x32_bf16 v[80:83], v[96:99], v[180:183], v[80:83]
    v_mfma_f32_16x16x32_bf16 v[36:39], v[100:103], v[176:179], v[36:39]
    ds_read_b64_tr_b16 v[148:149], v225 offset:37120
    ds_read_b64_tr_b16 v[150:151], v225 offset:43264
    v_mfma_f32_16x16x32_bf16 v[84:87], v[100:103], v[180:183], v[84:87]
    v_mfma_f32_16x16x32_bf16 v[40:43], v[104:107], v[176:179], v[40:43]
    ds_read_b64_tr_b16 v[152:153], v226 offset:37120
    ds_read_b64_tr_b16 v[154:155], v226 offset:43264
    v_mfma_f32_16x16x32_bf16 v[88:91], v[104:107], v[180:183], v[88:91]
    v_mfma_f32_16x16x32_bf16 v[44:47], v[108:111], v[176:179], v[44:47]
    ds_read_b64_tr_b16 v[156:157], v227 offset:37120
    ds_read_b64_tr_b16 v[158:159], v227 offset:43264
    v_mfma_f32_16x16x32_bf16 v[92:95], v[108:111], v[180:183], v[92:95]
    s_waitcnt vmcnt(20) lgkmcnt(15)
    v_mfma_f32_16x16x32_bf16 v[0:3], v[112:115], v[184:187], v[0:3]
    s_add_u32 s33, s28, 8
    v_mfma_f32_16x16x32_bf16 v[48:51], v[112:115], v[188:191], v[48:51]
    s_and_b32 s33, s33, 15
    v_mfma_f32_16x16x32_bf16 v[4:7], v[116:119], v[184:187], v[4:7]
    s_mul_i32 s33, s33, 2048
    v_mfma_f32_16x16x32_bf16 v[52:55], v[116:119], v[188:191], v[52:55]
    s_add_u32 s33, s33, s30
    buffer_load_dwordx4 v[160:163], v232, s[8:11], s33 offen sc0 sc1
    v_mfma_f32_16x16x32_bf16 v[8:11], v[120:123], v[184:187], v[8:11]
    v_mfma_f32_16x16x32_bf16 v[56:59], v[120:123], v[188:191], v[56:59]
    s_add_u32 s33, s33, 131072
    buffer_load_dwordx4 v[164:167], v232, s[8:11], s33 offen sc0 sc1
    v_mfma_f32_16x16x32_bf16 v[12:15], v[124:127], v[184:187], v[12:15]
    s_waitcnt lgkmcnt(0)
    s_barrier
    ds_read_b64_tr_b16 v[96:97], v228 offset:0
    ds_read_b64_tr_b16 v[98:99], v228 offset:6144
    v_mfma_f32_16x16x32_bf16 v[60:63], v[124:127], v[188:191], v[60:63]
    ds_read_b64_tr_b16 v[100:101], v229 offset:0
    ds_read_b64_tr_b16 v[102:103], v229 offset:6144
    v_mfma_f32_16x16x32_bf16 v[16:19], v[128:131], v[184:187], v[16:19]
    s_add_u32 s34, s28, 9
    ds_read_b64_tr_b16 v[104:105], v230 offset:0
    ds_read_b64_tr_b16 v[106:107], v230 offset:6144
    v_mfma_f32_16x16x32_bf16 v[64:67], v[128:131], v[188:191], v[64:67]
    s_and_b32 s34, s34, 15
    ds_read_b64_tr_b16 v[108:109], v231 offset:0
    ds_read_b64_tr_b16 v[110:111], v231 offset:6144
    v_mfma_f32_16x16x32_bf16 v[20:23], v[132:135], v[184:187], v[20:23]
    s_mul_i32 s34, s34, 73728
    ds_read_b64_tr_b16 v[112:113], v228 offset:128
    ds_read_b64_tr_b16 v[114:115], v228 offset:6272
    v_mfma_f32_16x16x32_bf16 v[68:71], v[132:135], v[188:191], v[68:71]
    s_add_u32 s34, s34, s29
    ds_read_b64_tr_b16 v[116:117], v229 offset:128
    ds_read_b64_tr_b16 v[118:119], v229 offset:6272
    v_mfma_f32_16x16x32_bf16 v[24:27], v[136:139], v[184:187], v[24:27]
    s_add_u32 m0, s31, 24576
    ds_read_b64_tr_b16 v[120:121], v230 offset:128
    ds_read_b64_tr_b16 v[122:123], v230 offset:6272
    v_mfma_f32_16x16x32_bf16 v[72:75], v[136:139], v[188:191], v[72:75]
    s_add_u32 s32, s34, 0
    buffer_load_dwordx4 v253, s[4:7], s32 offen offset:0 lds
    v_mfma_f32_16x16x32_bf16 v[28:31], v[140:143], v[184:187], v[28:31]
    ds_read_b64_tr_b16 v[124:125], v231 offset:128
    ds_read_b64_tr_b16 v[126:127], v231 offset:6272
    v_mfma_f32_16x16x32_bf16 v[76:79], v[140:143], v[188:191], v[76:79]
    s_add_u32 s32, s34, 4294966272
    buffer_load_dwordx4 v254, s[4:7], s32 offen offset:1024 lds
    v_mfma_f32_16x16x32_bf16 v[32:35], v[144:147], v[184:187], v[32:35]
    ds_read_b64_tr_b16 v[128:129], v228 offset:256
    ds_read_b64_tr_b16 v[130:131], v228 offset:6400
    v_mfma_f32_16x16x32_bf16 v[80:83], v[144:147], v[188:191], v[80:83]
    s_add_u32 s32, s34, 4294965248
    buffer_load_dwordx4 v255, s[4:7], s32 offen offset:2048 lds
    v_mfma_f32_16x16x32_bf16 v[36:39], v[148:151], v[184:187], v[36:39]
    ds_read_b64_tr_b16 v[132:133], v229 offset:256
    ds_read_b64_tr_b16 v[134:135], v229 offset:6400
    v_mfma_f32_16x16x32_bf16 v[84:87], v[148:151], v[188:191], v[84:87]
    s_add_u32 m0, s31, 27648
    v_mfma_f32_16x16x32_bf16 v[40:43], v[152:155], v[184:187], v[40:43]
    s_add_u32 s32, s34, 9216
    buffer_load_dwordx4 v253, s[4:7], s32 offen offset:0 lds
    ds_read_b64_tr_b16 v[136:137], v230 offset:256
    ds_read_b64_tr_b16 v[138:139], v230 offset:6400
    v_mfma_f32_16x16x32_bf16 v[88:91], v[152:155], v[188:191], v[88:91]
    v_mfma_f32_16x16x32_bf16 v[44:47], v[156:159], v[184:187], v[44:47]
    s_add_u32 s32, s34, 8192
    buffer_load_dwordx4 v254, s[4:7], s32 offen offset:1024 lds
    ds_read_b64_tr_b16 v[140:141], v231 offset:256
    ds_read_b64_tr_b16 v[142:143], v231 offset:6400
    v_mfma_f32_16x16x32_bf16 v[92:95], v[156:159], v[188:191], v[92:95]
    s_waitcnt vmcnt(25) lgkmcnt(15)
    v_mfma_f32_16x16x32_bf16 v[0:3], v[96:99], v[192:195], v[0:3]
    s_add_u32 s32, s34, 7168
    buffer_load_dwordx4 v255, s[4:7], s32 offen offset:2048 lds
    ds_read_b64_tr_b16 v[144:145], v228 offset:12288
    ds_read_b64_tr_b16 v[146:147], v228 offset:18432
    v_mfma_f32_16x16x32_bf16 v[48:51], v[96:99], v[196:199], v[48:51]
    v_mfma_f32_16x16x32_bf16 v[4:7], v[100:103], v[192:195], v[4:7]
    s_add_u32 s33, s28, 8
    ds_read_b64_tr_b16 v[148:149], v229 offset:12288
    ds_read_b64_tr_b16 v[150:151], v229 offset:18432
    v_mfma_f32_16x16x32_bf16 v[52:55], v[100:103], v[196:199], v[52:55]
    s_and_b32 s33, s33, 15
    v_mfma_f32_16x16x32_bf16 v[8:11], v[104:107], v[192:195], v[8:11]
    s_mul_i32 s33, s33, 2048
    ds_read_b64_tr_b16 v[152:153], v230 offset:12288
    ds_read_b64_tr_b16 v[154:155], v230 offset:18432
    v_mfma_f32_16x16x32_bf16 v[56:59], v[104:107], v[196:199], v[56:59]
    s_add_u32 s33, s33, s30
    v_mfma_f32_16x16x32_bf16 v[12:15], v[108:111], v[192:195], v[12:15]
    s_add_u32 s33, s33, 1024
    buffer_load_dwordx4 v[168:171], v232, s[8:11], s33 offen sc0 sc1
    ds_read_b64_tr_b16 v[156:157], v231 offset:12288
    ds_read_b64_tr_b16 v[158:159], v231 offset:18432
    v_mfma_f32_16x16x32_bf16 v[60:63], v[108:111], v[196:199], v[60:63]
    s_waitcnt lgkmcnt(15)
    v_mfma_f32_16x16x32_bf16 v[16:19], v[112:115], v[192:195], v[16:19]
    s_add_u32 s33, s33, 131072
    buffer_load_dwordx4 v[172:175], v232, s[8:11], s33 offen sc0 sc1
    ds_read_b64_tr_b16 v[96:97], v228 offset:12416
    ds_read_b64_tr_b16 v[98:99], v228 offset:18560
    v_mfma_f32_16x16x32_bf16 v[64:67], v[112:115], v[196:199], v[64:67]
    v_mfma_f32_16x16x32_bf16 v[20:23], v[116:119], v[192:195], v[20:23]
    ds_read_b64_tr_b16 v[100:101], v229 offset:12416
    ds_read_b64_tr_b16 v[102:103], v229 offset:18560
    v_mfma_f32_16x16x32_bf16 v[68:71], v[116:119], v[196:199], v[68:71]
    v_mfma_f32_16x16x32_bf16 v[24:27], v[120:123], v[192:195], v[24:27]
    ds_read_b64_tr_b16 v[104:105], v230 offset:12416
    ds_read_b64_tr_b16 v[106:107], v230 offset:18560
    v_mfma_f32_16x16x32_bf16 v[72:75], v[120:123], v[196:199], v[72:75]
    v_mfma_f32_16x16x32_bf16 v[28:31], v[124:127], v[192:195], v[28:31]
    ds_read_b64_tr_b16 v[108:109], v231 offset:12416
    ds_read_b64_tr_b16 v[110:111], v231 offset:18560
    v_mfma_f32_16x16x32_bf16 v[76:79], v[124:127], v[196:199], v[76:79]
    s_waitcnt lgkmcnt(15)
    v_mfma_f32_16x16x32_bf16 v[32:35], v[128:131], v[192:195], v[32:35]
    ds_read_b64_tr_b16 v[112:113], v228 offset:12544
    ds_read_b64_tr_b16 v[114:115], v228 offset:18688
    v_mfma_f32_16x16x32_bf16 v[80:83], v[128:131], v[196:199], v[80:83]
    v_mfma_f32_16x16x32_bf16 v[36:39], v[132:135], v[192:195], v[36:39]
    ds_read_b64_tr_b16 v[116:117], v229 offset:12544
    ds_read_b64_tr_b16 v[118:119], v229 offset:18688
    v_mfma_f32_16x16x32_bf16 v[84:87], v[132:135], v[196:199], v[84:87]
    v_mfma_f32_16x16x32_bf16 v[40:43], v[136:139], v[192:195], v[40:43]
    ds_read_b64_tr_b16 v[120:121], v230 offset:12544
    ds_read_b64_tr_b16 v[122:123], v230 offset:18688
    v_mfma_f32_16x16x32_bf16 v[88:91], v[136:139], v[196:199], v[88:91]
    v_mfma_f32_16x16x32_bf16 v[44:47], v[140:143], v[192:195], v[44:47]
    ds_read_b64_tr_b16 v[124:125], v231 offset:12544
    ds_read_b64_tr_b16 v[126:127], v231 offset:18688
    v_mfma_f32_16x16x32_bf16 v[92:95], v[140:143], v[196:199], v[92:95]
    s_waitcnt vmcnt(20) lgkmcnt(15)
    v_mfma_f32_16x16x32_bf16 v[0:3], v[144:147], v[200:203], v[0:3]
    s_add_u32 s33, s28, 9
    v_mfma_f32_16x16x32_bf16 v[48:51], v[144:147], v[204:207], v[48:51]
    s_and_b32 s33, s33, 15
    v_mfma_f32_16x16x32_bf16 v[4:7], v[148:151], v[200:203], v[4:7]
    s_mul_i32 s33, s33, 2048
    v_mfma_f32_16x16x32_bf16 v[52:55], v[148:151], v[204:207], v[52:55]
    s_add_u32 s33, s33, s30
    buffer_load_dwordx4 v[176:179], v232, s[8:11], s33 offen sc0 sc1
    v_mfma_f32_16x16x32_bf16 v[8:11], v[152:155], v[200:203], v[8:11]
    v_mfma_f32_16x16x32_bf16 v[56:59], v[152:155], v[204:207], v[56:59]
    s_add_u32 s33, s33, 131072
    buffer_load_dwordx4 v[180:183], v232, s[8:11], s33 offen sc0 sc1
    v_mfma_f32_16x16x32_bf16 v[12:15], v[156:159], v[200:203], v[12:15]
    s_waitcnt lgkmcnt(0)
    s_barrier
    ds_read_b64_tr_b16 v[128:129], v228 offset:24576
    ds_read_b64_tr_b16 v[130:131], v228 offset:30720
    v_mfma_f32_16x16x32_bf16 v[60:63], v[156:159], v[204:207], v[60:63]
    ds_read_b64_tr_b16 v[132:133], v229 offset:24576
    ds_read_b64_tr_b16 v[134:135], v229 offset:30720
    v_mfma_f32_16x16x32_bf16 v[16:19], v[96:99], v[200:203], v[16:19]
    s_add_u32 s34, s28, 10
    ds_read_b64_tr_b16 v[136:137], v230 offset:24576
    ds_read_b64_tr_b16 v[138:139], v230 offset:30720
    v_mfma_f32_16x16x32_bf16 v[64:67], v[96:99], v[204:207], v[64:67]
    s_and_b32 s34, s34, 15
    ds_read_b64_tr_b16 v[140:141], v231 offset:24576
    ds_read_b64_tr_b16 v[142:143], v231 offset:30720
    v_mfma_f32_16x16x32_bf16 v[20:23], v[100:103], v[200:203], v[20:23]
    s_mul_i32 s34, s34, 73728
    ds_read_b64_tr_b16 v[144:145], v228 offset:24704
    ds_read_b64_tr_b16 v[146:147], v228 offset:30848
    v_mfma_f32_16x16x32_bf16 v[68:71], v[100:103], v[204:207], v[68:71]
    s_add_u32 s34, s34, s29
    ds_read_b64_tr_b16 v[148:149], v229 offset:24704
    ds_read_b64_tr_b16 v[150:151], v229 offset:30848
    v_mfma_f32_16x16x32_bf16 v[24:27], v[104:107], v[200:203], v[24:27]
    s_add_u32 m0, s31, 49152
    ds_read_b64_tr_b16 v[152:153], v230 offset:24704
    ds_read_b64_tr_b16 v[154:155], v230 offset:30848
    v_mfma_f32_16x16x32_bf16 v[72:75], v[104:107], v[204:207], v[72:75]
    s_add_u32 s32, s34, 0
    buffer_load_dwordx4 v253, s[4:7], s32 offen offset:0 lds
    v_mfma_f32_16x16x32_bf16 v[28:31], v[108:111], v[200:203], v[28:31]
    ds_read_b64_tr_b16 v[156:157], v231 offset:24704
    ds_read_b64_tr_b16 v[158:159], v231 offset:30848
    v_mfma_f32_16x16x32_bf16 v[76:79], v[108:111], v[204:207], v[76:79]
    s_add_u32 s32, s34, 4294966272
    buffer_load_dwordx4 v254, s[4:7], s32 offen offset:1024 lds
    v_mfma_f32_16x16x32_bf16 v[32:35], v[112:115], v[200:203], v[32:35]
    ds_read_b64_tr_b16 v[96:97], v228 offset:24832
    ds_read_b64_tr_b16 v[98:99], v228 offset:30976
    v_mfma_f32_16x16x32_bf16 v[80:83], v[112:115], v[204:207], v[80:83]
    s_add_u32 s32, s34, 4294965248
    buffer_load_dwordx4 v255, s[4:7], s32 offen offset:2048 lds
    v_mfma_f32_16x16x32_bf16 v[36:39], v[116:119], v[200:203], v[36:39]
    ds_read_b64_tr_b16 v[100:101], v229 offset:24832
    ds_read_b64_tr_b16 v[102:103], v229 offset:30976
    v_mfma_f32_16x16x32_bf16 v[84:87], v[116:119], v[204:207], v[84:87]
    s_add_u32 m0, s31, 52224
    v_mfma_f32_16x16x32_bf16 v[40:43], v[120:123], v[200:203], v[40:43]
    s_add_u32 s32, s34, 9216
    buffer_load_dwordx4 v253, s[4:7], s32 offen offset:0 lds
    ds_read_b64_tr_b16 v[104:105], v230 offset:24832
    ds_read_b64_tr_b16 v[106:107], v230 offset:30976
    v_mfma_f32_16x16x32_bf16 v[88:91], v[120:123], v[204:207], v[88:91]
    v_mfma_f32_16x16x32_bf16 v[44:47], v[124:127], v[200:203], v[44:47]
    s_add_u32 s32, s34, 8192
    buffer_load_dwordx4 v254, s[4:7], s32 offen offset:1024 lds
    ds_read_b64_tr_b16 v[108:109], v231 offset:24832
    ds_read_b64_tr_b16 v[110:111], v231 offset:30976
    v_mfma_f32_16x16x32_bf16 v[92:95], v[124:127], v[204:207], v[92:95]
    s_waitcnt vmcnt(25) lgkmcnt(15)
    v_mfma_f32_16x16x32_bf16 v[0:3], v[128:131], v[208:211], v[0:3]
    s_add_u32 s32, s34, 7168
    buffer_load_dwordx4 v255, s[4:7], s32 offen offset:2048 lds
    ds_read_b64_tr_b16 v[112:113], v228 offset:36864
    ds_read_b64_tr_b16 v[114:115], v228 offset:43008
    v_mfma_f32_16x16x32_bf16 v[48:51], v[128:131], v[212:215], v[48:51]
    v_mfma_f32_16x16x32_bf16 v[4:7], v[132:135], v[208:211], v[4:7]
    s_add_u32 s33, s28, 9
    ds_read_b64_tr_b16 v[116:117], v229 offset:36864
    ds_read_b64_tr_b16 v[118:119], v229 offset:43008
    v_mfma_f32_16x16x32_bf16 v[52:55], v[132:135], v[212:215], v[52:55]
    s_and_b32 s33, s33, 15
    v_mfma_f32_16x16x32_bf16 v[8:11], v[136:139], v[208:211], v[8:11]
    s_mul_i32 s33, s33, 2048
    ds_read_b64_tr_b16 v[120:121], v230 offset:36864
    ds_read_b64_tr_b16 v[122:123], v230 offset:43008
    v_mfma_f32_16x16x32_bf16 v[56:59], v[136:139], v[212:215], v[56:59]
    s_add_u32 s33, s33, s30
    v_mfma_f32_16x16x32_bf16 v[12:15], v[140:143], v[208:211], v[12:15]
    s_add_u32 s33, s33, 1024
    buffer_load_dwordx4 v[184:187], v232, s[8:11], s33 offen sc0 sc1
    ds_read_b64_tr_b16 v[124:125], v231 offset:36864
    ds_read_b64_tr_b16 v[126:127], v231 offset:43008
    v_mfma_f32_16x16x32_bf16 v[60:63], v[140:143], v[212:215], v[60:63]
    s_waitcnt lgkmcnt(15)
    v_mfma_f32_16x16x32_bf16 v[16:19], v[144:147], v[208:211], v[16:19]
    s_add_u32 s33, s33, 131072
    buffer_load_dwordx4 v[188:191], v232, s[8:11], s33 offen sc0 sc1
    ds_read_b64_tr_b16 v[128:129], v228 offset:36992
    ds_read_b64_tr_b16 v[130:131], v228 offset:43136
    v_mfma_f32_16x16x32_bf16 v[64:67], v[144:147], v[212:215], v[64:67]
    v_mfma_f32_16x16x32_bf16 v[20:23], v[148:151], v[208:211], v[20:23]
    ds_read_b64_tr_b16 v[132:133], v229 offset:36992
    ds_read_b64_tr_b16 v[134:135], v229 offset:43136
    v_mfma_f32_16x16x32_bf16 v[68:71], v[148:151], v[212:215], v[68:71]
    v_mfma_f32_16x16x32_bf16 v[24:27], v[152:155], v[208:211], v[24:27]
    ds_read_b64_tr_b16 v[136:137], v230 offset:36992
    ds_read_b64_tr_b16 v[138:139], v230 offset:43136
    v_mfma_f32_16x16x32_bf16 v[72:75], v[152:155], v[212:215], v[72:75]
    v_mfma_f32_16x16x32_bf16 v[28:31], v[156:159], v[208:211], v[28:31]
    ds_read_b64_tr_b16 v[140:141], v231 offset:36992
    ds_read_b64_tr_b16 v[142:143], v231 offset:43136
    v_mfma_f32_16x16x32_bf16 v[76:79], v[156:159], v[212:215], v[76:79]
    s_waitcnt lgkmcnt(15)
    v_mfma_f32_16x16x32_bf16 v[32:35], v[96:99], v[208:211], v[32:35]
    ds_read_b64_tr_b16 v[144:145], v228 offset:37120
    ds_read_b64_tr_b16 v[146:147], v228 offset:43264
    v_mfma_f32_16x16x32_bf16 v[80:83], v[96:99], v[212:215], v[80:83]
    v_mfma_f32_16x16x32_bf16 v[36:39], v[100:103], v[208:211], v[36:39]
    ds_read_b64_tr_b16 v[148:149], v229 offset:37120
    ds_read_b64_tr_b16 v[150:151], v229 offset:43264
    v_mfma_f32_16x16x32_bf16 v[84:87], v[100:103], v[212:215], v[84:87]
    v_mfma_f32_16x16x32_bf16 v[40:43], v[104:107], v[208:211], v[40:43]
    ds_read_b64_tr_b16 v[152:153], v230 offset:37120
    ds_read_b64_tr_b16 v[154:155], v230 offset:43264
    v_mfma_f32_16x16x32_bf16 v[88:91], v[104:107], v[212:215], v[88:91]
    v_mfma_f32_16x16x32_bf16 v[44:47], v[108:111], v[208:211], v[44:47]
    ds_read_b64_tr_b16 v[156:157], v231 offset:37120
    ds_read_b64_tr_b16 v[158:159], v231 offset:43264
    v_mfma_f32_16x16x32_bf16 v[92:95], v[108:111], v[212:215], v[92:95]
    s_waitcnt vmcnt(20) lgkmcnt(15)
    v_mfma_f32_16x16x32_bf16 v[0:3], v[112:115], v[216:219], v[0:3]
    s_add_u32 s33, s28, 10
    v_mfma_f32_16x16x32_bf16 v[48:51], v[112:115], v[220:223], v[48:51]
    s_and_b32 s33, s33, 15
    v_mfma_f32_16x16x32_bf16 v[4:7], v[116:119], v[216:219], v[4:7]
    s_mul_i32 s33, s33, 2048
    v_mfma_f32_16x16x32_bf16 v[52:55], v[116:119], v[220:223], v[52:55]
    s_add_u32 s33, s33, s30
    buffer_load_dwordx4 v[192:195], v232, s[8:11], s33 offen sc0 sc1
    v_mfma_f32_16x16x32_bf16 v[8:11], v[120:123], v[216:219], v[8:11]
    v_mfma_f32_16x16x32_bf16 v[56:59], v[120:123], v[220:223], v[56:59]
    s_add_u32 s33, s33, 131072
    buffer_load_dwordx4 v[196:199], v232, s[8:11], s33 offen sc0 sc1
    v_mfma_f32_16x16x32_bf16 v[12:15], v[124:127], v[216:219], v[12:15]
    s_waitcnt lgkmcnt(0)
    s_barrier
    ds_read_b64_tr_b16 v[96:97], v224 offset:0
    ds_read_b64_tr_b16 v[98:99], v224 offset:6144
    v_mfma_f32_16x16x32_bf16 v[60:63], v[124:127], v[220:223], v[60:63]
    ds_read_b64_tr_b16 v[100:101], v225 offset:0
    ds_read_b64_tr_b16 v[102:103], v225 offset:6144
    v_mfma_f32_16x16x32_bf16 v[16:19], v[128:131], v[216:219], v[16:19]
    s_add_u32 s34, s28, 11
    ds_read_b64_tr_b16 v[104:105], v226 offset:0
    ds_read_b64_tr_b16 v[106:107], v226 offset:6144
    v_mfma_f32_16x16x32_bf16 v[64:67], v[128:131], v[220:223], v[64:67]
    s_and_b32 s34, s34, 15
    ds_read_b64_tr_b16 v[108:109], v227 offset:0
    ds_read_b64_tr_b16 v[110:111], v227 offset:6144
    v_mfma_f32_16x16x32_bf16 v[20:23], v[132:135], v[216:219], v[20:23]
    s_mul_i32 s34, s34, 73728
    ds_read_b64_tr_b16 v[112:113], v224 offset:128
    ds_read_b64_tr_b16 v[114:115], v224 offset:6272
    v_mfma_f32_16x16x32_bf16 v[68:71], v[132:135], v[220:223], v[68:71]
    s_add_u32 s34, s34, s29
    ds_read_b64_tr_b16 v[116:117], v225 offset:128
    ds_read_b64_tr_b16 v[118:119], v225 offset:6272
    v_mfma_f32_16x16x32_bf16 v[24:27], v[136:139], v[216:219], v[24:27]
    s_add_u32 m0, s31, 73728
    ds_read_b64_tr_b16 v[120:121], v226 offset:128
    ds_read_b64_tr_b16 v[122:123], v226 offset:6272
    v_mfma_f32_16x16x32_bf16 v[72:75], v[136:139], v[220:223], v[72:75]
    s_add_u32 s32, s34, 0
    buffer_load_dwordx4 v253, s[4:7], s32 offen offset:0 lds
    v_mfma_f32_16x16x32_bf16 v[28:31], v[140:143], v[216:219], v[28:31]
    ds_read_b64_tr_b16 v[124:125], v227 offset:128
    ds_read_b64_tr_b16 v[126:127], v227 offset:6272
    v_mfma_f32_16x16x32_bf16 v[76:79], v[140:143], v[220:223], v[76:79]
    s_add_u32 s32, s34, 4294966272
    buffer_load_dwordx4 v254, s[4:7], s32 offen offset:1024 lds
    v_mfma_f32_16x16x32_bf16 v[32:35], v[144:147], v[216:219], v[32:35]
    ds_read_b64_tr_b16 v[128:129], v224 offset:256
    ds_read_b64_tr_b16 v[130:131], v224 offset:6400
    v_mfma_f32_16x16x32_bf16 v[80:83], v[144:147], v[220:223], v[80:83]
    s_add_u32 s32, s34, 4294965248
    buffer_load_dwordx4 v255, s[4:7], s32 offen offset:2048 lds
    v_mfma_f32_16x16x32_bf16 v[36:39], v[148:151], v[216:219], v[36:39]
    ds_read_b64_tr_b16 v[132:133], v225 offset:256
    ds_read_b64_tr_b16 v[134:135], v225 offset:6400
    v_mfma_f32_16x16x32_bf16 v[84:87], v[148:151], v[220:223], v[84:87]
    s_add_u32 m0, s31, 76800
    v_mfma_f32_16x16x32_bf16 v[40:43], v[152:155], v[216:219], v[40:43]
    s_add_u32 s32, s34, 9216
    buffer_load_dwordx4 v253, s[4:7], s32 offen offset:0 lds
    ds_read_b64_tr_b16 v[136:137], v226 offset:256
    ds_read_b64_tr_b16 v[138:139], v226 offset:6400
    v_mfma_f32_16x16x32_bf16 v[88:91], v[152:155], v[220:223], v[88:91]
    v_mfma_f32_16x16x32_bf16 v[44:47], v[156:159], v[216:219], v[44:47]
    s_add_u32 s32, s34, 8192
    buffer_load_dwordx4 v254, s[4:7], s32 offen offset:1024 lds
    ds_read_b64_tr_b16 v[140:141], v227 offset:256
    ds_read_b64_tr_b16 v[142:143], v227 offset:6400
    v_mfma_f32_16x16x32_bf16 v[92:95], v[156:159], v[220:223], v[92:95]
    s_waitcnt vmcnt(25) lgkmcnt(15)
    v_mfma_f32_16x16x32_bf16 v[0:3], v[96:99], v[160:163], v[0:3]
    s_add_u32 s32, s34, 7168
    buffer_load_dwordx4 v255, s[4:7], s32 offen offset:2048 lds
    ds_read_b64_tr_b16 v[144:145], v224 offset:12288
    ds_read_b64_tr_b16 v[146:147], v224 offset:18432
    v_mfma_f32_16x16x32_bf16 v[48:51], v[96:99], v[164:167], v[48:51]
    v_mfma_f32_16x16x32_bf16 v[4:7], v[100:103], v[160:163], v[4:7]
    s_add_u32 s33, s28, 10
    ds_read_b64_tr_b16 v[148:149], v225 offset:12288
    ds_read_b64_tr_b16 v[150:151], v225 offset:18432
    v_mfma_f32_16x16x32_bf16 v[52:55], v[100:103], v[164:167], v[52:55]
    s_and_b32 s33, s33, 15
    v_mfma_f32_16x16x32_bf16 v[8:11], v[104:107], v[160:163], v[8:11]
    s_mul_i32 s33, s33, 2048
    ds_read_b64_tr_b16 v[152:153], v226 offset:12288
    ds_read_b64_tr_b16 v[154:155], v226 offset:18432
    v_mfma_f32_16x16x32_bf16 v[56:59], v[104:107], v[164:167], v[56:59]
    s_add_u32 s33, s33, s30
    v_mfma_f32_16x16x32_bf16 v[12:15], v[108:111], v[160:163], v[12:15]
    s_add_u32 s33, s33, 1024
    buffer_load_dwordx4 v[200:203], v232, s[8:11], s33 offen sc0 sc1
    ds_read_b64_tr_b16 v[156:157], v227 offset:12288
    ds_read_b64_tr_b16 v[158:159], v227 offset:18432
    v_mfma_f32_16x16x32_bf16 v[60:63], v[108:111], v[164:167], v[60:63]
    s_waitcnt lgkmcnt(15)
    v_mfma_f32_16x16x32_bf16 v[16:19], v[112:115], v[160:163], v[16:19]
    s_add_u32 s33, s33, 131072
    buffer_load_dwordx4 v[204:207], v232, s[8:11], s33 offen sc0 sc1
    ds_read_b64_tr_b16 v[96:97], v224 offset:12416
    ds_read_b64_tr_b16 v[98:99], v224 offset:18560
    v_mfma_f32_16x16x32_bf16 v[64:67], v[112:115], v[164:167], v[64:67]
    v_mfma_f32_16x16x32_bf16 v[20:23], v[116:119], v[160:163], v[20:23]
    ds_read_b64_tr_b16 v[100:101], v225 offset:12416
    ds_read_b64_tr_b16 v[102:103], v225 offset:18560
    v_mfma_f32_16x16x32_bf16 v[68:71], v[116:119], v[164:167], v[68:71]
    v_mfma_f32_16x16x32_bf16 v[24:27], v[120:123], v[160:163], v[24:27]
    ds_read_b64_tr_b16 v[104:105], v226 offset:12416
    ds_read_b64_tr_b16 v[106:107], v226 offset:18560
    v_mfma_f32_16x16x32_bf16 v[72:75], v[120:123], v[164:167], v[72:75]
    v_mfma_f32_16x16x32_bf16 v[28:31], v[124:127], v[160:163], v[28:31]
    ds_read_b64_tr_b16 v[108:109], v227 offset:12416
    ds_read_b64_tr_b16 v[110:111], v227 offset:18560
    v_mfma_f32_16x16x32_bf16 v[76:79], v[124:127], v[164:167], v[76:79]
    s_waitcnt lgkmcnt(15)
    v_mfma_f32_16x16x32_bf16 v[32:35], v[128:131], v[160:163], v[32:35]
    ds_read_b64_tr_b16 v[112:113], v224 offset:12544
    ds_read_b64_tr_b16 v[114:115], v224 offset:18688
    v_mfma_f32_16x16x32_bf16 v[80:83], v[128:131], v[164:167], v[80:83]
    v_mfma_f32_16x16x32_bf16 v[36:39], v[132:135], v[160:163], v[36:39]
    ds_read_b64_tr_b16 v[116:117], v225 offset:12544
    ds_read_b64_tr_b16 v[118:119], v225 offset:18688
    v_mfma_f32_16x16x32_bf16 v[84:87], v[132:135], v[164:167], v[84:87]
    v_mfma_f32_16x16x32_bf16 v[40:43], v[136:139], v[160:163], v[40:43]
    ds_read_b64_tr_b16 v[120:121], v226 offset:12544
    ds_read_b64_tr_b16 v[122:123], v226 offset:18688
    v_mfma_f32_16x16x32_bf16 v[88:91], v[136:139], v[164:167], v[88:91]
    v_mfma_f32_16x16x32_bf16 v[44:47], v[140:143], v[160:163], v[44:47]
    ds_read_b64_tr_b16 v[124:125], v227 offset:12544
    ds_read_b64_tr_b16 v[126:127], v227 offset:18688
    v_mfma_f32_16x16x32_bf16 v[92:95], v[140:143], v[164:167], v[92:95]
    s_waitcnt vmcnt(20) lgkmcnt(15)
    v_mfma_f32_16x16x32_bf16 v[0:3], v[144:147], v[168:171], v[0:3]
    s_add_u32 s33, s28, 11
    v_mfma_f32_16x16x32_bf16 v[48:51], v[144:147], v[172:175], v[48:51]
    s_and_b32 s33, s33, 15
    v_mfma_f32_16x16x32_bf16 v[4:7], v[148:151], v[168:171], v[4:7]
    s_mul_i32 s33, s33, 2048
    v_mfma_f32_16x16x32_bf16 v[52:55], v[148:151], v[172:175], v[52:55]
    s_add_u32 s33, s33, s30
    buffer_load_dwordx4 v[208:211], v232, s[8:11], s33 offen sc0 sc1
    v_mfma_f32_16x16x32_bf16 v[8:11], v[152:155], v[168:171], v[8:11]
    v_mfma_f32_16x16x32_bf16 v[56:59], v[152:155], v[172:175], v[56:59]
    s_add_u32 s33, s33, 131072
    buffer_load_dwordx4 v[212:215], v232, s[8:11], s33 offen sc0 sc1
    v_mfma_f32_16x16x32_bf16 v[12:15], v[156:159], v[168:171], v[12:15]
    s_waitcnt lgkmcnt(0)
    s_barrier
    ds_read_b64_tr_b16 v[128:129], v224 offset:24576
    ds_read_b64_tr_b16 v[130:131], v224 offset:30720
    v_mfma_f32_16x16x32_bf16 v[60:63], v[156:159], v[172:175], v[60:63]
    ds_read_b64_tr_b16 v[132:133], v225 offset:24576
    ds_read_b64_tr_b16 v[134:135], v225 offset:30720
    v_mfma_f32_16x16x32_bf16 v[16:19], v[96:99], v[168:171], v[16:19]
    s_add_u32 s34, s28, 12
    ds_read_b64_tr_b16 v[136:137], v226 offset:24576
    ds_read_b64_tr_b16 v[138:139], v226 offset:30720
    v_mfma_f32_16x16x32_bf16 v[64:67], v[96:99], v[172:175], v[64:67]
    s_and_b32 s34, s34, 15
    ds_read_b64_tr_b16 v[140:141], v227 offset:24576
    ds_read_b64_tr_b16 v[142:143], v227 offset:30720
    v_mfma_f32_16x16x32_bf16 v[20:23], v[100:103], v[168:171], v[20:23]
    s_mul_i32 s34, s34, 73728
    ds_read_b64_tr_b16 v[144:145], v224 offset:24704
    ds_read_b64_tr_b16 v[146:147], v224 offset:30848
    v_mfma_f32_16x16x32_bf16 v[68:71], v[100:103], v[172:175], v[68:71]
    s_add_u32 s34, s34, s29
    ds_read_b64_tr_b16 v[148:149], v225 offset:24704
    ds_read_b64_tr_b16 v[150:151], v225 offset:30848
    v_mfma_f32_16x16x32_bf16 v[24:27], v[104:107], v[168:171], v[24:27]
    s_add_u32 m0, s31, 0
    ds_read_b64_tr_b16 v[152:153], v226 offset:24704
    ds_read_b64_tr_b16 v[154:155], v226 offset:30848
    v_mfma_f32_16x16x32_bf16 v[72:75], v[104:107], v[172:175], v[72:75]
    s_add_u32 s32, s34, 0
    buffer_load_dwordx4 v253, s[4:7], s32 offen offset:0 lds
    v_mfma_f32_16x16x32_bf16 v[28:31], v[108:111], v[168:171], v[28:31]
    ds_read_b64_tr_b16 v[156:157], v227 offset:24704
    ds_read_b64_tr_b16 v[158:159], v227 offset:30848
    v_mfma_f32_16x16x32_bf16 v[76:79], v[108:111], v[172:175], v[76:79]
    s_add_u32 s32, s34, 4294966272
    buffer_load_dwordx4 v254, s[4:7], s32 offen offset:1024 lds
    v_mfma_f32_16x16x32_bf16 v[32:35], v[112:115], v[168:171], v[32:35]
    ds_read_b64_tr_b16 v[96:97], v224 offset:24832
    ds_read_b64_tr_b16 v[98:99], v224 offset:30976
    v_mfma_f32_16x16x32_bf16 v[80:83], v[112:115], v[172:175], v[80:83]
    s_add_u32 s32, s34, 4294965248
    buffer_load_dwordx4 v255, s[4:7], s32 offen offset:2048 lds
    v_mfma_f32_16x16x32_bf16 v[36:39], v[116:119], v[168:171], v[36:39]
    ds_read_b64_tr_b16 v[100:101], v225 offset:24832
    ds_read_b64_tr_b16 v[102:103], v225 offset:30976
    v_mfma_f32_16x16x32_bf16 v[84:87], v[116:119], v[172:175], v[84:87]
    s_add_u32 m0, s31, 3072
    v_mfma_f32_16x16x32_bf16 v[40:43], v[120:123], v[168:171], v[40:43]
    s_add_u32 s32, s34, 9216
    buffer_load_dwordx4 v253, s[4:7], s32 offen offset:0 lds
    ds_read_b64_tr_b16 v[104:105], v226 offset:24832
    ds_read_b64_tr_b16 v[106:107], v226 offset:30976
    v_mfma_f32_16x16x32_bf16 v[88:91], v[120:123], v[172:175], v[88:91]
    v_mfma_f32_16x16x32_bf16 v[44:47], v[124:127], v[168:171], v[44:47]
    s_add_u32 s32, s34, 8192
    buffer_load_dwordx4 v254, s[4:7], s32 offen offset:1024 lds
    ds_read_b64_tr_b16 v[108:109], v227 offset:24832
    ds_read_b64_tr_b16 v[110:111], v227 offset:30976
    v_mfma_f32_16x16x32_bf16 v[92:95], v[124:127], v[172:175], v[92:95]
    s_waitcnt vmcnt(25) lgkmcnt(15)
    v_mfma_f32_16x16x32_bf16 v[0:3], v[128:131], v[176:179], v[0:3]
    s_add_u32 s32, s34, 7168
    buffer_load_dwordx4 v255, s[4:7], s32 offen offset:2048 lds
    ds_read_b64_tr_b16 v[112:113], v224 offset:36864
    ds_read_b64_tr_b16 v[114:115], v224 offset:43008
    v_mfma_f32_16x16x32_bf16 v[48:51], v[128:131], v[180:183], v[48:51]
    v_mfma_f32_16x16x32_bf16 v[4:7], v[132:135], v[176:179], v[4:7]
    s_add_u32 s33, s28, 11
    ds_read_b64_tr_b16 v[116:117], v225 offset:36864
    ds_read_b64_tr_b16 v[118:119], v225 offset:43008
    v_mfma_f32_16x16x32_bf16 v[52:55], v[132:135], v[180:183], v[52:55]
    s_and_b32 s33, s33, 15
    v_mfma_f32_16x16x32_bf16 v[8:11], v[136:139], v[176:179], v[8:11]
    s_mul_i32 s33, s33, 2048
    ds_read_b64_tr_b16 v[120:121], v226 offset:36864
    ds_read_b64_tr_b16 v[122:123], v226 offset:43008
    v_mfma_f32_16x16x32_bf16 v[56:59], v[136:139], v[180:183], v[56:59]
    s_add_u32 s33, s33, s30
    v_mfma_f32_16x16x32_bf16 v[12:15], v[140:143], v[176:179], v[12:15]
    s_add_u32 s33, s33, 1024
    buffer_load_dwordx4 v[216:219], v232, s[8:11], s33 offen sc0 sc1
    ds_read_b64_tr_b16 v[124:125], v227 offset:36864
    ds_read_b64_tr_b16 v[126:127], v227 offset:43008
    v_mfma_f32_16x16x32_bf16 v[60:63], v[140:143], v[180:183], v[60:63]
    s_waitcnt lgkmcnt(15)
    v_mfma_f32_16x16x32_bf16 v[16:19], v[144:147], v[176:179], v[16:19]
    s_add_u32 s33, s33, 131072
    buffer_load_dwordx4 v[220:223], v232, s[8:11], s33 offen sc0 sc1
    ds_read_b64_tr_b16 v[128:129], v224 offset:36992
    ds_read_b64_tr_b16 v[130:131], v224 offset:43136
    v_mfma_f32_16x16x32_bf16 v[64:67], v[144:147], v[180:183], v[64:67]
    v_mfma_f32_16x16x32_bf16 v[20:23], v[148:151], v[176:179], v[20:23]
    ds_read_b64_tr_b16 v[132:133], v225 offset:36992
    ds_read_b64_tr_b16 v[134:135], v225 offset:43136
    v_mfma_f32_16x16x32_bf16 v[68:71], v[148:151], v[180:183], v[68:71]
    v_mfma_f32_16x16x32_bf16 v[24:27], v[152:155], v[176:179], v[24:27]
    ds_read_b64_tr_b16 v[136:137], v226 offset:36992
    ds_read_b64_tr_b16 v[138:139], v226 offset:43136
    v_mfma_f32_16x16x32_bf16 v[72:75], v[152:155], v[180:183], v[72:75]
    v_mfma_f32_16x16x32_bf16 v[28:31], v[156:159], v[176:179], v[28:31]
    ds_read_b64_tr_b16 v[140:141], v227 offset:36992
    ds_read_b64_tr_b16 v[142:143], v227 offset:43136
    v_mfma_f32_16x16x32_bf16 v[76:79], v[156:159], v[180:183], v[76:79]
    s_waitcnt lgkmcnt(15)
    v_mfma_f32_16x16x32_bf16 v[32:35], v[96:99], v[176:179], v[32:35]
    ds_read_b64_tr_b16 v[144:145], v224 offset:37120
    ds_read_b64_tr_b16 v[146:147], v224 offset:43264
    v_mfma_f32_16x16x32_bf16 v[80:83], v[96:99], v[180:183], v[80:83]
    v_mfma_f32_16x16x32_bf16 v[36:39], v[100:103], v[176:179], v[36:39]
    ds_read_b64_tr_b16 v[148:149], v225 offset:37120
    ds_read_b64_tr_b16 v[150:151], v225 offset:43264
    v_mfma_f32_16x16x32_bf16 v[84:87], v[100:103], v[180:183], v[84:87]
    v_mfma_f32_16x16x32_bf16 v[40:43], v[104:107], v[176:179], v[40:43]
    ds_read_b64_tr_b16 v[152:153], v226 offset:37120
    ds_read_b64_tr_b16 v[154:155], v226 offset:43264
    v_mfma_f32_16x16x32_bf16 v[88:91], v[104:107], v[180:183], v[88:91]
    v_mfma_f32_16x16x32_bf16 v[44:47], v[108:111], v[176:179], v[44:47]
    ds_read_b64_tr_b16 v[156:157], v227 offset:37120
    ds_read_b64_tr_b16 v[158:159], v227 offset:43264
    v_mfma_f32_16x16x32_bf16 v[92:95], v[108:111], v[180:183], v[92:95]
    s_waitcnt vmcnt(20) lgkmcnt(15)
    v_mfma_f32_16x16x32_bf16 v[0:3], v[112:115], v[184:187], v[0:3]
    s_add_u32 s33, s28, 12
    v_mfma_f32_16x16x32_bf16 v[48:51], v[112:115], v[188:191], v[48:51]
    s_and_b32 s33, s33, 15
    v_mfma_f32_16x16x32_bf16 v[4:7], v[116:119], v[184:187], v[4:7]
    s_mul_i32 s33, s33, 2048
    v_mfma_f32_16x16x32_bf16 v[52:55], v[116:119], v[188:191], v[52:55]
    s_add_u32 s33, s33, s30
    buffer_load_dwordx4 v[160:163], v232, s[8:11], s33 offen sc0 sc1
    v_mfma_f32_16x16x32_bf16 v[8:11], v[120:123], v[184:187], v[8:11]
    v_mfma_f32_16x16x32_bf16 v[56:59], v[120:123], v[188:191], v[56:59]
    s_add_u32 s33, s33, 131072
    buffer_load_dwordx4 v[164:167], v232, s[8:11], s33 offen sc0 sc1
    v_mfma_f32_16x16x32_bf16 v[12:15], v[124:127], v[184:187], v[12:15]
    s_waitcnt lgkmcnt(0)
    s_barrier
    ds_read_b64_tr_b16 v[96:97], v228 offset:0
    ds_read_b64_tr_b16 v[98:99], v228 offset:6144
    v_mfma_f32_16x16x32_bf16 v[60:63], v[124:127], v[188:191], v[60:63]
    ds_read_b64_tr_b16 v[100:101], v229 offset:0
    ds_read_b64_tr_b16 v[102:103], v229 offset:6144
    v_mfma_f32_16x16x32_bf16 v[16:19], v[128:131], v[184:187], v[16:19]
    s_add_u32 s34, s28, 13
    ds_read_b64_tr_b16 v[104:105], v230 offset:0
    ds_read_b64_tr_b16 v[106:107], v230 offset:6144
    v_mfma_f32_16x16x32_bf16 v[64:67], v[128:131], v[188:191], v[64:67]
    s_and_b32 s34, s34, 15
    ds_read_b64_tr_b16 v[108:109], v231 offset:0
    ds_read_b64_tr_b16 v[110:111], v231 offset:6144
    v_mfma_f32_16x16x32_bf16 v[20:23], v[132:135], v[184:187], v[20:23]
    s_mul_i32 s34, s34, 73728
    ds_read_b64_tr_b16 v[112:113], v228 offset:128
    ds_read_b64_tr_b16 v[114:115], v228 offset:6272
    v_mfma_f32_16x16x32_bf16 v[68:71], v[132:135], v[188:191], v[68:71]
    s_add_u32 s34, s34, s29
    ds_read_b64_tr_b16 v[116:117], v229 offset:128
    ds_read_b64_tr_b16 v[118:119], v229 offset:6272
    v_mfma_f32_16x16x32_bf16 v[24:27], v[136:139], v[184:187], v[24:27]
    s_add_u32 m0, s31, 24576
    ds_read_b64_tr_b16 v[120:121], v230 offset:128
    ds_read_b64_tr_b16 v[122:123], v230 offset:6272
    v_mfma_f32_16x16x32_bf16 v[72:75], v[136:139], v[188:191], v[72:75]
    s_add_u32 s32, s34, 0
    buffer_load_dwordx4 v253, s[4:7], s32 offen offset:0 lds
    v_mfma_f32_16x16x32_bf16 v[28:31], v[140:143], v[184:187], v[28:31]
    ds_read_b64_tr_b16 v[124:125], v231 offset:128
    ds_read_b64_tr_b16 v[126:127], v231 offset:6272
    v_mfma_f32_16x16x32_bf16 v[76:79], v[140:143], v[188:191], v[76:79]
    s_add_u32 s32, s34, 4294966272
    buffer_load_dwordx4 v254, s[4:7], s32 offen offset:1024 lds
    v_mfma_f32_16x16x32_bf16 v[32:35], v[144:147], v[184:187], v[32:35]
    ds_read_b64_tr_b16 v[128:129], v228 offset:256
    ds_read_b64_tr_b16 v[130:131], v228 offset:6400
    v_mfma_f32_16x16x32_bf16 v[80:83], v[144:147], v[188:191], v[80:83]
    s_add_u32 s32, s34, 4294965248
    buffer_load_dwordx4 v255, s[4:7], s32 offen offset:2048 lds
    v_mfma_f32_16x16x32_bf16 v[36:39], v[148:151], v[184:187], v[36:39]
    ds_read_b64_tr_b16 v[132:133], v229 offset:256
    ds_read_b64_tr_b16 v[134:135], v229 offset:6400
    v_mfma_f32_16x16x32_bf16 v[84:87], v[148:151], v[188:191], v[84:87]
    s_add_u32 m0, s31, 27648
    v_mfma_f32_16x16x32_bf16 v[40:43], v[152:155], v[184:187], v[40:43]
    s_add_u32 s32, s34, 9216
    buffer_load_dwordx4 v253, s[4:7], s32 offen offset:0 lds
    ds_read_b64_tr_b16 v[136:137], v230 offset:256
    ds_read_b64_tr_b16 v[138:139], v230 offset:6400
    v_mfma_f32_16x16x32_bf16 v[88:91], v[152:155], v[188:191], v[88:91]
    v_mfma_f32_16x16x32_bf16 v[44:47], v[156:159], v[184:187], v[44:47]
    s_add_u32 s32, s34, 8192
    buffer_load_dwordx4 v254, s[4:7], s32 offen offset:1024 lds
    ds_read_b64_tr_b16 v[140:141], v231 offset:256
    ds_read_b64_tr_b16 v[142:143], v231 offset:6400
    v_mfma_f32_16x16x32_bf16 v[92:95], v[156:159], v[188:191], v[92:95]
    s_waitcnt vmcnt(25) lgkmcnt(15)
    v_mfma_f32_16x16x32_bf16 v[0:3], v[96:99], v[192:195], v[0:3]
    s_add_u32 s32, s34, 7168
    buffer_load_dwordx4 v255, s[4:7], s32 offen offset:2048 lds
    ds_read_b64_tr_b16 v[144:145], v228 offset:12288
    ds_read_b64_tr_b16 v[146:147], v228 offset:18432
    v_mfma_f32_16x16x32_bf16 v[48:51], v[96:99], v[196:199], v[48:51]
    v_mfma_f32_16x16x32_bf16 v[4:7], v[100:103], v[192:195], v[4:7]
    s_add_u32 s33, s28, 12
    ds_read_b64_tr_b16 v[148:149], v229 offset:12288
    ds_read_b64_tr_b16 v[150:151], v229 offset:18432
    v_mfma_f32_16x16x32_bf16 v[52:55], v[100:103], v[196:199], v[52:55]
    s_and_b32 s33, s33, 15
    v_mfma_f32_16x16x32_bf16 v[8:11], v[104:107], v[192:195], v[8:11]
    s_mul_i32 s33, s33, 2048
    ds_read_b64_tr_b16 v[152:153], v230 offset:12288
    ds_read_b64_tr_b16 v[154:155], v230 offset:18432
    v_mfma_f32_16x16x32_bf16 v[56:59], v[104:107], v[196:199], v[56:59]
    s_add_u32 s33, s33, s30
    v_mfma_f32_16x16x32_bf16 v[12:15], v[108:111], v[192:195], v[12:15]
    s_add_u32 s33, s33, 1024
    buffer_load_dwordx4 v[168:171], v232, s[8:11], s33 offen sc0 sc1
    ds_read_b64_tr_b16 v[156:157], v231 offset:12288
    ds_read_b64_tr_b16 v[158:159], v231 offset:18432
    v_mfma_f32_16x16x32_bf16 v[60:63], v[108:111], v[196:199], v[60:63]
    s_waitcnt lgkmcnt(15)
    v_mfma_f32_16x16x32_bf16 v[16:19], v[112:115], v[192:195], v[16:19]
    s_add_u32 s33, s33, 131072
    buffer_load_dwordx4 v[172:175], v232, s[8:11], s33 offen sc0 sc1
    ds_read_b64_tr_b16 v[96:97], v228 offset:12416
    ds_read_b64_tr_b16 v[98:99], v228 offset:18560
    v_mfma_f32_16x16x32_bf16 v[64:67], v[112:115], v[196:199], v[64:67]
    v_mfma_f32_16x16x32_bf16 v[20:23], v[116:119], v[192:195], v[20:23]
    ds_read_b64_tr_b16 v[100:101], v229 offset:12416
    ds_read_b64_tr_b16 v[102:103], v229 offset:18560
    v_mfma_f32_16x16x32_bf16 v[68:71], v[116:119], v[196:199], v[68:71]
    v_mfma_f32_16x16x32_bf16 v[24:27], v[120:123], v[192:195], v[24:27]
    ds_read_b64_tr_b16 v[104:105], v230 offset:12416
    ds_read_b64_tr_b16 v[106:107], v230 offset:18560
    v_mfma_f32_16x16x32_bf16 v[72:75], v[120:123], v[196:199], v[72:75]
    v_mfma_f32_16x16x32_bf16 v[28:31], v[124:127], v[192:195], v[28:31]
    ds_read_b64_tr_b16 v[108:109], v231 offset:12416
    ds_read_b64_tr_b16 v[110:111], v231 offset:18560
    v_mfma_f32_16x16x32_bf16 v[76:79], v[124:127], v[196:199], v[76:79]
    s_waitcnt lgkmcnt(15)
    v_mfma_f32_16x16x32_bf16 v[32:35], v[128:131], v[192:195], v[32:35]
    ds_read_b64_tr_b16 v[112:113], v228 offset:12544
    ds_read_b64_tr_b16 v[114:115], v228 offset:18688
    v_mfma_f32_16x16x32_bf16 v[80:83], v[128:131], v[196:199], v[80:83]
    v_mfma_f32_16x16x32_bf16 v[36:39], v[132:135], v[192:195], v[36:39]
    ds_read_b64_tr_b16 v[116:117], v229 offset:12544
    ds_read_b64_tr_b16 v[118:119], v229 offset:18688
    v_mfma_f32_16x16x32_bf16 v[84:87], v[132:135], v[196:199], v[84:87]
    v_mfma_f32_16x16x32_bf16 v[40:43], v[136:139], v[192:195], v[40:43]
    ds_read_b64_tr_b16 v[120:121], v230 offset:12544
    ds_read_b64_tr_b16 v[122:123], v230 offset:18688
    v_mfma_f32_16x16x32_bf16 v[88:91], v[136:139], v[196:199], v[88:91]
    v_mfma_f32_16x16x32_bf16 v[44:47], v[140:143], v[192:195], v[44:47]
    ds_read_b64_tr_b16 v[124:125], v231 offset:12544
    ds_read_b64_tr_b16 v[126:127], v231 offset:18688
    v_mfma_f32_16x16x32_bf16 v[92:95], v[140:143], v[196:199], v[92:95]
    s_waitcnt vmcnt(20) lgkmcnt(15)
    v_mfma_f32_16x16x32_bf16 v[0:3], v[144:147], v[200:203], v[0:3]
    s_add_u32 s33, s28, 13
    v_mfma_f32_16x16x32_bf16 v[48:51], v[144:147], v[204:207], v[48:51]
    s_and_b32 s33, s33, 15
    v_mfma_f32_16x16x32_bf16 v[4:7], v[148:151], v[200:203], v[4:7]
    s_mul_i32 s33, s33, 2048
    v_mfma_f32_16x16x32_bf16 v[52:55], v[148:151], v[204:207], v[52:55]
    s_add_u32 s33, s33, s30
    buffer_load_dwordx4 v[176:179], v232, s[8:11], s33 offen sc0 sc1
    v_mfma_f32_16x16x32_bf16 v[8:11], v[152:155], v[200:203], v[8:11]
    v_mfma_f32_16x16x32_bf16 v[56:59], v[152:155], v[204:207], v[56:59]
    s_add_u32 s33, s33, 131072
    buffer_load_dwordx4 v[180:183], v232, s[8:11], s33 offen sc0 sc1
    v_mfma_f32_16x16x32_bf16 v[12:15], v[156:159], v[200:203], v[12:15]
    s_waitcnt lgkmcnt(0)
    s_barrier
    ds_read_b64_tr_b16 v[128:129], v228 offset:24576
    ds_read_b64_tr_b16 v[130:131], v228 offset:30720
    v_mfma_f32_16x16x32_bf16 v[60:63], v[156:159], v[204:207], v[60:63]
    ds_read_b64_tr_b16 v[132:133], v229 offset:24576
    ds_read_b64_tr_b16 v[134:135], v229 offset:30720
    v_mfma_f32_16x16x32_bf16 v[16:19], v[96:99], v[200:203], v[16:19]
    s_add_u32 s34, s28, 14
    ds_read_b64_tr_b16 v[136:137], v230 offset:24576
    ds_read_b64_tr_b16 v[138:139], v230 offset:30720
    v_mfma_f32_16x16x32_bf16 v[64:67], v[96:99], v[204:207], v[64:67]
    s_and_b32 s34, s34, 15
    ds_read_b64_tr_b16 v[140:141], v231 offset:24576
    ds_read_b64_tr_b16 v[142:143], v231 offset:30720
    v_mfma_f32_16x16x32_bf16 v[20:23], v[100:103], v[200:203], v[20:23]
    s_mul_i32 s34, s34, 73728
    ds_read_b64_tr_b16 v[144:145], v228 offset:24704
    ds_read_b64_tr_b16 v[146:147], v228 offset:30848
    v_mfma_f32_16x16x32_bf16 v[68:71], v[100:103], v[204:207], v[68:71]
    s_add_u32 s34, s34, s29
    ds_read_b64_tr_b16 v[148:149], v229 offset:24704
    ds_read_b64_tr_b16 v[150:151], v229 offset:30848
    v_mfma_f32_16x16x32_bf16 v[24:27], v[104:107], v[200:203], v[24:27]
    s_add_u32 m0, s31, 49152
    ds_read_b64_tr_b16 v[152:153], v230 offset:24704
    ds_read_b64_tr_b16 v[154:155], v230 offset:30848
    v_mfma_f32_16x16x32_bf16 v[72:75], v[104:107], v[204:207], v[72:75]
    s_add_u32 s32, s34, 0
    buffer_load_dwordx4 v253, s[4:7], s32 offen offset:0 lds
    v_mfma_f32_16x16x32_bf16 v[28:31], v[108:111], v[200:203], v[28:31]
    ds_read_b64_tr_b16 v[156:157], v231 offset:24704
    ds_read_b64_tr_b16 v[158:159], v231 offset:30848
    v_mfma_f32_16x16x32_bf16 v[76:79], v[108:111], v[204:207], v[76:79]
    s_add_u32 s32, s34, 4294966272
    buffer_load_dwordx4 v254, s[4:7], s32 offen offset:1024 lds
    v_mfma_f32_16x16x32_bf16 v[32:35], v[112:115], v[200:203], v[32:35]
    ds_read_b64_tr_b16 v[96:97], v228 offset:24832
    ds_read_b64_tr_b16 v[98:99], v228 offset:30976
    v_mfma_f32_16x16x32_bf16 v[80:83], v[112:115], v[204:207], v[80:83]
    s_add_u32 s32, s34, 4294965248
    buffer_load_dwordx4 v255, s[4:7], s32 offen offset:2048 lds
    v_mfma_f32_16x16x32_bf16 v[36:39], v[116:119], v[200:203], v[36:39]
    ds_read_b64_tr_b16 v[100:101], v229 offset:24832
    ds_read_b64_tr_b16 v[102:103], v229 offset:30976
    v_mfma_f32_16x16x32_bf16 v[84:87], v[116:119], v[204:207], v[84:87]
    s_add_u32 m0, s31, 52224
    v_mfma_f32_16x16x32_bf16 v[40:43], v[120:123], v[200:203], v[40:43]
    s_add_u32 s32, s34, 9216
    buffer_load_dwordx4 v253, s[4:7], s32 offen offset:0 lds
    ds_read_b64_tr_b16 v[104:105], v230 offset:24832
    ds_read_b64_tr_b16 v[106:107], v230 offset:30976
    v_mfma_f32_16x16x32_bf16 v[88:91], v[120:123], v[204:207], v[88:91]
    v_mfma_f32_16x16x32_bf16 v[44:47], v[124:127], v[200:203], v[44:47]
    s_add_u32 s32, s34, 8192
    buffer_load_dwordx4 v254, s[4:7], s32 offen offset:1024 lds
    ds_read_b64_tr_b16 v[108:109], v231 offset:24832
    ds_read_b64_tr_b16 v[110:111], v231 offset:30976
    v_mfma_f32_16x16x32_bf16 v[92:95], v[124:127], v[204:207], v[92:95]
    s_waitcnt vmcnt(25) lgkmcnt(15)
    v_mfma_f32_16x16x32_bf16 v[0:3], v[128:131], v[208:211], v[0:3]
    s_add_u32 s32, s34, 7168
    buffer_load_dwordx4 v255, s[4:7], s32 offen offset:2048 lds
    ds_read_b64_tr_b16 v[112:113], v228 offset:36864
    ds_read_b64_tr_b16 v[114:115], v228 offset:43008
    v_mfma_f32_16x16x32_bf16 v[48:51], v[128:131], v[212:215], v[48:51]
    v_mfma_f32_16x16x32_bf16 v[4:7], v[132:135], v[208:211], v[4:7]
    s_add_u32 s33, s28, 13
    ds_read_b64_tr_b16 v[116:117], v229 offset:36864
    ds_read_b64_tr_b16 v[118:119], v229 offset:43008
    v_mfma_f32_16x16x32_bf16 v[52:55], v[132:135], v[212:215], v[52:55]
    s_and_b32 s33, s33, 15
    v_mfma_f32_16x16x32_bf16 v[8:11], v[136:139], v[208:211], v[8:11]
    s_mul_i32 s33, s33, 2048
    ds_read_b64_tr_b16 v[120:121], v230 offset:36864
    ds_read_b64_tr_b16 v[122:123], v230 offset:43008
    v_mfma_f32_16x16x32_bf16 v[56:59], v[136:139], v[212:215], v[56:59]
    s_add_u32 s33, s33, s30
    v_mfma_f32_16x16x32_bf16 v[12:15], v[140:143], v[208:211], v[12:15]
    s_add_u32 s33, s33, 1024
    buffer_load_dwordx4 v[184:187], v232, s[8:11], s33 offen sc0 sc1
    ds_read_b64_tr_b16 v[124:125], v231 offset:36864
    ds_read_b64_tr_b16 v[126:127], v231 offset:43008
    v_mfma_f32_16x16x32_bf16 v[60:63], v[140:143], v[212:215], v[60:63]
    s_waitcnt lgkmcnt(15)
    v_mfma_f32_16x16x32_bf16 v[16:19], v[144:147], v[208:211], v[16:19]
    s_add_u32 s33, s33, 131072
    buffer_load_dwordx4 v[188:191], v232, s[8:11], s33 offen sc0 sc1
    ds_read_b64_tr_b16 v[128:129], v228 offset:36992
    ds_read_b64_tr_b16 v[130:131], v228 offset:43136
    v_mfma_f32_16x16x32_bf16 v[64:67], v[144:147], v[212:215], v[64:67]
    v_mfma_f32_16x16x32_bf16 v[20:23], v[148:151], v[208:211], v[20:23]
    ds_read_b64_tr_b16 v[132:133], v229 offset:36992
    ds_read_b64_tr_b16 v[134:135], v229 offset:43136
    v_mfma_f32_16x16x32_bf16 v[68:71], v[148:151], v[212:215], v[68:71]
    v_mfma_f32_16x16x32_bf16 v[24:27], v[152:155], v[208:211], v[24:27]
    ds_read_b64_tr_b16 v[136:137], v230 offset:36992
    ds_read_b64_tr_b16 v[138:139], v230 offset:43136
    v_mfma_f32_16x16x32_bf16 v[72:75], v[152:155], v[212:215], v[72:75]
    v_mfma_f32_16x16x32_bf16 v[28:31], v[156:159], v[208:211], v[28:31]
    ds_read_b64_tr_b16 v[140:141], v231 offset:36992
    ds_read_b64_tr_b16 v[142:143], v231 offset:43136
    v_mfma_f32_16x16x32_bf16 v[76:79], v[156:159], v[212:215], v[76:79]
    s_waitcnt lgkmcnt(15)
    v_mfma_f32_16x16x32_bf16 v[32:35], v[96:99], v[208:211], v[32:35]
    ds_read_b64_tr_b16 v[144:145], v228 offset:37120
    ds_read_b64_tr_b16 v[146:147], v228 offset:43264
    v_mfma_f32_16x16x32_bf16 v[80:83], v[96:99], v[212:215], v[80:83]
    v_mfma_f32_16x16x32_bf16 v[36:39], v[100:103], v[208:211], v[36:39]
    ds_read_b64_tr_b16 v[148:149], v229 offset:37120
    ds_read_b64_tr_b16 v[150:151], v229 offset:43264
    v_mfma_f32_16x16x32_bf16 v[84:87], v[100:103], v[212:215], v[84:87]
    v_mfma_f32_16x16x32_bf16 v[40:43], v[104:107], v[208:211], v[40:43]
    ds_read_b64_tr_b16 v[152:153], v230 offset:37120
    ds_read_b64_tr_b16 v[154:155], v230 offset:43264
    v_mfma_f32_16x16x32_bf16 v[88:91], v[104:107], v[212:215], v[88:91]
    v_mfma_f32_16x16x32_bf16 v[44:47], v[108:111], v[208:211], v[44:47]
    ds_read_b64_tr_b16 v[156:157], v231 offset:37120
    ds_read_b64_tr_b16 v[158:159], v231 offset:43264
    v_mfma_f32_16x16x32_bf16 v[92:95], v[108:111], v[212:215], v[92:95]
    s_waitcnt vmcnt(20) lgkmcnt(15)
    v_mfma_f32_16x16x32_bf16 v[0:3], v[112:115], v[216:219], v[0:3]
    s_add_u32 s33, s28, 14
    v_mfma_f32_16x16x32_bf16 v[48:51], v[112:115], v[220:223], v[48:51]
    s_and_b32 s33, s33, 15
    v_mfma_f32_16x16x32_bf16 v[4:7], v[116:119], v[216:219], v[4:7]
    s_mul_i32 s33, s33, 2048
    v_mfma_f32_16x16x32_bf16 v[52:55], v[116:119], v[220:223], v[52:55]
    s_add_u32 s33, s33, s30
    buffer_load_dwordx4 v[192:195], v232, s[8:11], s33 offen sc0 sc1
    v_mfma_f32_16x16x32_bf16 v[8:11], v[120:123], v[216:219], v[8:11]
    v_mfma_f32_16x16x32_bf16 v[56:59], v[120:123], v[220:223], v[56:59]
    s_add_u32 s33, s33, 131072
    buffer_load_dwordx4 v[196:199], v232, s[8:11], s33 offen sc0 sc1
    v_mfma_f32_16x16x32_bf16 v[12:15], v[124:127], v[216:219], v[12:15]
    s_waitcnt lgkmcnt(0)
    s_barrier
    ds_read_b64_tr_b16 v[96:97], v224 offset:0
    ds_read_b64_tr_b16 v[98:99], v224 offset:6144
    v_mfma_f32_16x16x32_bf16 v[60:63], v[124:127], v[220:223], v[60:63]
    ds_read_b64_tr_b16 v[100:101], v225 offset:0
    ds_read_b64_tr_b16 v[102:103], v225 offset:6144
    v_mfma_f32_16x16x32_bf16 v[16:19], v[128:131], v[216:219], v[16:19]
    s_add_u32 s34, s28, 15
    ds_read_b64_tr_b16 v[104:105], v226 offset:0
    ds_read_b64_tr_b16 v[106:107], v226 offset:6144
    v_mfma_f32_16x16x32_bf16 v[64:67], v[128:131], v[220:223], v[64:67]
    s_and_b32 s34, s34, 15
    ds_read_b64_tr_b16 v[108:109], v227 offset:0
    ds_read_b64_tr_b16 v[110:111], v227 offset:6144
    v_mfma_f32_16x16x32_bf16 v[20:23], v[132:135], v[216:219], v[20:23]
    s_mul_i32 s34, s34, 73728
    ds_read_b64_tr_b16 v[112:113], v224 offset:128
    ds_read_b64_tr_b16 v[114:115], v224 offset:6272
    v_mfma_f32_16x16x32_bf16 v[68:71], v[132:135], v[220:223], v[68:71]
    s_add_u32 s34, s34, s29
    ds_read_b64_tr_b16 v[116:117], v225 offset:128
    ds_read_b64_tr_b16 v[118:119], v225 offset:6272
    v_mfma_f32_16x16x32_bf16 v[24:27], v[136:139], v[216:219], v[24:27]
    s_add_u32 m0, s31, 73728
    ds_read_b64_tr_b16 v[120:121], v226 offset:128
    ds_read_b64_tr_b16 v[122:123], v226 offset:6272
    v_mfma_f32_16x16x32_bf16 v[72:75], v[136:139], v[220:223], v[72:75]
    s_add_u32 s32, s34, 0
    buffer_load_dwordx4 v253, s[4:7], s32 offen offset:0 lds
    v_mfma_f32_16x16x32_bf16 v[28:31], v[140:143], v[216:219], v[28:31]
    ds_read_b64_tr_b16 v[124:125], v227 offset:128
    ds_read_b64_tr_b16 v[126:127], v227 offset:6272
    v_mfma_f32_16x16x32_bf16 v[76:79], v[140:143], v[220:223], v[76:79]
    s_add_u32 s32, s34, 4294966272
    buffer_load_dwordx4 v254, s[4:7], s32 offen offset:1024 lds
    v_mfma_f32_16x16x32_bf16 v[32:35], v[144:147], v[216:219], v[32:35]
    ds_read_b64_tr_b16 v[128:129], v224 offset:256
    ds_read_b64_tr_b16 v[130:131], v224 offset:6400
    v_mfma_f32_16x16x32_bf16 v[80:83], v[144:147], v[220:223], v[80:83]
    s_add_u32 s32, s34, 4294965248
    buffer_load_dwordx4 v255, s[4:7], s32 offen offset:2048 lds
    v_mfma_f32_16x16x32_bf16 v[36:39], v[148:151], v[216:219], v[36:39]
    ds_read_b64_tr_b16 v[132:133], v225 offset:256
    ds_read_b64_tr_b16 v[134:135], v225 offset:6400
    v_mfma_f32_16x16x32_bf16 v[84:87], v[148:151], v[220:223], v[84:87]
    s_add_u32 m0, s31, 76800
    v_mfma_f32_16x16x32_bf16 v[40:43], v[152:155], v[216:219], v[40:43]
    s_add_u32 s32, s34, 9216
    buffer_load_dwordx4 v253, s[4:7], s32 offen offset:0 lds
    ds_read_b64_tr_b16 v[136:137], v226 offset:256
    ds_read_b64_tr_b16 v[138:139], v226 offset:6400
    v_mfma_f32_16x16x32_bf16 v[88:91], v[152:155], v[220:223], v[88:91]
    v_mfma_f32_16x16x32_bf16 v[44:47], v[156:159], v[216:219], v[44:47]
    s_add_u32 s32, s34, 8192
    buffer_load_dwordx4 v254, s[4:7], s32 offen offset:1024 lds
    ds_read_b64_tr_b16 v[140:141], v227 offset:256
    ds_read_b64_tr_b16 v[142:143], v227 offset:6400
    v_mfma_f32_16x16x32_bf16 v[92:95], v[156:159], v[220:223], v[92:95]
    s_waitcnt vmcnt(25) lgkmcnt(15)
    v_mfma_f32_16x16x32_bf16 v[0:3], v[96:99], v[160:163], v[0:3]
    s_add_u32 s32, s34, 7168
    buffer_load_dwordx4 v255, s[4:7], s32 offen offset:2048 lds
    ds_read_b64_tr_b16 v[144:145], v224 offset:12288
    ds_read_b64_tr_b16 v[146:147], v224 offset:18432
    v_mfma_f32_16x16x32_bf16 v[48:51], v[96:99], v[164:167], v[48:51]
    v_mfma_f32_16x16x32_bf16 v[4:7], v[100:103], v[160:163], v[4:7]
    s_add_u32 s33, s28, 14
    ds_read_b64_tr_b16 v[148:149], v225 offset:12288
    ds_read_b64_tr_b16 v[150:151], v225 offset:18432
    v_mfma_f32_16x16x32_bf16 v[52:55], v[100:103], v[164:167], v[52:55]
    s_and_b32 s33, s33, 15
    v_mfma_f32_16x16x32_bf16 v[8:11], v[104:107], v[160:163], v[8:11]
    s_mul_i32 s33, s33, 2048
    ds_read_b64_tr_b16 v[152:153], v226 offset:12288
    ds_read_b64_tr_b16 v[154:155], v226 offset:18432
    v_mfma_f32_16x16x32_bf16 v[56:59], v[104:107], v[164:167], v[56:59]
    s_add_u32 s33, s33, s30
    v_mfma_f32_16x16x32_bf16 v[12:15], v[108:111], v[160:163], v[12:15]
    s_add_u32 s33, s33, 1024
    buffer_load_dwordx4 v[200:203], v232, s[8:11], s33 offen sc0 sc1
    ds_read_b64_tr_b16 v[156:157], v227 offset:12288
    ds_read_b64_tr_b16 v[158:159], v227 offset:18432
    v_mfma_f32_16x16x32_bf16 v[60:63], v[108:111], v[164:167], v[60:63]
    s_waitcnt lgkmcnt(15)
    v_mfma_f32_16x16x32_bf16 v[16:19], v[112:115], v[160:163], v[16:19]
    s_add_u32 s33, s33, 131072
    buffer_load_dwordx4 v[204:207], v232, s[8:11], s33 offen sc0 sc1
    ds_read_b64_tr_b16 v[96:97], v224 offset:12416
    ds_read_b64_tr_b16 v[98:99], v224 offset:18560
    v_mfma_f32_16x16x32_bf16 v[64:67], v[112:115], v[164:167], v[64:67]
    v_mfma_f32_16x16x32_bf16 v[20:23], v[116:119], v[160:163], v[20:23]
    ds_read_b64_tr_b16 v[100:101], v225 offset:12416
    ds_read_b64_tr_b16 v[102:103], v225 offset:18560
    v_mfma_f32_16x16x32_bf16 v[68:71], v[116:119], v[164:167], v[68:71]
    v_mfma_f32_16x16x32_bf16 v[24:27], v[120:123], v[160:163], v[24:27]
    ds_read_b64_tr_b16 v[104:105], v226 offset:12416
    ds_read_b64_tr_b16 v[106:107], v226 offset:18560
    v_mfma_f32_16x16x32_bf16 v[72:75], v[120:123], v[164:167], v[72:75]
    v_mfma_f32_16x16x32_bf16 v[28:31], v[124:127], v[160:163], v[28:31]
    ds_read_b64_tr_b16 v[108:109], v227 offset:12416
    ds_read_b64_tr_b16 v[110:111], v227 offset:18560
    v_mfma_f32_16x16x32_bf16 v[76:79], v[124:127], v[164:167], v[76:79]
    s_waitcnt lgkmcnt(15)
    v_mfma_f32_16x16x32_bf16 v[32:35], v[128:131], v[160:163], v[32:35]
    ds_read_b64_tr_b16 v[112:113], v224 offset:12544
    ds_read_b64_tr_b16 v[114:115], v224 offset:18688
    v_mfma_f32_16x16x32_bf16 v[80:83], v[128:131], v[164:167], v[80:83]
    v_mfma_f32_16x16x32_bf16 v[36:39], v[132:135], v[160:163], v[36:39]
    ds_read_b64_tr_b16 v[116:117], v225 offset:12544
    ds_read_b64_tr_b16 v[118:119], v225 offset:18688
    v_mfma_f32_16x16x32_bf16 v[84:87], v[132:135], v[164:167], v[84:87]
    v_mfma_f32_16x16x32_bf16 v[40:43], v[136:139], v[160:163], v[40:43]
    ds_read_b64_tr_b16 v[120:121], v226 offset:12544
    ds_read_b64_tr_b16 v[122:123], v226 offset:18688
    v_mfma_f32_16x16x32_bf16 v[88:91], v[136:139], v[164:167], v[88:91]
    v_mfma_f32_16x16x32_bf16 v[44:47], v[140:143], v[160:163], v[44:47]
    ds_read_b64_tr_b16 v[124:125], v227 offset:12544
    ds_read_b64_tr_b16 v[126:127], v227 offset:18688
    v_mfma_f32_16x16x32_bf16 v[92:95], v[140:143], v[164:167], v[92:95]
    s_waitcnt vmcnt(20) lgkmcnt(15)
    v_mfma_f32_16x16x32_bf16 v[0:3], v[144:147], v[168:171], v[0:3]
    s_add_u32 s33, s28, 15
    v_mfma_f32_16x16x32_bf16 v[48:51], v[144:147], v[172:175], v[48:51]
    s_and_b32 s33, s33, 15
    v_mfma_f32_16x16x32_bf16 v[4:7], v[148:151], v[168:171], v[4:7]
    s_mul_i32 s33, s33, 2048
    v_mfma_f32_16x16x32_bf16 v[52:55], v[148:151], v[172:175], v[52:55]
    s_add_u32 s33, s33, s30
    buffer_load_dwordx4 v[208:211], v232, s[8:11], s33 offen sc0 sc1
    v_mfma_f32_16x16x32_bf16 v[8:11], v[152:155], v[168:171], v[8:11]
    v_mfma_f32_16x16x32_bf16 v[56:59], v[152:155], v[172:175], v[56:59]
    s_add_u32 s33, s33, 131072
    buffer_load_dwordx4 v[212:215], v232, s[8:11], s33 offen sc0 sc1
    v_mfma_f32_16x16x32_bf16 v[12:15], v[156:159], v[168:171], v[12:15]
    s_waitcnt lgkmcnt(0)
    s_barrier
    ds_read_b64_tr_b16 v[128:129], v224 offset:24576
    ds_read_b64_tr_b16 v[130:131], v224 offset:30720
    v_mfma_f32_16x16x32_bf16 v[60:63], v[156:159], v[172:175], v[60:63]
    ds_read_b64_tr_b16 v[132:133], v225 offset:24576
    ds_read_b64_tr_b16 v[134:135], v225 offset:30720
    v_mfma_f32_16x16x32_bf16 v[16:19], v[96:99], v[168:171], v[16:19]
    ds_read_b64_tr_b16 v[136:137], v226 offset:24576
    ds_read_b64_tr_b16 v[138:139], v226 offset:30720
    v_mfma_f32_16x16x32_bf16 v[64:67], v[96:99], v[172:175], v[64:67]
    ds_read_b64_tr_b16 v[140:141], v227 offset:24576
    ds_read_b64_tr_b16 v[142:143], v227 offset:30720
    v_mfma_f32_16x16x32_bf16 v[20:23], v[100:103], v[168:171], v[20:23]
    ds_read_b64_tr_b16 v[144:145], v224 offset:24704
    ds_read_b64_tr_b16 v[146:147], v224 offset:30848
    v_mfma_f32_16x16x32_bf16 v[68:71], v[100:103], v[172:175], v[68:71]
    ds_read_b64_tr_b16 v[148:149], v225 offset:24704
    ds_read_b64_tr_b16 v[150:151], v225 offset:30848
    v_mfma_f32_16x16x32_bf16 v[24:27], v[104:107], v[168:171], v[24:27]
    ds_read_b64_tr_b16 v[152:153], v226 offset:24704
    ds_read_b64_tr_b16 v[154:155], v226 offset:30848
    v_mfma_f32_16x16x32_bf16 v[72:75], v[104:107], v[172:175], v[72:75]
    v_mfma_f32_16x16x32_bf16 v[28:31], v[108:111], v[168:171], v[28:31]
    ds_read_b64_tr_b16 v[156:157], v227 offset:24704
    ds_read_b64_tr_b16 v[158:159], v227 offset:30848
    v_mfma_f32_16x16x32_bf16 v[76:79], v[108:111], v[172:175], v[76:79]
    v_mfma_f32_16x16x32_bf16 v[32:35], v[112:115], v[168:171], v[32:35]
    ds_read_b64_tr_b16 v[96:97], v224 offset:24832
    ds_read_b64_tr_b16 v[98:99], v224 offset:30976
    v_mfma_f32_16x16x32_bf16 v[80:83], v[112:115], v[172:175], v[80:83]
    v_mfma_f32_16x16x32_bf16 v[36:39], v[116:119], v[168:171], v[36:39]
    ds_read_b64_tr_b16 v[100:101], v225 offset:24832
    ds_read_b64_tr_b16 v[102:103], v225 offset:30976
    v_mfma_f32_16x16x32_bf16 v[84:87], v[116:119], v[172:175], v[84:87]
    v_mfma_f32_16x16x32_bf16 v[40:43], v[120:123], v[168:171], v[40:43]
    ds_read_b64_tr_b16 v[104:105], v226 offset:24832
    ds_read_b64_tr_b16 v[106:107], v226 offset:30976
    v_mfma_f32_16x16x32_bf16 v[88:91], v[120:123], v[172:175], v[88:91]
    v_mfma_f32_16x16x32_bf16 v[44:47], v[124:127], v[168:171], v[44:47]
    ds_read_b64_tr_b16 v[108:109], v227 offset:24832
    ds_read_b64_tr_b16 v[110:111], v227 offset:30976
    v_mfma_f32_16x16x32_bf16 v[92:95], v[124:127], v[172:175], v[92:95]
    s_waitcnt vmcnt(20) lgkmcnt(15)
    v_mfma_f32_16x16x32_bf16 v[0:3], v[128:131], v[176:179], v[0:3]
    s_add_u32 s33, s28, 15
    ds_read_b64_tr_b16 v[112:113], v224 offset:36864
    ds_read_b64_tr_b16 v[114:115], v224 offset:43008
    v_mfma_f32_16x16x32_bf16 v[48:51], v[128:131], v[180:183], v[48:51]
    s_and_b32 s33, s33, 15
    v_mfma_f32_16x16x32_bf16 v[4:7], v[132:135], v[176:179], v[4:7]
    s_mul_i32 s33, s33, 2048
    ds_read_b64_tr_b16 v[116:117], v225 offset:36864
    ds_read_b64_tr_b16 v[118:119], v225 offset:43008
    v_mfma_f32_16x16x32_bf16 v[52:55], v[132:135], v[180:183], v[52:55]
    s_add_u32 s33, s33, s30
    v_mfma_f32_16x16x32_bf16 v[8:11], v[136:139], v[176:179], v[8:11]
    s_add_u32 s33, s33, 1024
    buffer_load_dwordx4 v[216:219], v232, s[8:11], s33 offen sc0 sc1
    ds_read_b64_tr_b16 v[120:121], v226 offset:36864
    ds_read_b64_tr_b16 v[122:123], v226 offset:43008
    v_mfma_f32_16x16x32_bf16 v[56:59], v[136:139], v[180:183], v[56:59]
    v_mfma_f32_16x16x32_bf16 v[12:15], v[140:143], v[176:179], v[12:15]
    s_add_u32 s33, s33, 131072
    buffer_load_dwordx4 v[220:223], v232, s[8:11], s33 offen sc0 sc1
    ds_read_b64_tr_b16 v[124:125], v227 offset:36864
    ds_read_b64_tr_b16 v[126:127], v227 offset:43008
    v_mfma_f32_16x16x32_bf16 v[60:63], v[140:143], v[180:183], v[60:63]
    s_waitcnt lgkmcnt(15)
    v_mfma_f32_16x16x32_bf16 v[16:19], v[144:147], v[176:179], v[16:19]
    ds_read_b64_tr_b16 v[128:129], v224 offset:36992
    ds_read_b64_tr_b16 v[130:131], v224 offset:43136
    v_mfma_f32_16x16x32_bf16 v[64:67], v[144:147], v[180:183], v[64:67]
    v_mfma_f32_16x16x32_bf16 v[20:23], v[148:151], v[176:179], v[20:23]
    ds_read_b64_tr_b16 v[132:133], v225 offset:36992
    ds_read_b64_tr_b16 v[134:135], v225 offset:43136
    v_mfma_f32_16x16x32_bf16 v[68:71], v[148:151], v[180:183], v[68:71]
    v_mfma_f32_16x16x32_bf16 v[24:27], v[152:155], v[176:179], v[24:27]
    ds_read_b64_tr_b16 v[136:137], v226 offset:36992
    ds_read_b64_tr_b16 v[138:139], v226 offset:43136
    v_mfma_f32_16x16x32_bf16 v[72:75], v[152:155], v[180:183], v[72:75]
    v_mfma_f32_16x16x32_bf16 v[28:31], v[156:159], v[176:179], v[28:31]
    ds_read_b64_tr_b16 v[140:141], v227 offset:36992
    ds_read_b64_tr_b16 v[142:143], v227 offset:43136
    v_mfma_f32_16x16x32_bf16 v[76:79], v[156:159], v[180:183], v[76:79]
    s_waitcnt lgkmcnt(15)
    v_mfma_f32_16x16x32_bf16 v[32:35], v[96:99], v[176:179], v[32:35]
    ds_read_b64_tr_b16 v[144:145], v224 offset:37120
    ds_read_b64_tr_b16 v[146:147], v224 offset:43264
    v_mfma_f32_16x16x32_bf16 v[80:83], v[96:99], v[180:183], v[80:83]
    v_mfma_f32_16x16x32_bf16 v[36:39], v[100:103], v[176:179], v[36:39]
    ds_read_b64_tr_b16 v[148:149], v225 offset:37120
    ds_read_b64_tr_b16 v[150:151], v225 offset:43264
    v_mfma_f32_16x16x32_bf16 v[84:87], v[100:103], v[180:183], v[84:87]
    v_mfma_f32_16x16x32_bf16 v[40:43], v[104:107], v[176:179], v[40:43]
    ds_read_b64_tr_b16 v[152:153], v226 offset:37120
    ds_read_b64_tr_b16 v[154:155], v226 offset:43264
    v_mfma_f32_16x16x32_bf16 v[88:91], v[104:107], v[180:183], v[88:91]
    v_mfma_f32_16x16x32_bf16 v[44:47], v[108:111], v[176:179], v[44:47]
    ds_read_b64_tr_b16 v[156:157], v227 offset:37120
    ds_read_b64_tr_b16 v[158:159], v227 offset:43264
    v_mfma_f32_16x16x32_bf16 v[92:95], v[108:111], v[180:183], v[92:95]
    s_waitcnt vmcnt(14) lgkmcnt(15)
    v_mfma_f32_16x16x32_bf16 v[0:3], v[112:115], v[184:187], v[0:3]
    v_mfma_f32_16x16x32_bf16 v[48:51], v[112:115], v[188:191], v[48:51]
    v_mfma_f32_16x16x32_bf16 v[4:7], v[116:119], v[184:187], v[4:7]
    v_mfma_f32_16x16x32_bf16 v[52:55], v[116:119], v[188:191], v[52:55]
    v_mfma_f32_16x16x32_bf16 v[8:11], v[120:123], v[184:187], v[8:11]
    v_mfma_f32_16x16x32_bf16 v[56:59], v[120:123], v[188:191], v[56:59]
    v_mfma_f32_16x16x32_bf16 v[12:15], v[124:127], v[184:187], v[12:15]
    s_waitcnt lgkmcnt(0)
    s_barrier
    ds_read_b64_tr_b16 v[96:97], v228 offset:0
    ds_read_b64_tr_b16 v[98:99], v228 offset:6144
    v_mfma_f32_16x16x32_bf16 v[60:63], v[124:127], v[188:191], v[60:63]
    ds_read_b64_tr_b16 v[100:101], v229 offset:0
    ds_read_b64_tr_b16 v[102:103], v229 offset:6144
    v_mfma_f32_16x16x32_bf16 v[16:19], v[128:131], v[184:187], v[16:19]
    ds_read_b64_tr_b16 v[104:105], v230 offset:0
    ds_read_b64_tr_b16 v[106:107], v230 offset:6144
    v_mfma_f32_16x16x32_bf16 v[64:67], v[128:131], v[188:191], v[64:67]
    ds_read_b64_tr_b16 v[108:109], v231 offset:0
    ds_read_b64_tr_b16 v[110:111], v231 offset:6144
    v_mfma_f32_16x16x32_bf16 v[20:23], v[132:135], v[184:187], v[20:23]
    ds_read_b64_tr_b16 v[112:113], v228 offset:128
    ds_read_b64_tr_b16 v[114:115], v228 offset:6272
    v_mfma_f32_16x16x32_bf16 v[68:71], v[132:135], v[188:191], v[68:71]
    ds_read_b64_tr_b16 v[116:117], v229 offset:128
    ds_read_b64_tr_b16 v[118:119], v229 offset:6272
    v_mfma_f32_16x16x32_bf16 v[24:27], v[136:139], v[184:187], v[24:27]
    ds_read_b64_tr_b16 v[120:121], v230 offset:128
    ds_read_b64_tr_b16 v[122:123], v230 offset:6272
    v_mfma_f32_16x16x32_bf16 v[72:75], v[136:139], v[188:191], v[72:75]
    v_mfma_f32_16x16x32_bf16 v[28:31], v[140:143], v[184:187], v[28:31]
    ds_read_b64_tr_b16 v[124:125], v231 offset:128
    ds_read_b64_tr_b16 v[126:127], v231 offset:6272
    v_mfma_f32_16x16x32_bf16 v[76:79], v[140:143], v[188:191], v[76:79]
    v_mfma_f32_16x16x32_bf16 v[32:35], v[144:147], v[184:187], v[32:35]
    ds_read_b64_tr_b16 v[128:129], v228 offset:256
    ds_read_b64_tr_b16 v[130:131], v228 offset:6400
    v_mfma_f32_16x16x32_bf16 v[80:83], v[144:147], v[188:191], v[80:83]
    v_mfma_f32_16x16x32_bf16 v[36:39], v[148:151], v[184:187], v[36:39]
    ds_read_b64_tr_b16 v[132:133], v229 offset:256
    ds_read_b64_tr_b16 v[134:135], v229 offset:6400
    v_mfma_f32_16x16x32_bf16 v[84:87], v[148:151], v[188:191], v[84:87]
    v_mfma_f32_16x16x32_bf16 v[40:43], v[152:155], v[184:187], v[40:43]
    ds_read_b64_tr_b16 v[136:137], v230 offset:256
    ds_read_b64_tr_b16 v[138:139], v230 offset:6400
    v_mfma_f32_16x16x32_bf16 v[88:91], v[152:155], v[188:191], v[88:91]
    v_mfma_f32_16x16x32_bf16 v[44:47], v[156:159], v[184:187], v[44:47]
    ds_read_b64_tr_b16 v[140:141], v231 offset:256
    ds_read_b64_tr_b16 v[142:143], v231 offset:6400
    v_mfma_f32_16x16x32_bf16 v[92:95], v[156:159], v[188:191], v[92:95]
    s_waitcnt vmcnt(12) lgkmcnt(15)
    v_mfma_f32_16x16x32_bf16 v[0:3], v[96:99], v[192:195], v[0:3]
    ds_read_b64_tr_b16 v[144:145], v228 offset:12288
    ds_read_b64_tr_b16 v[146:147], v228 offset:18432
    v_mfma_f32_16x16x32_bf16 v[48:51], v[96:99], v[196:199], v[48:51]
    v_mfma_f32_16x16x32_bf16 v[4:7], v[100:103], v[192:195], v[4:7]
    ds_read_b64_tr_b16 v[148:149], v229 offset:12288
    ds_read_b64_tr_b16 v[150:151], v229 offset:18432
    v_mfma_f32_16x16x32_bf16 v[52:55], v[100:103], v[196:199], v[52:55]
    v_mfma_f32_16x16x32_bf16 v[8:11], v[104:107], v[192:195], v[8:11]
    ds_read_b64_tr_b16 v[152:153], v230 offset:12288
    ds_read_b64_tr_b16 v[154:155], v230 offset:18432
    v_mfma_f32_16x16x32_bf16 v[56:59], v[104:107], v[196:199], v[56:59]
    v_mfma_f32_16x16x32_bf16 v[12:15], v[108:111], v[192:195], v[12:15]
    ds_read_b64_tr_b16 v[156:157], v231 offset:12288
    ds_read_b64_tr_b16 v[158:159], v231 offset:18432
    v_mfma_f32_16x16x32_bf16 v[60:63], v[108:111], v[196:199], v[60:63]
    s_waitcnt lgkmcnt(15)
    v_mfma_f32_16x16x32_bf16 v[16:19], v[112:115], v[192:195], v[16:19]
    ds_read_b64_tr_b16 v[96:97], v228 offset:12416
    ds_read_b64_tr_b16 v[98:99], v228 offset:18560
    v_mfma_f32_16x16x32_bf16 v[64:67], v[112:115], v[196:199], v[64:67]
    v_mfma_f32_16x16x32_bf16 v[20:23], v[116:119], v[192:195], v[20:23]
    ds_read_b64_tr_b16 v[100:101], v229 offset:12416
    ds_read_b64_tr_b16 v[102:103], v229 offset:18560
    v_mfma_f32_16x16x32_bf16 v[68:71], v[116:119], v[196:199], v[68:71]
    v_mfma_f32_16x16x32_bf16 v[24:27], v[120:123], v[192:195], v[24:27]
    ds_read_b64_tr_b16 v[104:105], v230 offset:12416
    ds_read_b64_tr_b16 v[106:107], v230 offset:18560
    v_mfma_f32_16x16x32_bf16 v[72:75], v[120:123], v[196:199], v[72:75]
    v_mfma_f32_16x16x32_bf16 v[28:31], v[124:127], v[192:195], v[28:31]
    ds_read_b64_tr_b16 v[108:109], v231 offset:12416
    ds_read_b64_tr_b16 v[110:111], v231 offset:18560
    v_mfma_f32_16x16x32_bf16 v[76:79], v[124:127], v[196:199], v[76:79]
    s_waitcnt lgkmcnt(15)
    v_mfma_f32_16x16x32_bf16 v[32:35], v[128:131], v[192:195], v[32:35]
    ds_read_b64_tr_b16 v[112:113], v228 offset:12544
    ds_read_b64_tr_b16 v[114:115], v228 offset:18688
    v_mfma_f32_16x16x32_bf16 v[80:83], v[128:131], v[196:199], v[80:83]
    v_mfma_f32_16x16x32_bf16 v[36:39], v[132:135], v[192:195], v[36:39]
    ds_read_b64_tr_b16 v[116:117], v229 offset:12544
    ds_read_b64_tr_b16 v[118:119], v229 offset:18688
    v_mfma_f32_16x16x32_bf16 v[84:87], v[132:135], v[196:199], v[84:87]
    v_mfma_f32_16x16x32_bf16 v[40:43], v[136:139], v[192:195], v[40:43]
    ds_read_b64_tr_b16 v[120:121], v230 offset:12544
    ds_read_b64_tr_b16 v[122:123], v230 offset:18688
    v_mfma_f32_16x16x32_bf16 v[88:91], v[136:139], v[196:199], v[88:91]
    v_mfma_f32_16x16x32_bf16 v[44:47], v[140:143], v[192:195], v[44:47]
    ds_read_b64_tr_b16 v[124:125], v231 offset:12544
    ds_read_b64_tr_b16 v[126:127], v231 offset:18688
    v_mfma_f32_16x16x32_bf16 v[92:95], v[140:143], v[196:199], v[92:95]
    s_waitcnt vmcnt(4) lgkmcnt(15)
    v_mfma_f32_16x16x32_bf16 v[0:3], v[144:147], v[200:203], v[0:3]
    v_mfma_f32_16x16x32_bf16 v[48:51], v[144:147], v[204:207], v[48:51]
    v_mfma_f32_16x16x32_bf16 v[4:7], v[148:151], v[200:203], v[4:7]
    v_mfma_f32_16x16x32_bf16 v[52:55], v[148:151], v[204:207], v[52:55]
    v_mfma_f32_16x16x32_bf16 v[8:11], v[152:155], v[200:203], v[8:11]
    v_mfma_f32_16x16x32_bf16 v[56:59], v[152:155], v[204:207], v[56:59]
    v_mfma_f32_16x16x32_bf16 v[12:15], v[156:159], v[200:203], v[12:15]
    s_waitcnt lgkmcnt(0)
    s_barrier
    ds_read_b64_tr_b16 v[128:129], v228 offset:24576
    ds_read_b64_tr_b16 v[130:131], v228 offset:30720
    v_mfma_f32_16x16x32_bf16 v[60:63], v[156:159], v[204:207], v[60:63]
    ds_read_b64_tr_b16 v[132:133], v229 offset:24576
    ds_read_b64_tr_b16 v[134:135], v229 offset:30720
    v_mfma_f32_16x16x32_bf16 v[16:19], v[96:99], v[200:203], v[16:19]
    ds_read_b64_tr_b16 v[136:137], v228 offset:36864
    ds_read_b64_tr_b16 v[138:139], v228 offset:43008
    v_mfma_f32_16x16x32_bf16 v[64:67], v[96:99], v[204:207], v[64:67]
    ds_read_b64_tr_b16 v[140:141], v229 offset:36864
    ds_read_b64_tr_b16 v[142:143], v229 offset:43008
    v_mfma_f32_16x16x32_bf16 v[20:23], v[100:103], v[200:203], v[20:23]
    ds_read_b64_tr_b16 v[144:145], v230 offset:24576
    ds_read_b64_tr_b16 v[146:147], v230 offset:30720
    v_mfma_f32_16x16x32_bf16 v[68:71], v[100:103], v[204:207], v[68:71]
    ds_read_b64_tr_b16 v[148:149], v231 offset:24576
    ds_read_b64_tr_b16 v[150:151], v231 offset:30720
    v_mfma_f32_16x16x32_bf16 v[24:27], v[104:107], v[200:203], v[24:27]
    ds_read_b64_tr_b16 v[152:153], v230 offset:36864
    ds_read_b64_tr_b16 v[154:155], v230 offset:43008
    v_mfma_f32_16x16x32_bf16 v[72:75], v[104:107], v[204:207], v[72:75]
    v_mfma_f32_16x16x32_bf16 v[28:31], v[108:111], v[200:203], v[28:31]
    ds_read_b64_tr_b16 v[156:157], v231 offset:36864
    ds_read_b64_tr_b16 v[158:159], v231 offset:43008
    v_mfma_f32_16x16x32_bf16 v[76:79], v[108:111], v[204:207], v[76:79]
    v_mfma_f32_16x16x32_bf16 v[32:35], v[112:115], v[200:203], v[32:35]
    ds_read_b64_tr_b16 v[96:97], v228 offset:24704
    ds_read_b64_tr_b16 v[98:99], v228 offset:30848
    v_mfma_f32_16x16x32_bf16 v[80:83], v[112:115], v[204:207], v[80:83]
    v_mfma_f32_16x16x32_bf16 v[36:39], v[116:119], v[200:203], v[36:39]
    ds_read_b64_tr_b16 v[100:101], v229 offset:24704
    ds_read_b64_tr_b16 v[102:103], v229 offset:30848
    v_mfma_f32_16x16x32_bf16 v[84:87], v[116:119], v[204:207], v[84:87]
    v_mfma_f32_16x16x32_bf16 v[40:43], v[120:123], v[200:203], v[40:43]
    ds_read_b64_tr_b16 v[104:105], v228 offset:36992
    ds_read_b64_tr_b16 v[106:107], v228 offset:43136
    v_mfma_f32_16x16x32_bf16 v[88:91], v[120:123], v[204:207], v[88:91]
    v_mfma_f32_16x16x32_bf16 v[44:47], v[124:127], v[200:203], v[44:47]
    ds_read_b64_tr_b16 v[108:109], v229 offset:36992
    ds_read_b64_tr_b16 v[110:111], v229 offset:43136
    v_mfma_f32_16x16x32_bf16 v[92:95], v[124:127], v[204:207], v[92:95]
    s_waitcnt vmcnt(2) lgkmcnt(15)
    v_mfma_f32_16x16x32_bf16 v[0:3], v[128:131], v[208:211], v[0:3]
    ds_read_b64_tr_b16 v[112:113], v230 offset:24704
    ds_read_b64_tr_b16 v[114:115], v230 offset:30848
    v_mfma_f32_16x16x32_bf16 v[48:51], v[128:131], v[212:215], v[48:51]
    v_mfma_f32_16x16x32_bf16 v[4:7], v[132:135], v[208:211], v[4:7]
    ds_read_b64_tr_b16 v[116:117], v231 offset:24704
    ds_read_b64_tr_b16 v[118:119], v231 offset:30848
    v_mfma_f32_16x16x32_bf16 v[52:55], v[132:135], v[212:215], v[52:55]
    s_waitcnt vmcnt(0)
    v_mfma_f32_16x16x32_bf16 v[0:3], v[136:139], v[216:219], v[0:3]
    ds_read_b64_tr_b16 v[120:121], v230 offset:36992
    ds_read_b64_tr_b16 v[122:123], v230 offset:43136
    v_mfma_f32_16x16x32_bf16 v[48:51], v[136:139], v[220:223], v[48:51]
    v_mfma_f32_16x16x32_bf16 v[4:7], v[140:143], v[216:219], v[4:7]
    ds_read_b64_tr_b16 v[124:125], v231 offset:36992
    ds_read_b64_tr_b16 v[126:127], v231 offset:43136
    v_mfma_f32_16x16x32_bf16 v[52:55], v[140:143], v[220:223], v[52:55]
    s_waitcnt lgkmcnt(15)
    v_mfma_f32_16x16x32_bf16 v[8:11], v[144:147], v[208:211], v[8:11]
    ds_read_b64_tr_b16 v[128:129], v228 offset:24832
    ds_read_b64_tr_b16 v[130:131], v228 offset:30976
    v_mfma_f32_16x16x32_bf16 v[56:59], v[144:147], v[212:215], v[56:59]
    v_mfma_f32_16x16x32_bf16 v[12:15], v[148:151], v[208:211], v[12:15]
    ds_read_b64_tr_b16 v[132:133], v229 offset:24832
    ds_read_b64_tr_b16 v[134:135], v229 offset:30976
    v_mfma_f32_16x16x32_bf16 v[60:63], v[148:151], v[212:215], v[60:63]
    v_mfma_f32_16x16x32_bf16 v[8:11], v[152:155], v[216:219], v[8:11]
    ds_read_b64_tr_b16 v[136:137], v228 offset:37120
    ds_read_b64_tr_b16 v[138:139], v228 offset:43264
    v_mfma_f32_16x16x32_bf16 v[56:59], v[152:155], v[220:223], v[56:59]
    v_mfma_f32_16x16x32_bf16 v[12:15], v[156:159], v[216:219], v[12:15]
    ds_read_b64_tr_b16 v[140:141], v229 offset:37120
    ds_read_b64_tr_b16 v[142:143], v229 offset:43264
    v_mfma_f32_16x16x32_bf16 v[60:63], v[156:159], v[220:223], v[60:63]
    s_waitcnt lgkmcnt(15)
    v_cvt_pk_bf16_f32 v160, v0, v1
    v_cvt_pk_bf16_f32 v161, v2, v3
    v_cvt_pk_bf16_f32 v162, v4, v5
    v_cvt_pk_bf16_f32 v163, v6, v7
    s_add_u32 s32, s35, 0
    buffer_store_dwordx4 v[160:163], v232, s[12:15], s32 offen offset:0 sc0 sc1
    v_cvt_pk_bf16_f32 v164, v48, v49
    v_cvt_pk_bf16_f32 v165, v50, v51
    v_cvt_pk_bf16_f32 v166, v52, v53
    v_cvt_pk_bf16_f32 v167, v54, v55
    s_add_u32 s32, s35, 4096
    buffer_store_dwordx4 v[164:167], v232, s[12:15], s32 offen offset:2048 sc0 sc1
    v_mfma_f32_16x16x32_bf16 v[16:19], v[96:99], v[208:211], v[16:19]
    ds_read_b64_tr_b16 v[144:145], v230 offset:24832
    ds_read_b64_tr_b16 v[146:147], v230 offset:30976
    v_mfma_f32_16x16x32_bf16 v[64:67], v[96:99], v[212:215], v[64:67]
    v_mfma_f32_16x16x32_bf16 v[20:23], v[100:103], v[208:211], v[20:23]
    ds_read_b64_tr_b16 v[148:149], v231 offset:24832
    ds_read_b64_tr_b16 v[150:151], v231 offset:30976
    v_mfma_f32_16x16x32_bf16 v[68:71], v[100:103], v[212:215], v[68:71]
    v_mfma_f32_16x16x32_bf16 v[16:19], v[104:107], v[216:219], v[16:19]
    ds_read_b64_tr_b16 v[152:153], v230 offset:37120
    ds_read_b64_tr_b16 v[154:155], v230 offset:43264
    v_mfma_f32_16x16x32_bf16 v[64:67], v[104:107], v[220:223], v[64:67]
    v_mfma_f32_16x16x32_bf16 v[20:23], v[108:111], v[216:219], v[20:23]
    ds_read_b64_tr_b16 v[156:157], v231 offset:37120
    ds_read_b64_tr_b16 v[158:159], v231 offset:43264
    v_mfma_f32_16x16x32_bf16 v[68:71], v[108:111], v[220:223], v[68:71]
    s_waitcnt lgkmcnt(15)
    v_cvt_pk_bf16_f32 v168, v8, v9
    v_cvt_pk_bf16_f32 v169, v10, v11
    v_cvt_pk_bf16_f32 v170, v12, v13
    v_cvt_pk_bf16_f32 v171, v14, v15
    s_add_u32 s32, s35, 0
    buffer_store_dwordx4 v[168:171], v232, s[12:15], s32 offen offset:1024 sc0 sc1
    v_cvt_pk_bf16_f32 v172, v56, v57
    v_cvt_pk_bf16_f32 v173, v58, v59
    v_cvt_pk_bf16_f32 v174, v60, v61
    v_cvt_pk_bf16_f32 v175, v62, v63
    s_add_u32 s32, s35, 4096
    buffer_store_dwordx4 v[172:175], v232, s[12:15], s32 offen offset:3072 sc0 sc1
    v_mfma_f32_16x16x32_bf16 v[24:27], v[112:115], v[208:211], v[24:27]
    v_mfma_f32_16x16x32_bf16 v[72:75], v[112:115], v[212:215], v[72:75]
    v_mfma_f32_16x16x32_bf16 v[28:31], v[116:119], v[208:211], v[28:31]
    v_mfma_f32_16x16x32_bf16 v[76:79], v[116:119], v[212:215], v[76:79]
    v_mfma_f32_16x16x32_bf16 v[24:27], v[120:123], v[216:219], v[24:27]
    v_mfma_f32_16x16x32_bf16 v[72:75], v[120:123], v[220:223], v[72:75]
    v_mfma_f32_16x16x32_bf16 v[28:31], v[124:127], v[216:219], v[28:31]
    v_mfma_f32_16x16x32_bf16 v[76:79], v[124:127], v[220:223], v[76:79]
    s_waitcnt lgkmcnt(12)
    v_cvt_pk_bf16_f32 v176, v16, v17
    v_cvt_pk_bf16_f32 v177, v18, v19
    v_cvt_pk_bf16_f32 v178, v20, v21
    v_cvt_pk_bf16_f32 v179, v22, v23
    s_add_u32 s32, s35, 0
    buffer_store_dwordx4 v[176:179], v232, s[12:15], s32 offen offset:2048 sc0 sc1
    v_cvt_pk_bf16_f32 v180, v64, v65
    v_cvt_pk_bf16_f32 v181, v66, v67
    v_cvt_pk_bf16_f32 v182, v68, v69
    v_cvt_pk_bf16_f32 v183, v70, v71
    s_add_u32 s32, s35, 8192
    buffer_store_dwordx4 v[180:183], v232, s[12:15], s32 offen offset:0 sc0 sc1
    v_mfma_f32_16x16x32_bf16 v[32:35], v[128:131], v[208:211], v[32:35]
    v_mfma_f32_16x16x32_bf16 v[80:83], v[128:131], v[212:215], v[80:83]
    v_mfma_f32_16x16x32_bf16 v[36:39], v[132:135], v[208:211], v[36:39]
    v_mfma_f32_16x16x32_bf16 v[84:87], v[132:135], v[212:215], v[84:87]
    s_waitcnt lgkmcnt(8)
    v_mfma_f32_16x16x32_bf16 v[32:35], v[136:139], v[216:219], v[32:35]
    v_mfma_f32_16x16x32_bf16 v[80:83], v[136:139], v[220:223], v[80:83]
    v_mfma_f32_16x16x32_bf16 v[36:39], v[140:143], v[216:219], v[36:39]
    v_mfma_f32_16x16x32_bf16 v[84:87], v[140:143], v[220:223], v[84:87]
    s_waitcnt lgkmcnt(4)
    v_cvt_pk_bf16_f32 v184, v24, v25
    v_cvt_pk_bf16_f32 v185, v26, v27
    v_cvt_pk_bf16_f32 v186, v28, v29
    v_cvt_pk_bf16_f32 v187, v30, v31
    s_add_u32 s32, s35, 0
    buffer_store_dwordx4 v[184:187], v232, s[12:15], s32 offen offset:3072 sc0 sc1
    v_cvt_pk_bf16_f32 v188, v72, v73
    v_cvt_pk_bf16_f32 v189, v74, v75
    v_cvt_pk_bf16_f32 v190, v76, v77
    v_cvt_pk_bf16_f32 v191, v78, v79
    s_add_u32 s32, s35, 8192
    buffer_store_dwordx4 v[188:191], v232, s[12:15], s32 offen offset:1024 sc0 sc1
    v_mfma_f32_16x16x32_bf16 v[40:43], v[144:147], v[208:211], v[40:43]
    v_mfma_f32_16x16x32_bf16 v[88:91], v[144:147], v[212:215], v[88:91]
    v_mfma_f32_16x16x32_bf16 v[44:47], v[148:151], v[208:211], v[44:47]
    v_mfma_f32_16x16x32_bf16 v[92:95], v[148:151], v[212:215], v[92:95]
    s_waitcnt lgkmcnt(0)
    v_mfma_f32_16x16x32_bf16 v[40:43], v[152:155], v[216:219], v[40:43]
    v_mfma_f32_16x16x32_bf16 v[88:91], v[152:155], v[220:223], v[88:91]
    v_mfma_f32_16x16x32_bf16 v[44:47], v[156:159], v[216:219], v[44:47]
    v_mfma_f32_16x16x32_bf16 v[92:95], v[156:159], v[220:223], v[92:95]
    v_cvt_pk_bf16_f32 v160, v32, v33
    v_cvt_pk_bf16_f32 v161, v34, v35
    v_cvt_pk_bf16_f32 v162, v36, v37
    v_cvt_pk_bf16_f32 v163, v38, v39
    s_add_u32 s32, s35, 4096
    buffer_store_dwordx4 v[160:163], v232, s[12:15], s32 offen offset:0 sc0 sc1
    v_cvt_pk_bf16_f32 v164, v80, v81
    v_cvt_pk_bf16_f32 v165, v82, v83
    v_cvt_pk_bf16_f32 v166, v84, v85
    v_cvt_pk_bf16_f32 v167, v86, v87
    s_add_u32 s32, s35, 8192
    buffer_store_dwordx4 v[164:167], v232, s[12:15], s32 offen offset:2048 sc0 sc1
    s_nop 3
    v_cvt_pk_bf16_f32 v168, v40, v41
    v_cvt_pk_bf16_f32 v169, v42, v43
    v_cvt_pk_bf16_f32 v170, v44, v45
    v_cvt_pk_bf16_f32 v171, v46, v47
    s_add_u32 s32, s35, 4096
    buffer_store_dwordx4 v[168:171], v232, s[12:15], s32 offen offset:1024 sc0 sc1
    v_cvt_pk_bf16_f32 v172, v88, v89
    v_cvt_pk_bf16_f32 v173, v90, v91
    v_cvt_pk_bf16_f32 v174, v92, v93
    v_cvt_pk_bf16_f32 v175, v94, v95
    s_add_u32 s32, s35, 8192
    buffer_store_dwordx4 v[172:175], v232, s[12:15], s32 offen offset:3072 sc0 sc1
    s_lshl_b32 s36, s43, 3
    s_lshl_b32 s37, s51, 2
    s_add_u32 s36, s36, s37
    v_add_u32 v12, s36, v252
    v_lshlrev_b32 v12, 7, v12
    v_mov_b32 v13, 3
    s_mul_i32 s32, s36, 49152
    s_mul_i32 s37, s25, 12288
    s_add_u32 s32, s32, s37
    s_mul_i32 s37, s24, 3072
    s_add_u32 s32, s32, s37
    s_mov_b32 s20, s76
    s_mov_b32 s21, s77
    s_mov_b32 s22, 2949120
    s_mov_b32 s23, 0x20000
    v_and_b32 v4, 15, v252
    v_lshrrev_b32 v5, 4, v252
    s_lshl_b32 s37, s26, 3
    s_lshl_b32 s38, s25, 1
    s_add_u32 s37, s37, s38
    s_lshr_b32 s38, s24, 1
    s_add_u32 s37, s37, s38
    s_lshl_b32 s37, s37, 4
    v_add_u32 v4, s37, v4
    v_mul_u32_u24 v4, 2304, v4
    v_and_b32 v6, 1, v5
    v_lshlrev_b32 v6, 5, v6
    v_lshrrev_b32 v7, 1, v5
    v_lshl_add_u32 v6, v7, 4, v6
    v_add_u32 v4, v4, v6
    s_mul_i32 s37, s51, 1152
    s_mul_i32 s38, s27, 384
    s_add_u32 s37, s37, s38
    s_and_b32 s38, s24, 1
    s_mul_i32 s38, s38, 192
    s_add_u32 s34, s37, s38
    s_waitcnt vmcnt(0)
    s_barrier
    s_cmp_lg_u32 s24, 0
    s_cbranch_scc1 L_attn_f3
    v_mov_b32 v116, 3
    v_mov_b32 v117, 0
    s_mov_b64 exec, 1
    buffer_store_dword v116, v117, s[16:19], s90 offen sc0 sc1
    s_mov_b64 exec, -1
L_attn_f3:
    s_cmp_lg_u32 s24, 0
    s_cbranch_scc1 L_attn_p2_done
    s_mov_b32 s44, 0
    s_mov_b64 exec, 0xf
L_attn_p2_loop:
    buffer_load_dword v14, v12, s[16:19], 0 offen sc0 sc1
    s_waitcnt vmcnt(0)
    v_cmp_lt_u32 vcc, v14, v13
    s_nop 4
    s_cbranch_vccz L_attn_p2_restore
    s_add_u32 s44, s44, 1
    s_cmp_lt_u32 s44, 65536
    s_cbranch_scc0 L_attn_p2_restore
    s_sleep 1
    s_branch L_attn_p2_loop
L_attn_p2_restore:
    s_mov_b64 exec, -1
L_attn_p2_done:
    s_barrier
    buffer_load_dwordx4 v[16:19], v232, s[12:15], s32 offen offset:0 sc0 sc1
    buffer_load_dwordx4 v[20:23], v232, s[12:15], s32 offen offset:1024 sc0 sc1
    buffer_load_dwordx4 v[24:27], v232, s[12:15], s32 offen offset:2048 sc0 sc1
    s_add_u32 s32, s32, 49152
    buffer_load_dwordx4 v[28:31], v232, s[12:15], s32 offen offset:0 sc0 sc1
    buffer_load_dwordx4 v[32:35], v232, s[12:15], s32 offen offset:1024 sc0 sc1
    buffer_load_dwordx4 v[36:39], v232, s[12:15], s32 offen offset:2048 sc0 sc1
    s_add_u32 s32, s32, 49152
    buffer_load_dwordx4 v[40:43], v232, s[12:15], s32 offen offset:0 sc0 sc1
    buffer_load_dwordx4 v[44:47], v232, s[12:15], s32 offen offset:1024 sc0 sc1
    buffer_load_dwordx4 v[48:51], v232, s[12:15], s32 offen offset:2048 sc0 sc1
    s_add_u32 s32, s32, 49152
    buffer_load_dwordx4 v[52:55], v232, s[12:15], s32 offen offset:0 sc0 sc1
    buffer_load_dwordx4 v[56:59], v232, s[12:15], s32 offen offset:1024 sc0 sc1
    buffer_load_dwordx4 v[60:63], v232, s[12:15], s32 offen offset:2048 sc0 sc1
    s_mov_b32 s36, 0xffff0000
    s_waitcnt vmcnt(9)
    v_lshlrev_b32 v64, 16, v16
    v_and_b32 v65, s36, v16
    v_lshlrev_b32 v66, 16, v17
    v_and_b32 v67, s36, v17
    v_lshlrev_b32 v68, 16, v18
    v_and_b32 v69, s36, v18
    v_lshlrev_b32 v70, 16, v19
    v_and_b32 v71, s36, v19
    v_lshlrev_b32 v72, 16, v20
    v_and_b32 v73, s36, v20
    v_lshlrev_b32 v74, 16, v21
    v_and_b32 v75, s36, v21
    v_lshlrev_b32 v76, 16, v22
    v_and_b32 v77, s36, v22
    v_lshlrev_b32 v78, 16, v23
    v_and_b32 v79, s36, v23
    v_lshlrev_b32 v80, 16, v24
    v_and_b32 v81, s36, v24
    v_lshlrev_b32 v82, 16, v25
    v_and_b32 v83, s36, v25
    v_lshlrev_b32 v84, 16, v26
    v_and_b32 v85, s36, v26
    v_lshlrev_b32 v86, 16, v27
    v_and_b32 v87, s36, v27
    s_waitcnt vmcnt(6)
    v_lshlrev_b32 v8, 16, v28
    v_and_b32 v9, s36, v28
    v_pk_add_f32 v[64:65], v[64:65], v[8:9]
    v_lshlrev_b32 v8, 16, v29
    v_and_b32 v9, s36, v29
    v_pk_add_f32 v[66:67], v[66:67], v[8:9]
    v_lshlrev_b32 v8, 16, v30
    v_and_b32 v9, s36, v30
    v_pk_add_f32 v[68:69], v[68:69], v[8:9]
    v_lshlrev_b32 v8, 16, v31
    v_and_b32 v9, s36, v31
    v_pk_add_f32 v[70:71], v[70:71], v[8:9]
    v_lshlrev_b32 v8, 16, v32
    v_and_b32 v9, s36, v32
    v_pk_add_f32 v[72:73], v[72:73], v[8:9]
    v_lshlrev_b32 v8, 16, v33
    v_and_b32 v9, s36, v33
    v_pk_add_f32 v[74:75], v[74:75], v[8:9]
    v_lshlrev_b32 v8, 16, v34
    v_and_b32 v9, s36, v34
    v_pk_add_f32 v[76:77], v[76:77], v[8:9]
    v_lshlrev_b32 v8, 16, v35
    v_and_b32 v9, s36, v35
    v_pk_add_f32 v[78:79], v[78:79], v[8:9]
    v_lshlrev_b32 v8, 16, v36
    v_and_b32 v9, s36, v36
    v_pk_add_f32 v[80:81], v[80:81], v[8:9]
    v_lshlrev_b32 v8, 16, v37
    v_and_b32 v9, s36, v37
    v_pk_add_f32 v[82:83], v[82:83], v[8:9]
    v_lshlrev_b32 v8, 16, v38
    v_and_b32 v9, s36, v38
    v_pk_add_f32 v[84:85], v[84:85], v[8:9]
    v_lshlrev_b32 v8, 16, v39
    v_and_b32 v9, s36, v39
    v_pk_add_f32 v[86:87], v[86:87], v[8:9]
    s_waitcnt vmcnt(3)
    v_lshlrev_b32 v8, 16, v40
    v_and_b32 v9, s36, v40
    v_pk_add_f32 v[64:65], v[64:65], v[8:9]
    v_lshlrev_b32 v8, 16, v41
    v_and_b32 v9, s36, v41
    v_pk_add_f32 v[66:67], v[66:67], v[8:9]
    v_lshlrev_b32 v8, 16, v42
    v_and_b32 v9, s36, v42
    v_pk_add_f32 v[68:69], v[68:69], v[8:9]
    v_lshlrev_b32 v8, 16, v43
    v_and_b32 v9, s36, v43
    v_pk_add_f32 v[70:71], v[70:71], v[8:9]
    v_lshlrev_b32 v8, 16, v44
    v_and_b32 v9, s36, v44
    v_pk_add_f32 v[72:73], v[72:73], v[8:9]
    v_lshlrev_b32 v8, 16, v45
    v_and_b32 v9, s36, v45
    v_pk_add_f32 v[74:75], v[74:75], v[8:9]
    v_lshlrev_b32 v8, 16, v46
    v_and_b32 v9, s36, v46
    v_pk_add_f32 v[76:77], v[76:77], v[8:9]
    v_lshlrev_b32 v8, 16, v47
    v_and_b32 v9, s36, v47
    v_pk_add_f32 v[78:79], v[78:79], v[8:9]
    v_lshlrev_b32 v8, 16, v48
    v_and_b32 v9, s36, v48
    v_pk_add_f32 v[80:81], v[80:81], v[8:9]
    v_lshlrev_b32 v8, 16, v49
    v_and_b32 v9, s36, v49
    v_pk_add_f32 v[82:83], v[82:83], v[8:9]
    v_lshlrev_b32 v8, 16, v50
    v_and_b32 v9, s36, v50
    v_pk_add_f32 v[84:85], v[84:85], v[8:9]
    v_lshlrev_b32 v8, 16, v51
    v_and_b32 v9, s36, v51
    v_pk_add_f32 v[86:87], v[86:87], v[8:9]
    s_waitcnt vmcnt(0)
    v_lshlrev_b32 v8, 16, v52
    v_and_b32 v9, s36, v52
    v_pk_add_f32 v[64:65], v[64:65], v[8:9]
    v_lshlrev_b32 v8, 16, v53
    v_and_b32 v9, s36, v53
    v_pk_add_f32 v[66:67], v[66:67], v[8:9]
    v_lshlrev_b32 v8, 16, v54
    v_and_b32 v9, s36, v54
    v_pk_add_f32 v[68:69], v[68:69], v[8:9]
    v_lshlrev_b32 v8, 16, v55
    v_and_b32 v9, s36, v55
    v_pk_add_f32 v[70:71], v[70:71], v[8:9]
    v_lshlrev_b32 v8, 16, v56
    v_and_b32 v9, s36, v56
    v_pk_add_f32 v[72:73], v[72:73], v[8:9]
    v_lshlrev_b32 v8, 16, v57
    v_and_b32 v9, s36, v57
    v_pk_add_f32 v[74:75], v[74:75], v[8:9]
    v_lshlrev_b32 v8, 16, v58
    v_and_b32 v9, s36, v58
    v_pk_add_f32 v[76:77], v[76:77], v[8:9]
    v_lshlrev_b32 v8, 16, v59
    v_and_b32 v9, s36, v59
    v_pk_add_f32 v[78:79], v[78:79], v[8:9]
    v_lshlrev_b32 v8, 16, v60
    v_and_b32 v9, s36, v60
    v_pk_add_f32 v[80:81], v[80:81], v[8:9]
    v_lshlrev_b32 v8, 16, v61
    v_and_b32 v9, s36, v61
    v_pk_add_f32 v[82:83], v[82:83], v[8:9]
    v_lshlrev_b32 v8, 16, v62
    v_and_b32 v9, s36, v62
    v_pk_add_f32 v[84:85], v[84:85], v[8:9]
    v_lshlrev_b32 v8, 16, v63
    v_and_b32 v9, s36, v63
    v_pk_add_f32 v[86:87], v[86:87], v[8:9]
    v_cvt_pk_bf16_f32 v120, v64, v65
    v_cvt_pk_bf16_f32 v121, v66, v67
    v_cvt_pk_bf16_f32 v122, v68, v69
    v_cvt_pk_bf16_f32 v123, v70, v71
    v_cvt_pk_bf16_f32 v124, v72, v73
    v_cvt_pk_bf16_f32 v125, v74, v75
    v_cvt_pk_bf16_f32 v126, v76, v77
    v_cvt_pk_bf16_f32 v127, v78, v79
    v_cvt_pk_bf16_f32 v128, v80, v81
    v_cvt_pk_bf16_f32 v129, v82, v83
    v_cvt_pk_bf16_f32 v130, v84, v85
    v_cvt_pk_bf16_f32 v131, v86, v87
    s_nop 1
    v_permlane16_swap_b32 v120, v122
    v_permlane16_swap_b32 v121, v123
    v_permlane16_swap_b32 v124, v126
    v_permlane16_swap_b32 v125, v127
    v_permlane16_swap_b32 v128, v130
    v_permlane16_swap_b32 v129, v131
    s_nop 1
    buffer_store_dwordx4 v[120:123], v4, s[20:23], s34 offen offset:0
    buffer_store_dwordx4 v[124:127], v4, s[20:23], s34 offen offset:64
    buffer_store_dwordx4 v[128:131], v4, s[20:23], s34 offen offset:128
    s_endpgm
L_attn_slow:
    s_waitcnt vmcnt(0) lgkmcnt(0)
    s_barrier
    s_lshl_b32 s55, s40, 4
    v_mov_b32 v152, 0xff800000
    v_mov_b32 v153, 0xff800000
    v_mov_b32 v154, 0xff800000
    v_mov_b32 v155, 0xff800000
    v_mov_b32 v156, 0xff800000
    s_mov_b32 s41, 0
L_attn_sp1:
    s_add_u32 s26, s55, s41
    s_add_u32 s38, s26, 0
    s_add_u32 s36, s38, s86
    s_and_b32 s36, s36, 15
    s_lshl_b32 s36, s36, 14
    s_add_u32 s36, s36, s42
    s_lshr_b32 s37, s38, 4
    s_lshl_b32 s37, s37, 25
    s_add_u32 s36, s36, s37
    s_cmp_lt_u32 s38, 32
    s_cselect_b32 s29, s36, 0x70000000
    s_add_u32 m0, s52, 0
    s_nop 0
    buffer_load_dwordx4 v164, s[4:7], s29 offen nt lds
    buffer_load_dwordx4 v165, s[4:7], s29 offen offset:1024 nt lds
    buffer_load_dwordx4 v166, s[4:7], s29 offen offset:2048 nt lds
    buffer_load_dwordx4 v167, s[4:7], s29 offen offset:3072 nt lds
    s_waitcnt vmcnt(0)
    s_barrier
    s_mov_b32 s27, 0
    s_add_u32 s39, s25, s27
    v_add_u32 v172, s39, v160
    v_xor_b32 v173, 64, v172
    v_xor_b32 v174, 128, v172
    v_xor_b32 v175, 192, v172
    ds_read_b128 v[24:27], v172 offset:0
    ds_read_b128 v[28:31], v173 offset:0
    ds_read_b128 v[32:35], v174 offset:0
    ds_read_b128 v[36:39], v175 offset:0
    ds_read_b128 v[40:43], v172 offset:4096
    ds_read_b128 v[44:47], v173 offset:4096
    ds_read_b128 v[48:51], v174 offset:4096
    ds_read_b128 v[52:55], v175 offset:4096
    s_waitcnt lgkmcnt(0)
    s_barrier
    v_mfma_f32_16x16x32_bf16 v[0:3], v[24:27], a[160:163], 0
    v_mfma_f32_16x16x32_bf16 v[0:3], v[28:31], a[164:167], v[0:3]
    v_mfma_f32_16x16x32_bf16 v[0:3], v[32:35], a[168:171], v[0:3]
    v_mfma_f32_16x16x32_bf16 v[0:3], v[36:39], a[172:175], v[0:3]
    v_mfma_f32_16x16x32_bf16 v[4:7], v[40:43], a[160:163], 0
    v_mfma_f32_16x16x32_bf16 v[4:7], v[44:47], a[164:167], v[4:7]
    v_mfma_f32_16x16x32_bf16 v[4:7], v[48:51], a[168:171], v[4:7]
    v_mfma_f32_16x16x32_bf16 v[4:7], v[52:55], a[172:175], v[4:7]
    s_nop 3
    v_max3_f32 v152, v0, v1, v152
    v_max3_f32 v152, v2, v3, v152
    s_nop 1
    v_max3_f32 v152, v4, v5, v152
    v_max3_f32 v152, v6, v7, v152
    v_mfma_f32_16x16x32_bf16 v[0:3], v[24:27], a[176:179], 0
    v_mfma_f32_16x16x32_bf16 v[0:3], v[28:31], a[180:183], v[0:3]
    v_mfma_f32_16x16x32_bf16 v[0:3], v[32:35], a[184:187], v[0:3]
    v_mfma_f32_16x16x32_bf16 v[0:3], v[36:39], a[188:191], v[0:3]
    v_mfma_f32_16x16x32_bf16 v[4:7], v[40:43], a[176:179], 0
    v_mfma_f32_16x16x32_bf16 v[4:7], v[44:47], a[180:183], v[4:7]
    v_mfma_f32_16x16x32_bf16 v[4:7], v[48:51], a[184:187], v[4:7]
    v_mfma_f32_16x16x32_bf16 v[4:7], v[52:55], a[188:191], v[4:7]
    s_nop 3
    v_max3_f32 v153, v0, v1, v153
    v_max3_f32 v153, v2, v3, v153
    s_nop 1
    v_max3_f32 v153, v4, v5, v153
    v_max3_f32 v153, v6, v7, v153
    v_mfma_f32_16x16x32_bf16 v[0:3], v[24:27], a[192:195], 0
    v_mfma_f32_16x16x32_bf16 v[0:3], v[28:31], a[196:199], v[0:3]
    v_mfma_f32_16x16x32_bf16 v[0:3], v[32:35], a[200:203], v[0:3]
    v_mfma_f32_16x16x32_bf16 v[0:3], v[36:39], a[204:207], v[0:3]
    v_mfma_f32_16x16x32_bf16 v[4:7], v[40:43], a[192:195], 0
    v_mfma_f32_16x16x32_bf16 v[4:7], v[44:47], a[196:199], v[4:7]
    v_mfma_f32_16x16x32_bf16 v[4:7], v[48:51], a[200:203], v[4:7]
    v_mfma_f32_16x16x32_bf16 v[4:7], v[52:55], a[204:207], v[4:7]
    s_nop 3
    v_max3_f32 v154, v0, v1, v154
    v_max3_f32 v154, v2, v3, v154
    s_nop 1
    v_max3_f32 v154, v4, v5, v154
    v_max3_f32 v154, v6, v7, v154
    v_mfma_f32_16x16x32_bf16 v[0:3], v[24:27], a[208:211], 0
    v_mfma_f32_16x16x32_bf16 v[0:3], v[28:31], a[212:215], v[0:3]
    v_mfma_f32_16x16x32_bf16 v[0:3], v[32:35], a[216:219], v[0:3]
    v_mfma_f32_16x16x32_bf16 v[0:3], v[36:39], a[220:223], v[0:3]
    v_mfma_f32_16x16x32_bf16 v[4:7], v[40:43], a[208:211], 0
    v_mfma_f32_16x16x32_bf16 v[4:7], v[44:47], a[212:215], v[4:7]
    v_mfma_f32_16x16x32_bf16 v[4:7], v[48:51], a[216:219], v[4:7]
    v_mfma_f32_16x16x32_bf16 v[4:7], v[52:55], a[220:223], v[4:7]
    s_nop 3
    v_max3_f32 v155, v0, v1, v155
    v_max3_f32 v155, v2, v3, v155
    s_nop 1
    v_max3_f32 v155, v4, v5, v155
    v_max3_f32 v155, v6, v7, v155
    v_mfma_f32_16x16x32_bf16 v[0:3], v[24:27], a[224:227], 0
    v_mfma_f32_16x16x32_bf16 v[0:3], v[28:31], a[228:231], v[0:3]
    v_mfma_f32_16x16x32_bf16 v[0:3], v[32:35], a[232:235], v[0:3]
    v_mfma_f32_16x16x32_bf16 v[0:3], v[36:39], a[236:239], v[0:3]
    v_mfma_f32_16x16x32_bf16 v[4:7], v[40:43], a[224:227], 0
    v_mfma_f32_16x16x32_bf16 v[4:7], v[44:47], a[228:231], v[4:7]
    v_mfma_f32_16x16x32_bf16 v[4:7], v[48:51], a[232:235], v[4:7]
    v_mfma_f32_16x16x32_bf16 v[4:7], v[52:55], a[236:239], v[4:7]
    s_nop 3
    v_max3_f32 v156, v0, v1, v156
    v_max3_f32 v156, v2, v3, v156
    s_nop 1
    v_max3_f32 v156, v4, v5, v156
    v_max3_f32 v156, v6, v7, v156
    s_add_u32 s41, s41, 1
    s_cmp_lt_u32 s41, 16
    s_cbranch_scc1 L_attn_sp1
    v_mov_b32 v0, v152
    v_mov_b32 v1, v153
    v_mov_b32 v2, v154
    v_mov_b32 v3, v155
    v_mov_b32 v4, v156
    s_nop 1
    v_permlane32_swap_b32 v152, v0
    v_permlane32_swap_b32 v153, v1
    v_permlane32_swap_b32 v154, v2
    v_permlane32_swap_b32 v155, v3
    v_permlane32_swap_b32 v156, v4
    s_nop 1
    v_max_f32 v152, v152, v0
    v_max_f32 v153, v153, v1
    v_max_f32 v154, v154, v2
    v_max_f32 v155, v155, v3
    v_max_f32 v156, v156, v4
    v_mov_b32 v0, v152
    v_mov_b32 v1, v153
    v_mov_b32 v2, v154
    v_mov_b32 v3, v155
    v_mov_b32 v4, v156
    s_nop 1
    v_permlane16_swap_b32 v152, v0
    v_permlane16_swap_b32 v153, v1
    v_permlane16_swap_b32 v154, v2
    v_permlane16_swap_b32 v155, v3
    v_permlane16_swap_b32 v156, v4
    s_nop 1
    v_max_f32 v152, v152, v0
    v_max_f32 v153, v153, v1
    v_max_f32 v154, v154, v2
    v_max_f32 v155, v155, v3
    v_max_f32 v156, v156, v4
    v_subrev_u32 v180, 98304, v162
    v_lshrrev_b32 v181, 2, v180
    v_add_u32 v181, 139264, v181
    s_mul_i32 s36, s24, 1280
    v_add_u32 v182, s36, v181
    s_xor_b32 s37, s24, 2
    s_mul_i32 s36, s37, 1280
    v_add_u32 v183, s36, v181
    ds_write_b32 v182, v152 offset:0
    ds_write_b32 v182, v153 offset:256
    ds_write_b32 v182, v154 offset:512
    ds_write_b32 v182, v155 offset:768
    ds_write_b32 v182, v156 offset:1024
    s_waitcnt lgkmcnt(0)
    s_barrier
    ds_read_b32 v0, v183 offset:0
    ds_read_b32 v1, v183 offset:256
    ds_read_b32 v2, v183 offset:512
    ds_read_b32 v3, v183 offset:768
    ds_read_b32 v4, v183 offset:1024
    s_waitcnt lgkmcnt(0)
    v_max_f32 v152, v152, v0
    v_max_f32 v153, v153, v1
    v_max_f32 v154, v154, v2
    v_max_f32 v155, v155, v3
    v_max_f32 v156, v156, v4
    s_barrier
    v_mov_b32 v128, 0
    v_mov_b32 v129, 0
    v_mov_b32 v130, 0
    v_mov_b32 v131, 0
    v_accvgpr_write_b32 a0, 0
    v_accvgpr_write_b32 a1, 0
    v_accvgpr_write_b32 a2, 0
    v_accvgpr_write_b32 a3, 0
    v_accvgpr_write_b32 a4, 0
    v_accvgpr_write_b32 a5, 0
    v_accvgpr_write_b32 a6, 0
    v_accvgpr_write_b32 a7, 0
    v_accvgpr_write_b32 a8, 0
    v_accvgpr_write_b32 a9, 0
    v_accvgpr_write_b32 a10, 0
    v_accvgpr_write_b32 a11, 0
    v_accvgpr_write_b32 a12, 0
    v_accvgpr_write_b32 a13, 0
    v_accvgpr_write_b32 a14, 0
    v_accvgpr_write_b32 a15, 0
    v_accvgpr_write_b32 a16, 0
    v_accvgpr_write_b32 a17, 0
    v_accvgpr_write_b32 a18, 0
    v_accvgpr_write_b32 a19, 0
    v_accvgpr_write_b32 a20, 0
    v_accvgpr_write_b32 a21, 0
    v_accvgpr_write_b32 a22, 0
    v_accvgpr_write_b32 a23, 0
    v_accvgpr_write_b32 a24, 0
    v_accvgpr_write_b32 a25, 0
    v_accvgpr_write_b32 a26, 0
    v_accvgpr_write_b32 a27, 0
    v_accvgpr_write_b32 a28, 0
    v_accvgpr_write_b32 a29, 0
    v_accvgpr_write_b32 a30, 0
    v_accvgpr_write_b32 a31, 0
    v_mov_b32 v132, 0
    v_mov_b32 v133, 0
    v_mov_b32 v134, 0
    v_mov_b32 v135, 0
    v_accvgpr_write_b32 a32, 0
    v_accvgpr_write_b32 a33, 0
    v_accvgpr_write_b32 a34, 0
    v_accvgpr_write_b32 a35, 0
    v_accvgpr_write_b32 a36, 0
    v_accvgpr_write_b32 a37, 0
    v_accvgpr_write_b32 a38, 0
    v_accvgpr_write_b32 a39, 0
    v_accvgpr_write_b32 a40, 0
    v_accvgpr_write_b32 a41, 0
    v_accvgpr_write_b32 a42, 0
    v_accvgpr_write_b32 a43, 0
    v_accvgpr_write_b32 a44, 0
    v_accvgpr_write_b32 a45, 0
    v_accvgpr_write_b32 a46, 0
    v_accvgpr_write_b32 a47, 0
    v_accvgpr_write_b32 a48, 0
    v_accvgpr_write_b32 a49, 0
    v_accvgpr_write_b32 a50, 0
    v_accvgpr_write_b32 a51, 0
    v_accvgpr_write_b32 a52, 0
    v_accvgpr_write_b32 a53, 0
    v_accvgpr_write_b32 a54, 0
    v_accvgpr_write_b32 a55, 0
    v_accvgpr_write_b32 a56, 0
    v_accvgpr_write_b32 a57, 0
    v_accvgpr_write_b32 a58, 0
    v_accvgpr_write_b32 a59, 0
    v_accvgpr_write_b32 a60, 0
    v_accvgpr_write_b32 a61, 0
    v_accvgpr_write_b32 a62, 0
    v_accvgpr_write_b32 a63, 0
    v_mov_b32 v136, 0
    v_mov_b32 v137, 0
    v_mov_b32 v138, 0
    v_mov_b32 v139, 0
    v_accvgpr_write_b32 a64, 0
    v_accvgpr_write_b32 a65, 0
    v_accvgpr_write_b32 a66, 0
    v_accvgpr_write_b32 a67, 0
    v_accvgpr_write_b32 a68, 0
    v_accvgpr_write_b32 a69, 0
    v_accvgpr_write_b32 a70, 0
    v_accvgpr_write_b32 a71, 0
    v_accvgpr_write_b32 a72, 0
    v_accvgpr_write_b32 a73, 0
    v_accvgpr_write_b32 a74, 0
    v_accvgpr_write_b32 a75, 0
    v_accvgpr_write_b32 a76, 0
    v_accvgpr_write_b32 a77, 0
    v_accvgpr_write_b32 a78, 0
    v_accvgpr_write_b32 a79, 0
    v_accvgpr_write_b32 a80, 0
    v_accvgpr_write_b32 a81, 0
    v_accvgpr_write_b32 a82, 0
    v_accvgpr_write_b32 a83, 0
    v_accvgpr_write_b32 a84, 0
    v_accvgpr_write_b32 a85, 0
    v_accvgpr_write_b32 a86, 0
    v_accvgpr_write_b32 a87, 0
    v_accvgpr_write_b32 a88, 0
    v_accvgpr_write_b32 a89, 0
    v_accvgpr_write_b32 a90, 0
    v_accvgpr_write_b32 a91, 0
    v_accvgpr_write_b32 a92, 0
    v_accvgpr_write_b32 a93, 0
    v_accvgpr_write_b32 a94, 0
    v_accvgpr_write_b32 a95, 0
    v_mov_b32 v140, 0
    v_mov_b32 v141, 0
    v_mov_b32 v142, 0
    v_mov_b32 v143, 0
    v_accvgpr_write_b32 a96, 0
    v_accvgpr_write_b32 a97, 0
    v_accvgpr_write_b32 a98, 0
    v_accvgpr_write_b32 a99, 0
    v_accvgpr_write_b32 a100, 0
    v_accvgpr_write_b32 a101, 0
    v_accvgpr_write_b32 a102, 0
    v_accvgpr_write_b32 a103, 0
    v_accvgpr_write_b32 a104, 0
    v_accvgpr_write_b32 a105, 0
    v_accvgpr_write_b32 a106, 0
    v_accvgpr_write_b32 a107, 0
    v_accvgpr_write_b32 a108, 0
    v_accvgpr_write_b32 a109, 0
    v_accvgpr_write_b32 a110, 0
    v_accvgpr_write_b32 a111, 0
    v_accvgpr_write_b32 a112, 0
    v_accvgpr_write_b32 a113, 0
    v_accvgpr_write_b32 a114, 0
    v_accvgpr_write_b32 a115, 0
    v_accvgpr_write_b32 a116, 0
    v_accvgpr_write_b32 a117, 0
    v_accvgpr_write_b32 a118, 0
    v_accvgpr_write_b32 a119, 0
    v_accvgpr_write_b32 a120, 0
    v_accvgpr_write_b32 a121, 0
    v_accvgpr_write_b32 a122, 0
    v_accvgpr_write_b32 a123, 0
    v_accvgpr_write_b32 a124, 0
    v_accvgpr_write_b32 a125, 0
    v_accvgpr_write_b32 a126, 0
    v_accvgpr_write_b32 a127, 0
    v_mov_b32 v144, 0
    v_mov_b32 v145, 0
    v_mov_b32 v146, 0
    v_mov_b32 v147, 0
    v_accvgpr_write_b32 a128, 0
    v_accvgpr_write_b32 a129, 0
    v_accvgpr_write_b32 a130, 0
    v_accvgpr_write_b32 a131, 0
    v_accvgpr_write_b32 a132, 0
    v_accvgpr_write_b32 a133, 0
    v_accvgpr_write_b32 a134, 0
    v_accvgpr_write_b32 a135, 0
    v_accvgpr_write_b32 a136, 0
    v_accvgpr_write_b32 a137, 0
    v_accvgpr_write_b32 a138, 0
    v_accvgpr_write_b32 a139, 0
    v_accvgpr_write_b32 a140, 0
    v_accvgpr_write_b32 a141, 0
    v_accvgpr_write_b32 a142, 0
    v_accvgpr_write_b32 a143, 0
    v_accvgpr_write_b32 a144, 0
    v_accvgpr_write_b32 a145, 0
    v_accvgpr_write_b32 a146, 0
    v_accvgpr_write_b32 a147, 0
    v_accvgpr_write_b32 a148, 0
    v_accvgpr_write_b32 a149, 0
    v_accvgpr_write_b32 a150, 0
    v_accvgpr_write_b32 a151, 0
    v_accvgpr_write_b32 a152, 0
    v_accvgpr_write_b32 a153, 0
    v_accvgpr_write_b32 a154, 0
    v_accvgpr_write_b32 a155, 0
    v_accvgpr_write_b32 a156, 0
    v_accvgpr_write_b32 a157, 0
    v_accvgpr_write_b32 a158, 0
    v_accvgpr_write_b32 a159, 0
    s_mov_b32 s41, 0
L_attn_sp2:
    s_add_u32 s26, s55, s41
    s_add_u32 s38, s26, 0
    s_add_u32 s36, s38, s86
    s_and_b32 s36, s36, 15
    s_lshl_b32 s36, s36, 14
    s_add_u32 s36, s36, s42
    s_lshr_b32 s37, s38, 4
    s_lshl_b32 s37, s37, 25
    s_add_u32 s36, s36, s37
    s_cmp_lt_u32 s38, 32
    s_cselect_b32 s29, s36, 0x70000000
    s_add_u32 m0, s52, 0
    s_nop 0
    buffer_load_dwordx4 v164, s[4:7], s29 offen nt lds
    buffer_load_dwordx4 v165, s[4:7], s29 offen offset:1024 nt lds
    buffer_load_dwordx4 v166, s[4:7], s29 offen offset:2048 nt lds
    buffer_load_dwordx4 v167, s[4:7], s29 offen offset:3072 nt lds
    s_add_u32 m0, s53, 0
    s_nop 0
    buffer_load_dwordx4 v168, s[8:11], s29 offen nt lds
    buffer_load_dwordx4 v169, s[8:11], s29 offen offset:1024 nt lds
    buffer_load_dwordx4 v168, s[8:11], s29 offen offset:2048 nt lds
    buffer_load_dwordx4 v169, s[8:11], s29 offen offset:3072 nt lds
    s_waitcnt vmcnt(0)
    s_barrier
    s_mov_b32 s27, 0
    s_add_u32 s39, s25, s27
    v_add_u32 v172, s39, v160
    v_xor_b32 v173, 64, v172
    v_xor_b32 v174, 128, v172
    v_xor_b32 v175, 192, v172
    ds_read_b128 v[24:27], v172 offset:0
    ds_read_b128 v[28:31], v173 offset:0
    ds_read_b128 v[32:35], v174 offset:0
    ds_read_b128 v[36:39], v175 offset:0
    ds_read_b128 v[40:43], v172 offset:4096
    ds_read_b128 v[44:47], v173 offset:4096
    ds_read_b128 v[48:51], v174 offset:4096
    ds_read_b128 v[52:55], v175 offset:4096
    s_waitcnt lgkmcnt(0)
    s_add_u32 s39, s82, s27
    v_add_u32 v232, s39, v161
    v_xor_b32 v233, 32, v232
    v_xor_b32 v234, 64, v232
    v_xor_b32 v235, 96, v232
    v_xor_b32 v236, 128, v232
    v_xor_b32 v237, 160, v232
    v_xor_b32 v238, 192, v232
    v_xor_b32 v239, 224, v232
    ds_read_b64_tr_b16 v[56:57], v232 offset:0
    ds_read_b64_tr_b16 v[58:59], v232 offset:4096
    ds_read_b64_tr_b16 v[60:61], v233 offset:0
    ds_read_b64_tr_b16 v[62:63], v233 offset:4096
    ds_read_b64_tr_b16 v[64:65], v234 offset:0
    ds_read_b64_tr_b16 v[66:67], v234 offset:4096
    ds_read_b64_tr_b16 v[68:69], v235 offset:0
    ds_read_b64_tr_b16 v[70:71], v235 offset:4096
    ds_read_b64_tr_b16 v[72:73], v236 offset:0
    ds_read_b64_tr_b16 v[74:75], v236 offset:4096
    ds_read_b64_tr_b16 v[76:77], v237 offset:0
    ds_read_b64_tr_b16 v[78:79], v237 offset:4096
    ds_read_b64_tr_b16 v[80:81], v238 offset:0
    ds_read_b64_tr_b16 v[82:83], v238 offset:4096
    ds_read_b64_tr_b16 v[84:85], v239 offset:0
    ds_read_b64_tr_b16 v[86:87], v239 offset:4096
    s_waitcnt lgkmcnt(0)
    s_barrier
    v_mfma_f32_16x16x32_bf16 v[0:3], v[24:27], a[160:163], 0
    v_mfma_f32_16x16x32_bf16 v[0:3], v[28:31], a[164:167], v[0:3]
    v_mfma_f32_16x16x32_bf16 v[0:3], v[32:35], a[168:171], v[0:3]
    v_mfma_f32_16x16x32_bf16 v[0:3], v[36:39], a[172:175], v[0:3]
    v_mfma_f32_16x16x32_bf16 v[4:7], v[40:43], a[160:163], 0
    v_mfma_f32_16x16x32_bf16 v[4:7], v[44:47], a[164:167], v[4:7]
    v_mfma_f32_16x16x32_bf16 v[4:7], v[48:51], a[168:171], v[4:7]
    v_mfma_f32_16x16x32_bf16 v[4:7], v[52:55], a[172:175], v[4:7]
    s_nop 3
    v_sub_f32 v0, v0, v152
    v_sub_f32 v1, v1, v152
    v_sub_f32 v2, v2, v152
    v_sub_f32 v3, v3, v152
    v_sub_f32 v4, v4, v152
    v_sub_f32 v5, v5, v152
    v_sub_f32 v6, v6, v152
    v_sub_f32 v7, v7, v152
    v_exp_f32 v0, v0
    v_exp_f32 v1, v1
    v_exp_f32 v2, v2
    v_exp_f32 v3, v3
    v_exp_f32 v4, v4
    v_exp_f32 v5, v5
    v_exp_f32 v6, v6
    v_exp_f32 v7, v7
    s_nop 0
    v_cvt_pk_bf16_f32 v16, v0, v1
    v_cvt_pk_bf16_f32 v17, v2, v3
    v_cvt_pk_bf16_f32 v18, v4, v5
    v_cvt_pk_bf16_f32 v19, v6, v7
    s_nop 1
    v_mfma_f32_16x16x32_bf16 v[128:131], v[148:151], v[16:19], v[128:131]
    v_mfma_f32_16x16x32_bf16 a[0:3], v[56:59], v[16:19], a[0:3]
    v_mfma_f32_16x16x32_bf16 a[4:7], v[60:63], v[16:19], a[4:7]
    v_mfma_f32_16x16x32_bf16 a[8:11], v[64:67], v[16:19], a[8:11]
    v_mfma_f32_16x16x32_bf16 a[12:15], v[68:71], v[16:19], a[12:15]
    v_mfma_f32_16x16x32_bf16 a[16:19], v[72:75], v[16:19], a[16:19]
    v_mfma_f32_16x16x32_bf16 a[20:23], v[76:79], v[16:19], a[20:23]
    v_mfma_f32_16x16x32_bf16 a[24:27], v[80:83], v[16:19], a[24:27]
    v_mfma_f32_16x16x32_bf16 a[28:31], v[84:87], v[16:19], a[28:31]
    v_mfma_f32_16x16x32_bf16 v[0:3], v[24:27], a[176:179], 0
    v_mfma_f32_16x16x32_bf16 v[0:3], v[28:31], a[180:183], v[0:3]
    v_mfma_f32_16x16x32_bf16 v[0:3], v[32:35], a[184:187], v[0:3]
    v_mfma_f32_16x16x32_bf16 v[0:3], v[36:39], a[188:191], v[0:3]
    v_mfma_f32_16x16x32_bf16 v[4:7], v[40:43], a[176:179], 0
    v_mfma_f32_16x16x32_bf16 v[4:7], v[44:47], a[180:183], v[4:7]
    v_mfma_f32_16x16x32_bf16 v[4:7], v[48:51], a[184:187], v[4:7]
    v_mfma_f32_16x16x32_bf16 v[4:7], v[52:55], a[188:191], v[4:7]
    s_nop 3
    v_sub_f32 v0, v0, v153
    v_sub_f32 v1, v1, v153
    v_sub_f32 v2, v2, v153
    v_sub_f32 v3, v3, v153
    v_sub_f32 v4, v4, v153
    v_sub_f32 v5, v5, v153
    v_sub_f32 v6, v6, v153
    v_sub_f32 v7, v7, v153
    v_exp_f32 v0, v0
    v_exp_f32 v1, v1
    v_exp_f32 v2, v2
    v_exp_f32 v3, v3
    v_exp_f32 v4, v4
    v_exp_f32 v5, v5
    v_exp_f32 v6, v6
    v_exp_f32 v7, v7
    s_nop 0
    v_cvt_pk_bf16_f32 v16, v0, v1
    v_cvt_pk_bf16_f32 v17, v2, v3
    v_cvt_pk_bf16_f32 v18, v4, v5
    v_cvt_pk_bf16_f32 v19, v6, v7
    s_nop 1
    v_mfma_f32_16x16x32_bf16 v[132:135], v[148:151], v[16:19], v[132:135]
    v_mfma_f32_16x16x32_bf16 a[32:35], v[56:59], v[16:19], a[32:35]
    v_mfma_f32_16x16x32_bf16 a[36:39], v[60:63], v[16:19], a[36:39]
    v_mfma_f32_16x16x32_bf16 a[40:43], v[64:67], v[16:19], a[40:43]
    v_mfma_f32_16x16x32_bf16 a[44:47], v[68:71], v[16:19], a[44:47]
    v_mfma_f32_16x16x32_bf16 a[48:51], v[72:75], v[16:19], a[48:51]
    v_mfma_f32_16x16x32_bf16 a[52:55], v[76:79], v[16:19], a[52:55]
    v_mfma_f32_16x16x32_bf16 a[56:59], v[80:83], v[16:19], a[56:59]
    v_mfma_f32_16x16x32_bf16 a[60:63], v[84:87], v[16:19], a[60:63]
    v_mfma_f32_16x16x32_bf16 v[0:3], v[24:27], a[192:195], 0
    v_mfma_f32_16x16x32_bf16 v[0:3], v[28:31], a[196:199], v[0:3]
    v_mfma_f32_16x16x32_bf16 v[0:3], v[32:35], a[200:203], v[0:3]
    v_mfma_f32_16x16x32_bf16 v[0:3], v[36:39], a[204:207], v[0:3]
    v_mfma_f32_16x16x32_bf16 v[4:7], v[40:43], a[192:195], 0
    v_mfma_f32_16x16x32_bf16 v[4:7], v[44:47], a[196:199], v[4:7]
    v_mfma_f32_16x16x32_bf16 v[4:7], v[48:51], a[200:203], v[4:7]
    v_mfma_f32_16x16x32_bf16 v[4:7], v[52:55], a[204:207], v[4:7]
    s_nop 3
    v_sub_f32 v0, v0, v154
    v_sub_f32 v1, v1, v154
    v_sub_f32 v2, v2, v154
    v_sub_f32 v3, v3, v154
    v_sub_f32 v4, v4, v154
    v_sub_f32 v5, v5, v154
    v_sub_f32 v6, v6, v154
    v_sub_f32 v7, v7, v154
    v_exp_f32 v0, v0
    v_exp_f32 v1, v1
    v_exp_f32 v2, v2
    v_exp_f32 v3, v3
    v_exp_f32 v4, v4
    v_exp_f32 v5, v5
    v_exp_f32 v6, v6
    v_exp_f32 v7, v7
    s_nop 0
    v_cvt_pk_bf16_f32 v16, v0, v1
    v_cvt_pk_bf16_f32 v17, v2, v3
    v_cvt_pk_bf16_f32 v18, v4, v5
    v_cvt_pk_bf16_f32 v19, v6, v7
    s_nop 1
    v_mfma_f32_16x16x32_bf16 v[136:139], v[148:151], v[16:19], v[136:139]
    v_mfma_f32_16x16x32_bf16 a[64:67], v[56:59], v[16:19], a[64:67]
    v_mfma_f32_16x16x32_bf16 a[68:71], v[60:63], v[16:19], a[68:71]
    v_mfma_f32_16x16x32_bf16 a[72:75], v[64:67], v[16:19], a[72:75]
    v_mfma_f32_16x16x32_bf16 a[76:79], v[68:71], v[16:19], a[76:79]
    v_mfma_f32_16x16x32_bf16 a[80:83], v[72:75], v[16:19], a[80:83]
    v_mfma_f32_16x16x32_bf16 a[84:87], v[76:79], v[16:19], a[84:87]
    v_mfma_f32_16x16x32_bf16 a[88:91], v[80:83], v[16:19], a[88:91]
    v_mfma_f32_16x16x32_bf16 a[92:95], v[84:87], v[16:19], a[92:95]
    v_mfma_f32_16x16x32_bf16 v[0:3], v[24:27], a[208:211], 0
    v_mfma_f32_16x16x32_bf16 v[0:3], v[28:31], a[212:215], v[0:3]
    v_mfma_f32_16x16x32_bf16 v[0:3], v[32:35], a[216:219], v[0:3]
    v_mfma_f32_16x16x32_bf16 v[0:3], v[36:39], a[220:223], v[0:3]
    v_mfma_f32_16x16x32_bf16 v[4:7], v[40:43], a[208:211], 0
    v_mfma_f32_16x16x32_bf16 v[4:7], v[44:47], a[212:215], v[4:7]
    v_mfma_f32_16x16x32_bf16 v[4:7], v[48:51], a[216:219], v[4:7]
    v_mfma_f32_16x16x32_bf16 v[4:7], v[52:55], a[220:223], v[4:7]
    s_nop 3
    v_sub_f32 v0, v0, v155
    v_sub_f32 v1, v1, v155
    v_sub_f32 v2, v2, v155
    v_sub_f32 v3, v3, v155
    v_sub_f32 v4, v4, v155
    v_sub_f32 v5, v5, v155
    v_sub_f32 v6, v6, v155
    v_sub_f32 v7, v7, v155
    v_exp_f32 v0, v0
    v_exp_f32 v1, v1
    v_exp_f32 v2, v2
    v_exp_f32 v3, v3
    v_exp_f32 v4, v4
    v_exp_f32 v5, v5
    v_exp_f32 v6, v6
    v_exp_f32 v7, v7
    s_nop 0
    v_cvt_pk_bf16_f32 v16, v0, v1
    v_cvt_pk_bf16_f32 v17, v2, v3
    v_cvt_pk_bf16_f32 v18, v4, v5
    v_cvt_pk_bf16_f32 v19, v6, v7
    s_nop 1
    v_mfma_f32_16x16x32_bf16 v[140:143], v[148:151], v[16:19], v[140:143]
    v_mfma_f32_16x16x32_bf16 a[96:99], v[56:59], v[16:19], a[96:99]
    v_mfma_f32_16x16x32_bf16 a[100:103], v[60:63], v[16:19], a[100:103]
    v_mfma_f32_16x16x32_bf16 a[104:107], v[64:67], v[16:19], a[104:107]
    v_mfma_f32_16x16x32_bf16 a[108:111], v[68:71], v[16:19], a[108:111]
    v_mfma_f32_16x16x32_bf16 a[112:115], v[72:75], v[16:19], a[112:115]
    v_mfma_f32_16x16x32_bf16 a[116:119], v[76:79], v[16:19], a[116:119]
    v_mfma_f32_16x16x32_bf16 a[120:123], v[80:83], v[16:19], a[120:123]
    v_mfma_f32_16x16x32_bf16 a[124:127], v[84:87], v[16:19], a[124:127]
    v_mfma_f32_16x16x32_bf16 v[0:3], v[24:27], a[224:227], 0
    v_mfma_f32_16x16x32_bf16 v[0:3], v[28:31], a[228:231], v[0:3]
    v_mfma_f32_16x16x32_bf16 v[0:3], v[32:35], a[232:235], v[0:3]
    v_mfma_f32_16x16x32_bf16 v[0:3], v[36:39], a[236:239], v[0:3]
    v_mfma_f32_16x16x32_bf16 v[4:7], v[40:43], a[224:227], 0
    v_mfma_f32_16x16x32_bf16 v[4:7], v[44:47], a[228:231], v[4:7]
    v_mfma_f32_16x16x32_bf16 v[4:7], v[48:51], a[232:235], v[4:7]
    v_mfma_f32_16x16x32_bf16 v[4:7], v[52:55], a[236:239], v[4:7]
    s_nop 3
    v_sub_f32 v0, v0, v156
    v_sub_f32 v1, v1, v156
    v_sub_f32 v2, v2, v156
    v_sub_f32 v3, v3, v156
    v_sub_f32 v4, v4, v156
    v_sub_f32 v5, v5, v156
    v_sub_f32 v6, v6, v156
    v_sub_f32 v7, v7, v156
    v_exp_f32 v0, v0
    v_exp_f32 v1, v1
    v_exp_f32 v2, v2
    v_exp_f32 v3, v3
    v_exp_f32 v4, v4
    v_exp_f32 v5, v5
    v_exp_f32 v6, v6
    v_exp_f32 v7, v7
    s_nop 0
    v_cvt_pk_bf16_f32 v16, v0, v1
    v_cvt_pk_bf16_f32 v17, v2, v3
    v_cvt_pk_bf16_f32 v18, v4, v5
    v_cvt_pk_bf16_f32 v19, v6, v7
    s_nop 1
    v_mfma_f32_16x16x32_bf16 v[144:147], v[148:151], v[16:19], v[144:147]
    v_mfma_f32_16x16x32_bf16 a[128:131], v[56:59], v[16:19], a[128:131]
    v_mfma_f32_16x16x32_bf16 a[132:135], v[60:63], v[16:19], a[132:135]
    v_mfma_f32_16x16x32_bf16 a[136:139], v[64:67], v[16:19], a[136:139]
    v_mfma_f32_16x16x32_bf16 a[140:143], v[68:71], v[16:19], a[140:143]
    v_mfma_f32_16x16x32_bf16 a[144:147], v[72:75], v[16:19], a[144:147]
    v_mfma_f32_16x16x32_bf16 a[148:151], v[76:79], v[16:19], a[148:151]
    v_mfma_f32_16x16x32_bf16 a[152:155], v[80:83], v[16:19], a[152:155]
    v_mfma_f32_16x16x32_bf16 a[156:159], v[84:87], v[16:19], a[156:159]
    s_add_u32 s41, s41, 1
    s_cmp_lt_u32 s41, 16
    s_cbranch_scc1 L_attn_sp2
    s_cmp_eq_u32 s40, 0
    s_cbranch_scc0 L_attn_sp3
    s_mov_b32 s26, 8192
    s_mov_b32 s27, 16384
    s_mov_b32 s28, 0
    s_add_u32 s38, s85, 0
    s_add_u32 s36, s38, s86
    s_and_b32 s36, s36, 15
    s_lshl_b32 s36, s36, 14
    s_add_u32 s36, s36, s42
    s_lshr_b32 s37, s38, 4
    s_lshl_b32 s37, s37, 25
    s_add_u32 s36, s36, s37
    s_cmp_lt_u32 s38, 32
    s_cselect_b32 s29, s36, 0x70000000
    s_add_u32 m0, s52, s26
    s_nop 0
    buffer_load_dwordx4 v164, s[4:7], s29 offen nt lds
    buffer_load_dwordx4 v165, s[4:7], s29 offen offset:1024 nt lds
    buffer_load_dwordx4 v166, s[4:7], s29 offen offset:2048 nt lds
    buffer_load_dwordx4 v167, s[4:7], s29 offen offset:3072 nt lds
    s_add_u32 s38, s85, 0
    s_add_u32 s36, s38, s86
    s_and_b32 s36, s36, 15
    s_lshl_b32 s36, s36, 14
    s_add_u32 s36, s36, s42
    s_lshr_b32 s37, s38, 4
    s_lshl_b32 s37, s37, 25
    s_add_u32 s36, s36, s37
    s_cmp_lt_u32 s38, 32
    s_cselect_b32 s29, s36, 0x70000000
    s_add_u32 m0, s53, s26
    s_nop 0
    buffer_load_dwordx4 v168, s[8:11], s29 offen nt lds
    buffer_load_dwordx4 v169, s[8:11], s29 offen offset:1024 nt lds
    buffer_load_dwordx4 v168, s[8:11], s29 offen offset:2048 nt lds
    buffer_load_dwordx4 v169, s[8:11], s29 offen offset:3072 nt lds
    s_add_u32 s38, s85, 1
    s_add_u32 s36, s38, s86
    s_and_b32 s36, s36, 15
    s_lshl_b32 s36, s36, 14
    s_add_u32 s36, s36, s42
    s_lshr_b32 s37, s38, 4
    s_lshl_b32 s37, s37, 25
    s_add_u32 s36, s36, s37
    s_cmp_lt_u32 s38, 32
    s_cselect_b32 s29, s36, 0x70000000
    s_add_u32 m0, s52, s27
    s_nop 0
    buffer_load_dwordx4 v164, s[4:7], s29 offen nt lds
    buffer_load_dwordx4 v165, s[4:7], s29 offen offset:1024 nt lds
    buffer_load_dwordx4 v166, s[4:7], s29 offen offset:2048 nt lds
    buffer_load_dwordx4 v167, s[4:7], s29 offen offset:3072 nt lds
    s_add_u32 s38, s85, 1
    s_add_u32 s36, s38, s86
    s_and_b32 s36, s36, 15
    s_lshl_b32 s36, s36, 14
    s_add_u32 s36, s36, s42
    s_lshr_b32 s37, s38, 4
    s_lshl_b32 s37, s37, 25
    s_add_u32 s36, s36, s37
    s_cmp_lt_u32 s38, 32
    s_cselect_b32 s29, s36, 0x70000000
    s_add_u32 m0, s53, s27
    s_nop 0
    buffer_load_dwordx4 v168, s[8:11], s29 offen nt lds
    buffer_load_dwordx4 v169, s[8:11], s29 offen offset:1024 nt lds
    buffer_load_dwordx4 v168, s[8:11], s29 offen offset:2048 nt lds
    buffer_load_dwordx4 v169, s[8:11], s29 offen offset:3072 nt lds
    s_add_u32 s38, s85, 2
    s_add_u32 s36, s38, s86
    s_and_b32 s36, s36, 15
    s_lshl_b32 s36, s36, 14
    s_add_u32 s36, s36, s42
    s_lshr_b32 s37, s38, 4
    s_lshl_b32 s37, s37, 25
    s_add_u32 s36, s36, s37
    s_cmp_lt_u32 s38, 32
    s_cselect_b32 s29, s36, 0x70000000
    s_add_u32 m0, s52, s28
    s_nop 0
    buffer_load_dwordx4 v164, s[4:7], s29 offen nt lds
    buffer_load_dwordx4 v165, s[4:7], s29 offen offset:1024 nt lds
    buffer_load_dwordx4 v166, s[4:7], s29 offen offset:2048 nt lds
    buffer_load_dwordx4 v167, s[4:7], s29 offen offset:3072 nt lds
    s_mov_b32 s30, s29
    s_add_u32 s38, s85, 3
    s_add_u32 s36, s38, s86
    s_and_b32 s36, s36, 15
    s_lshl_b32 s36, s36, 14
    s_add_u32 s36, s36, s42
    s_lshr_b32 s37, s38, 4
    s_lshl_b32 s37, s37, 25
    s_add_u32 s36, s36, s37
    s_cmp_lt_u32 s38, 32
    s_cselect_b32 s29, s36, 0x70000000
    s_waitcnt vmcnt(0)
    s_barrier
    s_add_u32 s39, s25, s26
    v_add_u32 v172, s39, v160
    v_xor_b32 v173, 64, v172
    v_xor_b32 v174, 128, v172
    v_xor_b32 v175, 192, v172
    ds_read_b128 v[24:27], v172 offset:0
    ds_read_b128 v[28:31], v173 offset:0
    ds_read_b128 v[32:35], v174 offset:0
    ds_read_b128 v[36:39], v175 offset:0
    ds_read_b128 v[40:43], v172 offset:4096
    ds_read_b128 v[44:47], v173 offset:4096
    ds_read_b128 v[48:51], v174 offset:4096
    ds_read_b128 v[52:55], v175 offset:4096
    s_waitcnt lgkmcnt(0)
    s_barrier
L_attn_sp3:
    s_nop 7
    v_subrev_u32 v180, 98304, v162
    v_lshrrev_b32 v181, 2, v180
    v_add_u32 v181, 139264, v181
    s_mul_i32 s36, s24, 1280
    v_add_u32 v182, s36, v181
    ds_write_b32 v182, v128 offset:0
    ds_write_b32 v182, v132 offset:256
    ds_write_b32 v182, v136 offset:512
    ds_write_b32 v182, v140 offset:768
    ds_write_b32 v182, v144 offset:1024
    s_waitcnt lgkmcnt(0)
    s_barrier
    ds_read_b32 v192, v181 offset:0
    ds_read_b32 v193, v181 offset:256
    ds_read_b32 v194, v181 offset:512
    ds_read_b32 v195, v181 offset:768
    ds_read_b32 v196, v181 offset:1024
    ds_read_b32 v197, v181 offset:1280
    ds_read_b32 v198, v181 offset:1536
    ds_read_b32 v199, v181 offset:1792
    ds_read_b32 v200, v181 offset:2048
    ds_read_b32 v201, v181 offset:2304
    ds_read_b32 v202, v181 offset:2560
    ds_read_b32 v203, v181 offset:2816
    ds_read_b32 v204, v181 offset:3072
    ds_read_b32 v205, v181 offset:3328
    ds_read_b32 v206, v181 offset:3584
    ds_read_b32 v207, v181 offset:3840
    ds_read_b32 v208, v181 offset:4096
    ds_read_b32 v209, v181 offset:4352
    ds_read_b32 v210, v181 offset:4608
    ds_read_b32 v211, v181 offset:4864
    s_waitcnt lgkmcnt(0)
    v_add_f32 v192, v192, v202
    v_add_f32 v197, v197, v207
    v_add_f32 v193, v193, v203
    v_add_f32 v198, v198, v208
    v_add_f32 v194, v194, v204
    v_add_f32 v199, v199, v209
    v_add_f32 v195, v195, v205
    v_add_f32 v200, v200, v210
    v_add_f32 v196, v196, v206
    v_add_f32 v201, v201, v211
    s_cmp_eq_u32 s84, 0
    s_cselect_b64 vcc, -1, 0
    s_nop 1
    v_cndmask_b32 v128, v197, v192, vcc
    v_cndmask_b32 v132, v198, v193, vcc
    v_cndmask_b32 v136, v199, v194, vcc
    v_cndmask_b32 v140, v200, v195, vcc
    v_cndmask_b32 v144, v201, v196, vcc
    v_rcp_f32 v128, v128
    v_rcp_f32 v132, v132
    v_rcp_f32 v136, v136
    v_rcp_f32 v140, v140
    v_rcp_f32 v144, v144
    s_branch L_attn_oex
L_attn_end:
    s_endpgm

.section .rodata,"a"
.p2align 6
.amdhsa_kernel concat_heads__mha_block_cached__gqa_block_cached__near_ridge_kernel
  .amdhsa_next_free_vgpr 512
  .amdhsa_next_free_sgpr 102
  .amdhsa_accum_offset 256
  .amdhsa_group_segment_fixed_size 0
  .amdhsa_kernarg_size 104
  .amdhsa_user_sgpr_count 2
  .amdhsa_user_sgpr_kernarg_segment_ptr 1
  .amdhsa_system_sgpr_workgroup_id_x 1
.end_amdhsa_kernel
```
